```python
import torch

def _softmax(x, axis=-1):
    return torch.softmax(x, dim=axis)

def _gelu(x):
    return torch.nn.functional.gelu(x, approximate='tanh')

def _silu(x):
    return torch.nn.functional.silu(x)

def _sigmoid(x):
    return torch.sigmoid(x)

def _layernorm(x, axis=-1, eps=1e-05):
    m = x.mean(dim=axis, keepdim=True)
    v = x.var(dim=axis, keepdim=True, unbiased=False)
    return (x - m) / torch.sqrt(v + eps)

def _scatter_add(tgt, idx, src, axis=0):
    return tgt.clone().index_add_(axis, idx, src)

def _segment_sum(src, seg, n):
    out = torch.zeros((n,) + src.shape[1:], dtype=src.dtype)
    return out.index_add_(0, seg, src)

def _pad(x, pw):
    flat = tuple((v for pair in reversed(pw) for v in pair))
    return torch.nn.functional.pad(x, flat)
kernel_name = 'adaLN_cond__ssm_conv_h3__mixer_gmlp__prompt'

def setup_inputs():

    _w = lambda a: (lambda t: t.to(torch.bfloat16) if t.is_floating_point() else t)(torch.as_tensor(a))

    def _A_setup():
        B, S, D = (1, 2048, 1024)
        ks = 4
        return {'q': _w((lambda *s: torch.randn(*s, dtype=torch.bfloat16) * 0.05)(B, S, D)), 'k': _w((lambda *s: torch.randn(*s, dtype=torch.bfloat16) * 0.8)(B, S, D)), 'v': _w((lambda *s: torch.randn(*s, dtype=torch.bfloat16) * 0.8)(B, S, D)), 'shift_k': _w((lambda *s: torch.randn(*s, dtype=torch.bfloat16) * 0.8)(D, ks) * 0.5), 'ssm_k': _w((lambda *s: torch.randn(*s, dtype=torch.bfloat16) * 0.8)(D, S) * (1.0 / S ** 0.5)), 'ssm_D': _w((lambda *s: torch.randn(*s, dtype=torch.bfloat16) * 0.8)(D))}
    _A_in = _A_setup()

    def _B_setup():
        B, S, D, F = (1, 2048, 1024, 3584)
        Fh = F // 2
        return {'x': _w((lambda *s: torch.randn(*s, dtype=torch.bfloat16) * 0.05)(B, S, D)), 'w_in': _w((lambda *s: torch.randn(*s, dtype=torch.bfloat16) * 0.4)(D, 2 * Fh)), 'w_sp': _w(0.01 * (lambda *s: torch.randn(*s, dtype=torch.bfloat16) * 0.4)(S, S)), 'b_sp': _w(1.0 + 0.01 * (lambda *s: torch.randn(*s, dtype=torch.bfloat16) * 0.05)(S)), 'w_out': _w((lambda *s: torch.randn(*s, dtype=torch.bfloat16) * 0.05)(Fh, D))}
    _B_in = _B_setup()
    return {'A_q': _A_in['q'], 'A_k': _A_in['k'], 'A_v': _A_in['v'], 'A_shift_k': _A_in['shift_k'], 'A_ssm_k': _A_in['ssm_k'], 'A_ssm_D': _A_in['ssm_D'], 'B_x': _B_in['x'], 'B_w_in': _B_in['w_in'], 'B_w_sp': _B_in['w_sp'], 'B_b_sp': _B_in['b_sp'], 'B_w_out': _B_in['w_out'], 'c': _w((lambda *s: torch.randn(*s, dtype=torch.bfloat16) * 0.1)(1, 1024) * 8.0), 'w_mod': _w((lambda *s: torch.randn(*s, dtype=torch.bfloat16) * 0.1)(1024, 6 * 1024) * 1024 ** (-0.5) * 8.0)}

def reference(A_q, A_k, A_v, A_shift_k, A_ssm_k, A_ssm_D, B_x, B_w_in, B_w_sp, B_b_sp, B_w_out, c, w_mod):

    def _A_ref(q, k, v, shift_k, ssm_k, ssm_D):
        B, S, D = q.shape
        ks = shift_k.shape[-1]
        k_pad = _pad(k, ((0, 0), (ks - 1, 0), (0, 0)))
        k_shift = torch.zeros_like(k)
        for t in range(ks):
            k_shift = k_shift + k_pad[:, t:t + S, :] * shift_k[:, ks - 1 - t][None, None, :]
        kv = k_shift * v
        L = 2 * S
        kv_pad = _pad(kv, ((0, 0), (0, S), (0, 0)))
        kf_pad = _pad(ssm_k, ((0, 0), (0, S)))
        kv_f = (lambda x, axes=(-2, -1): torch.fft.rfft2(x.float(), dim=axes))(kv_pad[:, None, :, :], axes=(1, 2))
        kf_f = (lambda x, axes=(-2, -1): torch.fft.rfft2(x.float(), dim=axes))(kf_pad[:, None, :], axes=(1, 2))
        kf_f = (lambda x, *d: x.permute(*d))(kf_f, 1, 2, 0)
        y_f = kv_f * kf_f[None, :, :, :]
        y = (lambda x, s, axes=(-2, -1): torch.fft.irfft2(x, s=s, dim=axes).to(torch.bfloat16))(y_f, (1, L), axes=(1, 2))[:, 0, :S, :]
        y = y + kv * ssm_D[None, None, :]
        return q * y

    def _B_ref(x, w_in, w_sp, b_sp, w_out):
        B, S, D = x.shape
        F = w_in.shape[-1]
        Fh = F // 2
        z = _gelu(torch.einsum('bsd,df->bsf', x, w_in))
        z1 = z[..., :Fh].clone()
        z2 = _layernorm(z[..., Fh:], axis=-1)
        g = torch.einsum('ts,bsf->btf', w_sp, z2) + b_sp[None, :, None]
        return torch.einsum('bsf,fd->bsd', z1 * g, w_out)
    x = A_q
    mod = (_silu(c) @ w_mod).reshape(c.shape[0], 6, 1, -1)
    sa, ca, ga, sb, cb, gb = (mod[:, 0].clone(), mod[:, 1].clone(), mod[:, 2].clone(), mod[:, 3].clone(), mod[:, 4].clone(), mod[:, 5].clone())
    h = _layernorm(x, axis=-1) * (1 + ca) + sa
    x = x + ga * _A_ref(h, A_k, A_v, A_shift_k, A_ssm_k, A_ssm_D)
    h = _layernorm(x, axis=-1) * (1 + cb) + sb
    x = x + gb * _B_ref(h, B_w_in, B_w_sp, B_b_sp, B_w_out)
    return x
```

```asm
; @launch kernel=adaLN_cond__ssm_conv_h3__mixer_gmlp__prompt_kernel grid=(256,1,1) block=(512,1,1) lds=163840
.amdgcn_target "amdgcn-amd-amdhsa--gfx950"
.text
.globl adaLN_cond__ssm_conv_h3__mixer_gmlp__prompt_kernel
.p2align 8
.type adaLN_cond__ssm_conv_h3__mixer_gmlp__prompt_kernel,@function
adaLN_cond__ssm_conv_h3__mixer_gmlp__prompt_kernel:
    s_cmp_ge_u32 s2, 256
    s_cbranch_scc1 L_done
    s_load_dwordx16 s[64:79], s[0:1], 0
    s_load_dwordx16 s[80:95], s[0:1], 64
    v_lshrrev_b32 v1, 6, v0
    v_and_b32 v2, 63, v0
    v_readfirstlane_b32 s3, v1
    s_and_b32 s4, s2, 7
    s_lshr_b32 s5, s2, 3
    s_lshl_b32 s7, s4, 5
    s_add_u32 s7, s7, s5
    v_and_b32 v3, 15, v2
    v_lshrrev_b32 v4, 4, v2
    s_mov_b32 s99, 0
    s_lshr_b32 s33, s4, 1
    s_and_b32 s34, s4, 1
    s_mul_i32 s35, s5, 37
    s_lshr_b32 s35, s35, 8
    s_mul_i32 s36, s35, 7
    s_sub_u32 s36, s5, s36
    s_lshl_b32 s58, s33, 2
    s_add_u32 s58, s58, s35
    s_mul_i32 s59, s34, 7
    s_add_u32 s59, s59, s36
    s_lshr_b32 s35, s5, 2
    s_and_b32 s36, s5, 3
    s_lshl_b32 s56, s33, 3
    s_add_u32 s56, s56, s35
    s_lshl_b32 s57, s34, 2
    s_add_u32 s57, s57, s36
    s_lshr_b32 s32, s7, 4
    s_and_b32 s33, s7, 15
    s_lshl_b32 s34, s33, 18
    s_lshl_b32 s35, s32, 7
    s_add_u32 s34, s34, s35
    v_lshrrev_b32 v5, 3, v2
    v_and_b32 v6, 7, v2
    v_lshlrev_b32 v6, 4, v6
    v_lshl_add_u32 v7, v5, 11, v6
    v_xor_b32 v8, 2048, v7
    s_lshl_b32 s36, s3, 15
    s_add_u32 s36, s36, s34
    s_add_u32 s37, s36, 16384
    s_lshl_b32 s38, s3, 11
    s_add_u32 m0, s38, 71680
    s_mov_b32 s14, 4194304
    s_mov_b32 s15, 0x00020000
    s_mov_b32 s18, 4194304
    s_mov_b32 s19, 0x00020000
    s_waitcnt lgkmcnt(0)
    s_mov_b32 s12, s66
    s_and_b32 s13, s67, 0xffff
    buffer_load_dwordx4 v8, s[12:15], s36 offen nt lds
    s_mov_b32 s16, s68
    s_and_b32 s17, s69, 0xffff
    s_add_u32 m0, s38, 88064
    s_nop 0
    buffer_load_dwordx4 v7, s[16:19], s36 offen nt lds
    s_add_u32 m0, s38, 72704
    s_nop 0
    buffer_load_dwordx4 v7, s[12:15], s37 offen nt lds
    s_add_u32 m0, s38, 89088
    s_nop 0
    buffer_load_dwordx4 v8, s[16:19], s37 offen nt lds
    s_cmp_lg_u32 s3, 3
    s_cbranch_scc1 L_skip_1
    s_sub_u32 s36, s34, 16384
    v_add_u32 v8, s36, v7
    s_mov_b32 m0, 70656
    s_nop 0
    buffer_load_dwordx4 v8, s[12:15], 0 offen nt lds
L_skip_1:
    s_mov_b32 s8, s94
    s_and_b32 s9, s95, 0xffff
    s_mov_b32 s10, 134217728
    s_mov_b32 s11, 0x00020000
    s_cmp_ge_u32 s3, 4
    s_cbranch_scc1 L_B
L_padstart:
    s_mov_b32 s20, s70
    s_and_b32 s21, s71, 0xffff
    s_mov_b32 s22, 8192
    s_mov_b32 s23, 0x00020000
    s_lshl_b32 s35, s32, 6
    v_lshl_add_u32 v6, v3, 2, s35
    v_lshlrev_b32 v1, 3, v6
    buffer_load_dwordx4 v[64:67], v1, s[20:23], 0 offen
    buffer_load_dwordx4 v[68:71], v1, s[20:23], 0 offen offset:16
    s_mov_b32 s24, s74
    s_and_b32 s25, s75, 0xffff
    s_mov_b32 s26, 2048
    s_mov_b32 s27, 0x00020000
    s_lshl_b32 s37, s7, 2
    s_add_u32 s37, s37, s3
    s_lshl_b32 s37, s37, 1
L_pad_0:
    s_cmp_eq_u32 s99, 1
    s_cbranch_scc1 L_padret_0
    v_mov_b32 v1, s37
    buffer_load_ushort v190, v1, s[24:27], 0 offen
    v_lshrrev_b32 v5, 4, v0
    v_lshlrev_b32 v7, 10, v5
    v_lshl_add_u32 v7, v3, 3, v7
    v_add_u32 v7, 70656, v7
    v_and_b32 v8, 1, v5
    v_lshlrev_b32 v8, 7, v8
    v_add_u32 v12, v7, v8
    v_sub_u32 v13, v7, v8
    v_xor_b32 v8, 128, v8
    v_add_u32 v14, v7, v8
    v_sub_u32 v15, v7, v8
    v_lshlrev_b32 v5, 3, v5
    s_lshl_b32 s36, s33, 7
    v_add_u32 v5, s36, v5
    v_sub_u32 v1, 2040, v5
    v_lshlrev_b32 v1, 1, v1
    v_lshl_add_u32 v1, v6, 12, v1
    s_waitcnt vmcnt(0)
    s_barrier
    ds_read_b64 v[20:21], v13 offset:640
    ds_read_b64 v[22:23], v12 offset:768
    ds_read_b64 v[24:25], v13 offset:896
    ds_read_b64 v[26:27], v14 offset:1024
    ds_read_b64 v[44:45], v12 offset:17408
    ds_read_b64 v[28:29], v15 offset:1152
    ds_read_b64 v[46:47], v13 offset:17536
    ds_read_b64 v[30:31], v14 offset:1280
    ds_read_b64 v[48:49], v12 offset:17664
    v_lshlrev_b32 v72, 16, v64
    v_and_b32 v76, 0xffff0000, v64
    v_lshlrev_b32 v80, 16, v65
    v_and_b32 v84, 0xffff0000, v65
    v_lshlrev_b32 v73, 16, v66
    v_and_b32 v77, 0xffff0000, v66
    v_lshlrev_b32 v81, 16, v67
    v_and_b32 v85, 0xffff0000, v67
    v_lshlrev_b32 v74, 16, v68
    v_and_b32 v78, 0xffff0000, v68
    v_lshlrev_b32 v82, 16, v69
    v_and_b32 v86, 0xffff0000, v69
    v_lshlrev_b32 v75, 16, v70
    v_and_b32 v79, 0xffff0000, v70
    v_lshlrev_b32 v83, 16, v71
    v_and_b32 v87, 0xffff0000, v71
    ds_read_b64 v[32:33], v15 offset:1408
    ds_read_b64 v[50:51], v13 offset:17792
    ds_read_b64 v[34:35], v14 offset:1536
    ds_read_b64 v[52:53], v12 offset:17920
    ds_read_b64 v[36:37], v15 offset:1664
    ds_read_b64 v[54:55], v13 offset:18048
    ds_read_b64 v[38:39], v14 offset:1792
    ds_read_b64 v[56:57], v12 offset:18176
    ds_read_b64 v[40:41], v15 offset:1920
    ds_read_b64 v[58:59], v13 offset:18304
    s_waitcnt lgkmcnt(15)
    v_lshlrev_b32 v88, 16, v20
    v_and_b32 v89, 0xffff0000, v20
    v_lshlrev_b32 v90, 16, v21
    v_and_b32 v91, 0xffff0000, v21
    s_waitcnt lgkmcnt(15)
    v_lshlrev_b32 v92, 16, v22
    v_and_b32 v93, 0xffff0000, v22
    v_lshlrev_b32 v94, 16, v23
    v_and_b32 v95, 0xffff0000, v23
    s_waitcnt lgkmcnt(15)
    v_lshlrev_b32 v96, 16, v24
    v_and_b32 v97, 0xffff0000, v24
    v_lshlrev_b32 v98, 16, v25
    v_and_b32 v99, 0xffff0000, v25
    s_waitcnt lgkmcnt(14)
    v_lshlrev_b32 v100, 16, v26
    v_and_b32 v101, 0xffff0000, v26
    v_lshlrev_b32 v102, 16, v27
    v_and_b32 v103, 0xffff0000, v27
    v_lshlrev_b32 v136, 16, v44
    v_and_b32 v137, 0xffff0000, v44
    v_lshlrev_b32 v138, 16, v45
    v_and_b32 v139, 0xffff0000, v45
    v_pk_mul_f32 v[8:9], v[88:89], v[84:85]
    v_pk_mul_f32 v[10:11], v[90:91], v[86:87]
    v_pk_fma_f32 v[8:9], v[92:93], v[80:81], v[8:9]
    v_pk_fma_f32 v[10:11], v[94:95], v[82:83], v[10:11]
    v_pk_fma_f32 v[8:9], v[96:97], v[76:77], v[8:9]
    v_pk_fma_f32 v[10:11], v[98:99], v[78:79], v[10:11]
    v_pk_fma_f32 v[8:9], v[100:101], v[72:73], v[8:9]
    v_pk_fma_f32 v[10:11], v[102:103], v[74:75], v[10:11]
    v_pk_mul_f32 v[136:137], v[8:9], v[136:137]
    v_pk_mul_f32 v[138:139], v[10:11], v[138:139]
    s_waitcnt lgkmcnt(12)
    v_lshlrev_b32 v104, 16, v28
    v_and_b32 v105, 0xffff0000, v28
    v_lshlrev_b32 v106, 16, v29
    v_and_b32 v107, 0xffff0000, v29
    v_lshlrev_b32 v140, 16, v46
    v_and_b32 v141, 0xffff0000, v46
    v_lshlrev_b32 v142, 16, v47
    v_and_b32 v143, 0xffff0000, v47
    v_pk_mul_f32 v[8:9], v[92:93], v[84:85]
    v_pk_mul_f32 v[10:11], v[94:95], v[86:87]
    v_pk_fma_f32 v[8:9], v[96:97], v[80:81], v[8:9]
    v_pk_fma_f32 v[10:11], v[98:99], v[82:83], v[10:11]
    v_pk_fma_f32 v[8:9], v[100:101], v[76:77], v[8:9]
    v_pk_fma_f32 v[10:11], v[102:103], v[78:79], v[10:11]
    v_pk_fma_f32 v[8:9], v[104:105], v[72:73], v[8:9]
    v_pk_fma_f32 v[10:11], v[106:107], v[74:75], v[10:11]
    v_pk_mul_f32 v[140:141], v[8:9], v[140:141]
    v_pk_mul_f32 v[142:143], v[10:11], v[142:143]
    s_waitcnt lgkmcnt(10)
    v_lshlrev_b32 v108, 16, v30
    v_and_b32 v109, 0xffff0000, v30
    v_lshlrev_b32 v110, 16, v31
    v_and_b32 v111, 0xffff0000, v31
    v_lshlrev_b32 v144, 16, v48
    v_and_b32 v145, 0xffff0000, v48
    v_lshlrev_b32 v146, 16, v49
    v_and_b32 v147, 0xffff0000, v49
    v_pk_mul_f32 v[8:9], v[96:97], v[84:85]
    v_pk_mul_f32 v[10:11], v[98:99], v[86:87]
    v_pk_fma_f32 v[8:9], v[100:101], v[80:81], v[8:9]
    v_pk_fma_f32 v[10:11], v[102:103], v[82:83], v[10:11]
    v_pk_fma_f32 v[8:9], v[104:105], v[76:77], v[8:9]
    v_pk_fma_f32 v[10:11], v[106:107], v[78:79], v[10:11]
    v_pk_fma_f32 v[8:9], v[108:109], v[72:73], v[8:9]
    v_pk_fma_f32 v[10:11], v[110:111], v[74:75], v[10:11]
    v_pk_mul_f32 v[144:145], v[8:9], v[144:145]
    v_pk_mul_f32 v[146:147], v[10:11], v[146:147]
    s_waitcnt lgkmcnt(8)
    v_lshlrev_b32 v112, 16, v32
    v_and_b32 v113, 0xffff0000, v32
    v_lshlrev_b32 v114, 16, v33
    v_and_b32 v115, 0xffff0000, v33
    v_lshlrev_b32 v148, 16, v50
    v_and_b32 v149, 0xffff0000, v50
    v_lshlrev_b32 v150, 16, v51
    v_and_b32 v151, 0xffff0000, v51
    v_pk_mul_f32 v[8:9], v[100:101], v[84:85]
    v_pk_mul_f32 v[10:11], v[102:103], v[86:87]
    v_pk_fma_f32 v[8:9], v[104:105], v[80:81], v[8:9]
    v_pk_fma_f32 v[10:11], v[106:107], v[82:83], v[10:11]
    v_pk_fma_f32 v[8:9], v[108:109], v[76:77], v[8:9]
    v_pk_fma_f32 v[10:11], v[110:111], v[78:79], v[10:11]
    v_pk_fma_f32 v[8:9], v[112:113], v[72:73], v[8:9]
    v_pk_fma_f32 v[10:11], v[114:115], v[74:75], v[10:11]
    v_pk_mul_f32 v[148:149], v[8:9], v[148:149]
    v_pk_mul_f32 v[150:151], v[10:11], v[150:151]
    s_waitcnt lgkmcnt(6)
    v_lshlrev_b32 v116, 16, v34
    v_and_b32 v117, 0xffff0000, v34
    v_lshlrev_b32 v118, 16, v35
    v_and_b32 v119, 0xffff0000, v35
    v_lshlrev_b32 v152, 16, v52
    v_and_b32 v153, 0xffff0000, v52
    v_lshlrev_b32 v154, 16, v53
    v_and_b32 v155, 0xffff0000, v53
    v_pk_mul_f32 v[8:9], v[104:105], v[84:85]
    v_pk_mul_f32 v[10:11], v[106:107], v[86:87]
    v_pk_fma_f32 v[8:9], v[108:109], v[80:81], v[8:9]
    v_pk_fma_f32 v[10:11], v[110:111], v[82:83], v[10:11]
    v_pk_fma_f32 v[8:9], v[112:113], v[76:77], v[8:9]
    v_pk_fma_f32 v[10:11], v[114:115], v[78:79], v[10:11]
    v_pk_fma_f32 v[8:9], v[116:117], v[72:73], v[8:9]
    v_pk_fma_f32 v[10:11], v[118:119], v[74:75], v[10:11]
    v_pk_mul_f32 v[152:153], v[8:9], v[152:153]
    v_pk_mul_f32 v[154:155], v[10:11], v[154:155]
    s_waitcnt lgkmcnt(4)
    v_lshlrev_b32 v120, 16, v36
    v_and_b32 v121, 0xffff0000, v36
    v_lshlrev_b32 v122, 16, v37
    v_and_b32 v123, 0xffff0000, v37
    v_lshlrev_b32 v156, 16, v54
    v_and_b32 v157, 0xffff0000, v54
    v_lshlrev_b32 v158, 16, v55
    v_and_b32 v159, 0xffff0000, v55
    v_pk_mul_f32 v[8:9], v[108:109], v[84:85]
    v_pk_mul_f32 v[10:11], v[110:111], v[86:87]
    v_pk_fma_f32 v[8:9], v[112:113], v[80:81], v[8:9]
    v_pk_fma_f32 v[10:11], v[114:115], v[82:83], v[10:11]
    v_pk_fma_f32 v[8:9], v[116:117], v[76:77], v[8:9]
    v_pk_fma_f32 v[10:11], v[118:119], v[78:79], v[10:11]
    v_pk_fma_f32 v[8:9], v[120:121], v[72:73], v[8:9]
    v_pk_fma_f32 v[10:11], v[122:123], v[74:75], v[10:11]
    v_pk_mul_f32 v[156:157], v[8:9], v[156:157]
    v_pk_mul_f32 v[158:159], v[10:11], v[158:159]
    s_waitcnt lgkmcnt(2)
    v_lshlrev_b32 v124, 16, v38
    v_and_b32 v125, 0xffff0000, v38
    v_lshlrev_b32 v126, 16, v39
    v_and_b32 v127, 0xffff0000, v39
    v_lshlrev_b32 v160, 16, v56
    v_and_b32 v161, 0xffff0000, v56
    v_lshlrev_b32 v162, 16, v57
    v_and_b32 v163, 0xffff0000, v57
    v_pk_mul_f32 v[8:9], v[112:113], v[84:85]
    v_pk_mul_f32 v[10:11], v[114:115], v[86:87]
    v_pk_fma_f32 v[8:9], v[116:117], v[80:81], v[8:9]
    v_pk_fma_f32 v[10:11], v[118:119], v[82:83], v[10:11]
    v_pk_fma_f32 v[8:9], v[120:121], v[76:77], v[8:9]
    v_pk_fma_f32 v[10:11], v[122:123], v[78:79], v[10:11]
    v_pk_fma_f32 v[8:9], v[124:125], v[72:73], v[8:9]
    v_pk_fma_f32 v[10:11], v[126:127], v[74:75], v[10:11]
    v_pk_mul_f32 v[160:161], v[8:9], v[160:161]
    v_pk_mul_f32 v[162:163], v[10:11], v[162:163]
    s_waitcnt lgkmcnt(0)
    v_lshlrev_b32 v128, 16, v40
    v_and_b32 v129, 0xffff0000, v40
    v_lshlrev_b32 v130, 16, v41
    v_and_b32 v131, 0xffff0000, v41
    v_lshlrev_b32 v164, 16, v58
    v_and_b32 v165, 0xffff0000, v58
    v_lshlrev_b32 v166, 16, v59
    v_and_b32 v167, 0xffff0000, v59
    v_pk_mul_f32 v[8:9], v[116:117], v[84:85]
    v_pk_mul_f32 v[10:11], v[118:119], v[86:87]
    v_pk_fma_f32 v[8:9], v[120:121], v[80:81], v[8:9]
    v_pk_fma_f32 v[10:11], v[122:123], v[82:83], v[10:11]
    v_pk_fma_f32 v[8:9], v[124:125], v[76:77], v[8:9]
    v_pk_fma_f32 v[10:11], v[126:127], v[78:79], v[10:11]
    v_pk_fma_f32 v[8:9], v[128:129], v[72:73], v[8:9]
    v_pk_fma_f32 v[10:11], v[130:131], v[74:75], v[10:11]
    v_pk_mul_f32 v[164:165], v[8:9], v[164:165]
    v_pk_mul_f32 v[166:167], v[10:11], v[166:167]
    v_cvt_pk_bf16_f32 v20, v164, v160
    v_cvt_pk_bf16_f32 v21, v156, v152
    v_cvt_pk_bf16_f32 v22, v148, v144
    v_cvt_pk_bf16_f32 v23, v140, v136
    s_mov_b32 s30, 1048576
    buffer_store_dwordx4 v[20:23], v1, s[8:11], s30 offen sc1
    v_cvt_pk_bf16_f32 v24, v165, v161
    v_cvt_pk_bf16_f32 v25, v157, v153
    v_cvt_pk_bf16_f32 v26, v149, v145
    v_cvt_pk_bf16_f32 v27, v141, v137
    s_mov_b32 s30, 1052672
    buffer_store_dwordx4 v[24:27], v1, s[8:11], s30 offen sc1
    v_cvt_pk_bf16_f32 v28, v166, v162
    v_cvt_pk_bf16_f32 v29, v158, v154
    v_cvt_pk_bf16_f32 v30, v150, v146
    v_cvt_pk_bf16_f32 v31, v142, v138
    s_mov_b32 s30, 1056768
    buffer_store_dwordx4 v[28:31], v1, s[8:11], s30 offen sc1
    v_cvt_pk_bf16_f32 v32, v167, v163
    v_cvt_pk_bf16_f32 v33, v159, v155
    v_cvt_pk_bf16_f32 v34, v151, v147
    v_cvt_pk_bf16_f32 v35, v143, v139
    s_mov_b32 s30, 1060864
    buffer_store_dwordx4 v[32:35], v1, s[8:11], s30 offen sc1
    s_mul_i32 s34, s3, 17664
    v_and_b32 v10, 1, v3
    v_xor_b32 v11, 1, v10
    v_mul_u32_u24 v11, 4576, v11
    v_lshrrev_b32 v16, 1, v3
    v_sub_u32 v16, 7, v16
    v_lshlrev_b32 v16, 6, v16
    v_lshl_add_u32 v16, v4, 4, v16
    v_add3_u32 v16, v16, v11, s34
    v_mul_u32_u24 v11, 4220, v10
    v_sub_u32 v11, 13440, v11
    v_lshl_add_u32 v11, v3, 2, v11
    v_lshl_add_u32 v11, v4, 4, v11
    v_add_u32 v17, s34, v11
    v_lshlrev_b32 v10, 2, v4
    v_add_u32 v10, v10, v3
    v_sub_u32 v10, 15, v10
    v_lshlrev_b32 v5, 4, v2
    s_lshl_b32 s35, s7, 2
    s_add_u32 s35, s35, s3
    s_lshl_b32 s35, s35, 12
    s_add_u32 s35, s35, 1048576
    v_mov_b32 v18, s34
    v_mov_b32 v19, 0
    v_cmp_eq_u32 vcc, 0, v10
    s_nop 1
    v_cndmask_b32 v12, 0, v190, vcc
    v_cmp_eq_u32 vcc, 1, v10
    s_nop 1
    v_cndmask_b32 v13, 0, v190, vcc
    v_cmp_eq_u32 vcc, 2, v10
    s_nop 1
    v_cndmask_b32 v14, 0, v190, vcc
    v_cmp_eq_u32 vcc, 3, v10
    s_nop 1
    v_cndmask_b32 v15, 0, v190, vcc
    s_waitcnt vmcnt(0)
    s_barrier
    s_barrier
    s_add_u32 m0, s34, 0
    s_add_u32 s37, s35, 0
    buffer_load_dwordx4 v5, s[8:11], s37 offen sc1 lds
    s_add_u32 m0, s34, 1024
    s_add_u32 s37, s35, 1024
    buffer_load_dwordx4 v5, s[8:11], s37 offen sc1 lds
    s_add_u32 m0, s34, 2048
    s_add_u32 s37, s35, 2048
    buffer_load_dwordx4 v5, s[8:11], s37 offen sc1 lds
    s_add_u32 m0, s34, 3072
    s_add_u32 s37, s35, 3072
    buffer_load_dwordx4 v5, s[8:11], s37 offen sc1 lds
    v_add_u32 v18, s34, v5
    s_waitcnt vmcnt(3)
    ds_read_b128 v[24:27], v18 offset:0
    s_waitcnt vmcnt(2)
    ds_read_b128 v[32:35], v18 offset:1024
    s_waitcnt vmcnt(1)
    ds_read_b128 v[40:43], v18 offset:2048
    s_waitcnt vmcnt(0)
    ds_read_b128 v[48:51], v18 offset:3072
    ds_read_b32 v28, v18 offset:16
    ds_read_b32 v36, v18 offset:1040
    ds_read_b32 v44, v18 offset:2064
    ds_read_b32 v52, v18 offset:3088
    s_waitcnt lgkmcnt(3)
    v_alignbit_b32 v24, v25, v24, 16
    v_alignbit_b32 v25, v26, v25, 16
    v_alignbit_b32 v26, v27, v26, 16
    v_alignbit_b32 v27, v28, v27, 16
    ds_write_b128 v18, v[24:27] offset:4576
    s_waitcnt lgkmcnt(3)
    v_alignbit_b32 v32, v33, v32, 16
    v_alignbit_b32 v33, v34, v33, 16
    v_alignbit_b32 v34, v35, v34, 16
    v_alignbit_b32 v35, v36, v35, 16
    ds_write_b128 v18, v[32:35] offset:5600
    s_waitcnt lgkmcnt(3)
    v_alignbit_b32 v40, v41, v40, 16
    v_alignbit_b32 v41, v42, v41, 16
    v_alignbit_b32 v42, v43, v42, 16
    v_alignbit_b32 v43, v44, v43, 16
    ds_write_b128 v18, v[40:43] offset:6624
    s_waitcnt lgkmcnt(3)
    v_alignbit_b32 v48, v49, v48, 16
    v_alignbit_b32 v49, v50, v49, 16
    v_alignbit_b32 v50, v51, v50, 16
    v_alignbit_b32 v51, v52, v51, 16
    ds_write_b128 v18, v[48:51] offset:7648
    s_mul_i32 s37, s3, 17792
    v_lshlrev_b32 v10, 2, v3
    v_lshl_add_u32 v10, v4, 7, v10
    v_add_u32 v10, s37, v10
    v_bfe_u32 v11, v2, 1, 2
    v_lshrrev_b32 v18, 3, v2
    v_and_b32 v20, 1, v2
    v_mul_u32_u24 v19, 17792, v11
    v_lshl_add_u32 v19, v18, 5, v19
    v_lshl_add_u32 v19, v20, 4, v19
    s_lshl_b32 s38, s3, 10
    v_add_u32 v19, s38, v19
    s_lshl_b32 s38, s7, 7
    v_and_b32 v11, 7, v2
    v_lshl_add_u32 v11, v11, 4, s38
    v_lshl_add_u32 v11, v18, 15, v11
    s_lshl_b32 s38, s3, 20
    s_add_u32 s38, s38, 9437184
    s_barrier
    ds_read_b128 v[56:59], v16 offset:3584
    ds_read_b128 v[60:63], v16 offset:3072
    ds_read_b128 v[64:67], v16 offset:2560
    ds_read_b128 v[68:71], v16 offset:2048
    ds_read_b128 v[72:75], v16 offset:1536
    ds_read_b128 v[76:79], v16 offset:1024
    ds_read_b128 v[80:83], v16 offset:512
    ds_read_b128 v[84:87], v16 offset:0
    ds_read_b64 v[88:89], v17 offset:0
    ds_read_b64 v[90:91], v17 offset:8
    ds_read_b64 v[92:93], v17 offset:512
    ds_read_b64 v[94:95], v17 offset:520
    ds_read_b64 v[96:97], v17 offset:1024
    ds_read_b64 v[98:99], v17 offset:1032
    ds_read_b64 v[100:101], v17 offset:1536
    ds_read_b64 v[102:103], v17 offset:1544
    ds_read_b64 v[104:105], v17 offset:2048
    ds_read_b64 v[106:107], v17 offset:2056
    ds_read_b64 v[108:109], v17 offset:2560
    ds_read_b64 v[110:111], v17 offset:2568
    ds_read_b64 v[112:113], v17 offset:3072
    ds_read_b64 v[114:115], v17 offset:3080
    ds_read_b64 v[116:117], v17 offset:3584
    ds_read_b64 v[118:119], v17 offset:3592
    s_waitcnt lgkmcnt(0)
    v_mfma_f32_16x16x32_bf16 v[52:55], v[56:59], v[116:119], 0
    v_mfma_f32_16x16x32_bf16 v[48:51], v[56:59], v[112:115], 0
    v_mfma_f32_16x16x32_bf16 v[44:47], v[56:59], v[108:111], 0
    v_mfma_f32_16x16x32_bf16 v[40:43], v[56:59], v[104:107], 0
    v_mfma_f32_16x16x32_bf16 v[36:39], v[56:59], v[100:103], 0
    v_mfma_f32_16x16x32_bf16 v[32:35], v[56:59], v[96:99], 0
    v_mfma_f32_16x16x32_bf16 v[28:31], v[56:59], v[92:95], 0
    v_mfma_f32_16x16x32_bf16 v[24:27], v[56:59], v[12:15], 0
    v_mfma_f32_16x16x32_bf16 v[24:27], v[56:59], v[88:91], v[24:27]
    s_waitcnt lgkmcnt(0)
    v_mfma_f32_16x16x32_bf16 v[28:31], v[60:63], v[12:15], v[28:31]
    v_mfma_f32_16x16x32_bf16 v[28:31], v[60:63], v[88:91], v[28:31]
    v_mfma_f32_16x16x32_bf16 v[32:35], v[60:63], v[92:95], v[32:35]
    v_mfma_f32_16x16x32_bf16 v[36:39], v[60:63], v[96:99], v[36:39]
    v_mfma_f32_16x16x32_bf16 v[40:43], v[60:63], v[100:103], v[40:43]
    v_mfma_f32_16x16x32_bf16 v[44:47], v[60:63], v[104:107], v[44:47]
    v_mfma_f32_16x16x32_bf16 v[48:51], v[60:63], v[108:111], v[48:51]
    v_mfma_f32_16x16x32_bf16 v[52:55], v[60:63], v[112:115], v[52:55]
    s_waitcnt lgkmcnt(0)
    v_mfma_f32_16x16x32_bf16 v[52:55], v[64:67], v[108:111], v[52:55]
    v_mfma_f32_16x16x32_bf16 v[48:51], v[64:67], v[104:107], v[48:51]
    v_mfma_f32_16x16x32_bf16 v[44:47], v[64:67], v[100:103], v[44:47]
    v_mfma_f32_16x16x32_bf16 v[40:43], v[64:67], v[96:99], v[40:43]
    v_mfma_f32_16x16x32_bf16 v[36:39], v[64:67], v[92:95], v[36:39]
    v_mfma_f32_16x16x32_bf16 v[32:35], v[64:67], v[12:15], v[32:35]
    v_mfma_f32_16x16x32_bf16 v[32:35], v[64:67], v[88:91], v[32:35]
    s_waitcnt lgkmcnt(0)
    v_mfma_f32_16x16x32_bf16 v[36:39], v[68:71], v[12:15], v[36:39]
    v_mfma_f32_16x16x32_bf16 v[36:39], v[68:71], v[88:91], v[36:39]
    v_mfma_f32_16x16x32_bf16 v[40:43], v[68:71], v[92:95], v[40:43]
    v_mfma_f32_16x16x32_bf16 v[44:47], v[68:71], v[96:99], v[44:47]
    v_mfma_f32_16x16x32_bf16 v[48:51], v[68:71], v[100:103], v[48:51]
    v_mfma_f32_16x16x32_bf16 v[52:55], v[68:71], v[104:107], v[52:55]
    s_waitcnt lgkmcnt(0)
    v_mfma_f32_16x16x32_bf16 v[52:55], v[72:75], v[100:103], v[52:55]
    v_mfma_f32_16x16x32_bf16 v[48:51], v[72:75], v[96:99], v[48:51]
    v_mfma_f32_16x16x32_bf16 v[44:47], v[72:75], v[92:95], v[44:47]
    v_mfma_f32_16x16x32_bf16 v[40:43], v[72:75], v[12:15], v[40:43]
    v_mfma_f32_16x16x32_bf16 v[40:43], v[72:75], v[88:91], v[40:43]
    s_waitcnt lgkmcnt(0)
    v_mfma_f32_16x16x32_bf16 v[44:47], v[76:79], v[12:15], v[44:47]
    v_mfma_f32_16x16x32_bf16 v[44:47], v[76:79], v[88:91], v[44:47]
    v_mfma_f32_16x16x32_bf16 v[48:51], v[76:79], v[92:95], v[48:51]
    v_mfma_f32_16x16x32_bf16 v[52:55], v[76:79], v[96:99], v[52:55]
    s_waitcnt lgkmcnt(0)
    v_mfma_f32_16x16x32_bf16 v[52:55], v[80:83], v[92:95], v[52:55]
    v_mfma_f32_16x16x32_bf16 v[48:51], v[80:83], v[12:15], v[48:51]
    v_mfma_f32_16x16x32_bf16 v[48:51], v[80:83], v[88:91], v[48:51]
    s_waitcnt lgkmcnt(0)
    v_mfma_f32_16x16x32_bf16 v[52:55], v[84:87], v[12:15], v[52:55]
    v_mfma_f32_16x16x32_bf16 v[52:55], v[84:87], v[88:91], v[52:55]
    ds_read_b128 v[56:59], v16 offset:3648
    ds_read_b128 v[60:63], v16 offset:3136
    ds_read_b128 v[64:67], v16 offset:2624
    ds_read_b128 v[68:71], v16 offset:2112
    ds_read_b128 v[72:75], v16 offset:1600
    ds_read_b128 v[76:79], v16 offset:1088
    ds_read_b128 v[80:83], v16 offset:576
    ds_read_b128 v[84:87], v16 offset:64
    ds_read_b64 v[120:121], v17 offset:64
    ds_read_b64 v[122:123], v17 offset:72
    ds_read_b64 v[124:125], v17 offset:576
    ds_read_b64 v[126:127], v17 offset:584
    ds_read_b64 v[128:129], v17 offset:1088
    ds_read_b64 v[130:131], v17 offset:1096
    ds_read_b64 v[132:133], v17 offset:1600
    ds_read_b64 v[134:135], v17 offset:1608
    ds_read_b64 v[136:137], v17 offset:2112
    ds_read_b64 v[138:139], v17 offset:2120
    ds_read_b64 v[140:141], v17 offset:2624
    ds_read_b64 v[142:143], v17 offset:2632
    ds_read_b64 v[144:145], v17 offset:3136
    ds_read_b64 v[146:147], v17 offset:3144
    ds_read_b64 v[148:149], v17 offset:3648
    ds_read_b64 v[150:151], v17 offset:3656
    s_waitcnt lgkmcnt(0)
    v_mfma_f32_16x16x32_bf16 v[52:55], v[56:59], v[148:151], v[52:55]
    v_mfma_f32_16x16x32_bf16 v[48:51], v[56:59], v[144:147], v[48:51]
    v_mfma_f32_16x16x32_bf16 v[44:47], v[56:59], v[140:143], v[44:47]
    v_mfma_f32_16x16x32_bf16 v[40:43], v[56:59], v[136:139], v[40:43]
    v_mfma_f32_16x16x32_bf16 v[36:39], v[56:59], v[132:135], v[36:39]
    v_mfma_f32_16x16x32_bf16 v[32:35], v[56:59], v[128:131], v[32:35]
    v_mfma_f32_16x16x32_bf16 v[28:31], v[56:59], v[124:127], v[28:31]
    v_mfma_f32_16x16x32_bf16 v[24:27], v[56:59], v[120:123], v[24:27]
    s_waitcnt lgkmcnt(0)
    v_mfma_f32_16x16x32_bf16 v[28:31], v[60:63], v[120:123], v[28:31]
    v_mfma_f32_16x16x32_bf16 v[32:35], v[60:63], v[124:127], v[32:35]
    v_mfma_f32_16x16x32_bf16 v[36:39], v[60:63], v[128:131], v[36:39]
    v_mfma_f32_16x16x32_bf16 v[40:43], v[60:63], v[132:135], v[40:43]
    v_mfma_f32_16x16x32_bf16 v[44:47], v[60:63], v[136:139], v[44:47]
    v_mfma_f32_16x16x32_bf16 v[48:51], v[60:63], v[140:143], v[48:51]
    v_mfma_f32_16x16x32_bf16 v[52:55], v[60:63], v[144:147], v[52:55]
    s_waitcnt lgkmcnt(0)
    v_mfma_f32_16x16x32_bf16 v[52:55], v[64:67], v[140:143], v[52:55]
    v_mfma_f32_16x16x32_bf16 v[48:51], v[64:67], v[136:139], v[48:51]
    v_mfma_f32_16x16x32_bf16 v[44:47], v[64:67], v[132:135], v[44:47]
    v_mfma_f32_16x16x32_bf16 v[40:43], v[64:67], v[128:131], v[40:43]
    v_mfma_f32_16x16x32_bf16 v[36:39], v[64:67], v[124:127], v[36:39]
    v_mfma_f32_16x16x32_bf16 v[32:35], v[64:67], v[120:123], v[32:35]
    s_waitcnt lgkmcnt(0)
    v_mfma_f32_16x16x32_bf16 v[36:39], v[68:71], v[120:123], v[36:39]
    v_mfma_f32_16x16x32_bf16 v[40:43], v[68:71], v[124:127], v[40:43]
    v_mfma_f32_16x16x32_bf16 v[44:47], v[68:71], v[128:131], v[44:47]
    v_mfma_f32_16x16x32_bf16 v[48:51], v[68:71], v[132:135], v[48:51]
    v_mfma_f32_16x16x32_bf16 v[52:55], v[68:71], v[136:139], v[52:55]
    s_waitcnt lgkmcnt(0)
    v_mfma_f32_16x16x32_bf16 v[52:55], v[72:75], v[132:135], v[52:55]
    v_mfma_f32_16x16x32_bf16 v[48:51], v[72:75], v[128:131], v[48:51]
    v_mfma_f32_16x16x32_bf16 v[44:47], v[72:75], v[124:127], v[44:47]
    v_mfma_f32_16x16x32_bf16 v[40:43], v[72:75], v[120:123], v[40:43]
    s_waitcnt lgkmcnt(0)
    v_mfma_f32_16x16x32_bf16 v[44:47], v[76:79], v[120:123], v[44:47]
    v_mfma_f32_16x16x32_bf16 v[48:51], v[76:79], v[124:127], v[48:51]
    v_mfma_f32_16x16x32_bf16 v[52:55], v[76:79], v[128:131], v[52:55]
    s_waitcnt lgkmcnt(0)
    v_mfma_f32_16x16x32_bf16 v[52:55], v[80:83], v[124:127], v[52:55]
    v_mfma_f32_16x16x32_bf16 v[48:51], v[80:83], v[120:123], v[48:51]
    s_waitcnt lgkmcnt(0)
    v_mfma_f32_16x16x32_bf16 v[52:55], v[84:87], v[120:123], v[52:55]
    ds_read_b128 v[56:59], v16 offset:3712
    ds_read_b128 v[60:63], v16 offset:3200
    ds_read_b128 v[64:67], v16 offset:2688
    ds_read_b128 v[68:71], v16 offset:2176
    ds_read_b128 v[72:75], v16 offset:1664
    ds_read_b128 v[76:79], v16 offset:1152
    ds_read_b128 v[80:83], v16 offset:640
    ds_read_b128 v[84:87], v16 offset:128
    ds_read_b64 v[88:89], v17 offset:128
    ds_read_b64 v[90:91], v17 offset:136
    ds_read_b64 v[92:93], v17 offset:640
    ds_read_b64 v[94:95], v17 offset:648
    ds_read_b64 v[96:97], v17 offset:1152
    ds_read_b64 v[98:99], v17 offset:1160
    ds_read_b64 v[100:101], v17 offset:1664
    ds_read_b64 v[102:103], v17 offset:1672
    ds_read_b64 v[104:105], v17 offset:2176
    ds_read_b64 v[106:107], v17 offset:2184
    ds_read_b64 v[108:109], v17 offset:2688
    ds_read_b64 v[110:111], v17 offset:2696
    ds_read_b64 v[112:113], v17 offset:3200
    ds_read_b64 v[114:115], v17 offset:3208
    ds_read_b64 v[116:117], v17 offset:3712
    ds_read_b64 v[118:119], v17 offset:3720
    s_waitcnt lgkmcnt(0)
    v_mfma_f32_16x16x32_bf16 v[52:55], v[56:59], v[116:119], v[52:55]
    v_mfma_f32_16x16x32_bf16 v[48:51], v[56:59], v[112:115], v[48:51]
    v_mfma_f32_16x16x32_bf16 v[44:47], v[56:59], v[108:111], v[44:47]
    v_mfma_f32_16x16x32_bf16 v[40:43], v[56:59], v[104:107], v[40:43]
    v_mfma_f32_16x16x32_bf16 v[36:39], v[56:59], v[100:103], v[36:39]
    v_mfma_f32_16x16x32_bf16 v[32:35], v[56:59], v[96:99], v[32:35]
    v_mfma_f32_16x16x32_bf16 v[28:31], v[56:59], v[92:95], v[28:31]
    v_mfma_f32_16x16x32_bf16 v[24:27], v[56:59], v[88:91], v[24:27]
    s_waitcnt lgkmcnt(0)
    v_mfma_f32_16x16x32_bf16 v[28:31], v[60:63], v[88:91], v[28:31]
    v_mfma_f32_16x16x32_bf16 v[32:35], v[60:63], v[92:95], v[32:35]
    v_mfma_f32_16x16x32_bf16 v[36:39], v[60:63], v[96:99], v[36:39]
    v_mfma_f32_16x16x32_bf16 v[40:43], v[60:63], v[100:103], v[40:43]
    v_mfma_f32_16x16x32_bf16 v[44:47], v[60:63], v[104:107], v[44:47]
    v_mfma_f32_16x16x32_bf16 v[48:51], v[60:63], v[108:111], v[48:51]
    v_mfma_f32_16x16x32_bf16 v[52:55], v[60:63], v[112:115], v[52:55]
    s_waitcnt lgkmcnt(0)
    v_mfma_f32_16x16x32_bf16 v[52:55], v[64:67], v[108:111], v[52:55]
    v_mfma_f32_16x16x32_bf16 v[48:51], v[64:67], v[104:107], v[48:51]
    v_mfma_f32_16x16x32_bf16 v[44:47], v[64:67], v[100:103], v[44:47]
    v_mfma_f32_16x16x32_bf16 v[40:43], v[64:67], v[96:99], v[40:43]
    v_mfma_f32_16x16x32_bf16 v[36:39], v[64:67], v[92:95], v[36:39]
    v_mfma_f32_16x16x32_bf16 v[32:35], v[64:67], v[88:91], v[32:35]
    s_waitcnt lgkmcnt(0)
    v_mfma_f32_16x16x32_bf16 v[36:39], v[68:71], v[88:91], v[36:39]
    v_mfma_f32_16x16x32_bf16 v[40:43], v[68:71], v[92:95], v[40:43]
    v_mfma_f32_16x16x32_bf16 v[44:47], v[68:71], v[96:99], v[44:47]
    v_mfma_f32_16x16x32_bf16 v[48:51], v[68:71], v[100:103], v[48:51]
    v_mfma_f32_16x16x32_bf16 v[52:55], v[68:71], v[104:107], v[52:55]
    s_waitcnt lgkmcnt(0)
    v_mfma_f32_16x16x32_bf16 v[52:55], v[72:75], v[100:103], v[52:55]
    v_mfma_f32_16x16x32_bf16 v[48:51], v[72:75], v[96:99], v[48:51]
    v_mfma_f32_16x16x32_bf16 v[44:47], v[72:75], v[92:95], v[44:47]
    v_mfma_f32_16x16x32_bf16 v[40:43], v[72:75], v[88:91], v[40:43]
    s_waitcnt lgkmcnt(0)
    v_mfma_f32_16x16x32_bf16 v[44:47], v[76:79], v[88:91], v[44:47]
    v_mfma_f32_16x16x32_bf16 v[48:51], v[76:79], v[92:95], v[48:51]
    v_mfma_f32_16x16x32_bf16 v[52:55], v[76:79], v[96:99], v[52:55]
    s_waitcnt lgkmcnt(0)
    v_mfma_f32_16x16x32_bf16 v[52:55], v[80:83], v[92:95], v[52:55]
    v_mfma_f32_16x16x32_bf16 v[48:51], v[80:83], v[88:91], v[48:51]
    s_waitcnt lgkmcnt(0)
    v_mfma_f32_16x16x32_bf16 v[52:55], v[84:87], v[88:91], v[52:55]
    ds_read_b128 v[56:59], v16 offset:3776
    ds_read_b128 v[60:63], v16 offset:3264
    ds_read_b128 v[64:67], v16 offset:2752
    ds_read_b128 v[68:71], v16 offset:2240
    ds_read_b128 v[72:75], v16 offset:1728
    ds_read_b128 v[76:79], v16 offset:1216
    ds_read_b128 v[80:83], v16 offset:704
    ds_read_b128 v[84:87], v16 offset:192
    ds_read_b64 v[120:121], v17 offset:192
    ds_read_b64 v[122:123], v17 offset:200
    ds_read_b64 v[124:125], v17 offset:704
    ds_read_b64 v[126:127], v17 offset:712
    ds_read_b64 v[128:129], v17 offset:1216
    ds_read_b64 v[130:131], v17 offset:1224
    ds_read_b64 v[132:133], v17 offset:1728
    ds_read_b64 v[134:135], v17 offset:1736
    ds_read_b64 v[136:137], v17 offset:2240
    ds_read_b64 v[138:139], v17 offset:2248
    ds_read_b64 v[140:141], v17 offset:2752
    ds_read_b64 v[142:143], v17 offset:2760
    ds_read_b64 v[144:145], v17 offset:3264
    ds_read_b64 v[146:147], v17 offset:3272
    ds_read_b64 v[148:149], v17 offset:3776
    ds_read_b64 v[150:151], v17 offset:3784
    s_waitcnt lgkmcnt(0)
L_pad_1:
    s_cmp_eq_u32 s99, 1
    s_cbranch_scc1 L_padret_1
    v_mfma_f32_16x16x32_bf16 v[52:55], v[56:59], v[148:151], v[52:55]
    v_mfma_f32_16x16x32_bf16 v[48:51], v[56:59], v[144:147], v[48:51]
    v_mfma_f32_16x16x32_bf16 v[44:47], v[56:59], v[140:143], v[44:47]
    v_mfma_f32_16x16x32_bf16 v[40:43], v[56:59], v[136:139], v[40:43]
    v_mfma_f32_16x16x32_bf16 v[36:39], v[56:59], v[132:135], v[36:39]
    v_mfma_f32_16x16x32_bf16 v[32:35], v[56:59], v[128:131], v[32:35]
    v_mfma_f32_16x16x32_bf16 v[28:31], v[56:59], v[124:127], v[28:31]
    v_mfma_f32_16x16x32_bf16 v[24:27], v[56:59], v[120:123], v[24:27]
    s_waitcnt lgkmcnt(0)
    v_mfma_f32_16x16x32_bf16 v[28:31], v[60:63], v[120:123], v[28:31]
    v_mfma_f32_16x16x32_bf16 v[32:35], v[60:63], v[124:127], v[32:35]
    v_mfma_f32_16x16x32_bf16 v[36:39], v[60:63], v[128:131], v[36:39]
    v_mfma_f32_16x16x32_bf16 v[40:43], v[60:63], v[132:135], v[40:43]
    v_mfma_f32_16x16x32_bf16 v[44:47], v[60:63], v[136:139], v[44:47]
    v_mfma_f32_16x16x32_bf16 v[48:51], v[60:63], v[140:143], v[48:51]
    v_mfma_f32_16x16x32_bf16 v[52:55], v[60:63], v[144:147], v[52:55]
    s_waitcnt lgkmcnt(0)
    v_mfma_f32_16x16x32_bf16 v[52:55], v[64:67], v[140:143], v[52:55]
    v_mfma_f32_16x16x32_bf16 v[48:51], v[64:67], v[136:139], v[48:51]
    v_mfma_f32_16x16x32_bf16 v[44:47], v[64:67], v[132:135], v[44:47]
    v_mfma_f32_16x16x32_bf16 v[40:43], v[64:67], v[128:131], v[40:43]
    v_mfma_f32_16x16x32_bf16 v[36:39], v[64:67], v[124:127], v[36:39]
    v_mfma_f32_16x16x32_bf16 v[32:35], v[64:67], v[120:123], v[32:35]
    s_waitcnt lgkmcnt(0)
    v_mfma_f32_16x16x32_bf16 v[36:39], v[68:71], v[120:123], v[36:39]
    v_mfma_f32_16x16x32_bf16 v[40:43], v[68:71], v[124:127], v[40:43]
    v_mfma_f32_16x16x32_bf16 v[44:47], v[68:71], v[128:131], v[44:47]
    v_mfma_f32_16x16x32_bf16 v[48:51], v[68:71], v[132:135], v[48:51]
    v_mfma_f32_16x16x32_bf16 v[52:55], v[68:71], v[136:139], v[52:55]
    s_waitcnt lgkmcnt(0)
    v_mfma_f32_16x16x32_bf16 v[52:55], v[72:75], v[132:135], v[52:55]
    v_mfma_f32_16x16x32_bf16 v[48:51], v[72:75], v[128:131], v[48:51]
    v_mfma_f32_16x16x32_bf16 v[44:47], v[72:75], v[124:127], v[44:47]
    v_mfma_f32_16x16x32_bf16 v[40:43], v[72:75], v[120:123], v[40:43]
    s_waitcnt lgkmcnt(0)
    v_mfma_f32_16x16x32_bf16 v[44:47], v[76:79], v[120:123], v[44:47]
    v_mfma_f32_16x16x32_bf16 v[48:51], v[76:79], v[124:127], v[48:51]
    v_mfma_f32_16x16x32_bf16 v[52:55], v[76:79], v[128:131], v[52:55]
    s_waitcnt lgkmcnt(0)
    v_mfma_f32_16x16x32_bf16 v[52:55], v[80:83], v[124:127], v[52:55]
    v_mfma_f32_16x16x32_bf16 v[48:51], v[80:83], v[120:123], v[48:51]
    s_waitcnt lgkmcnt(0)
    v_mfma_f32_16x16x32_bf16 v[52:55], v[84:87], v[120:123], v[52:55]
    ds_read_b128 v[56:59], v16 offset:3840
    ds_read_b128 v[60:63], v16 offset:3328
    ds_read_b128 v[64:67], v16 offset:2816
    ds_read_b128 v[68:71], v16 offset:2304
    ds_read_b128 v[72:75], v16 offset:1792
    ds_read_b128 v[76:79], v16 offset:1280
    ds_read_b128 v[80:83], v16 offset:768
    ds_read_b128 v[84:87], v16 offset:256
    ds_read_b64 v[88:89], v17 offset:256
    ds_read_b64 v[90:91], v17 offset:264
    ds_read_b64 v[92:93], v17 offset:768
    ds_read_b64 v[94:95], v17 offset:776
    ds_read_b64 v[96:97], v17 offset:1280
    ds_read_b64 v[98:99], v17 offset:1288
    ds_read_b64 v[100:101], v17 offset:1792
    ds_read_b64 v[102:103], v17 offset:1800
    ds_read_b64 v[104:105], v17 offset:2304
    ds_read_b64 v[106:107], v17 offset:2312
    ds_read_b64 v[108:109], v17 offset:2816
    ds_read_b64 v[110:111], v17 offset:2824
    ds_read_b64 v[112:113], v17 offset:3328
    ds_read_b64 v[114:115], v17 offset:3336
    ds_read_b64 v[116:117], v17 offset:3840
    ds_read_b64 v[118:119], v17 offset:3848
    s_waitcnt lgkmcnt(0)
    v_mfma_f32_16x16x32_bf16 v[52:55], v[56:59], v[116:119], v[52:55]
    v_mfma_f32_16x16x32_bf16 v[48:51], v[56:59], v[112:115], v[48:51]
    v_mfma_f32_16x16x32_bf16 v[44:47], v[56:59], v[108:111], v[44:47]
    v_mfma_f32_16x16x32_bf16 v[40:43], v[56:59], v[104:107], v[40:43]
    v_mfma_f32_16x16x32_bf16 v[36:39], v[56:59], v[100:103], v[36:39]
    v_mfma_f32_16x16x32_bf16 v[32:35], v[56:59], v[96:99], v[32:35]
    v_mfma_f32_16x16x32_bf16 v[28:31], v[56:59], v[92:95], v[28:31]
    v_mfma_f32_16x16x32_bf16 v[24:27], v[56:59], v[88:91], v[24:27]
    s_waitcnt lgkmcnt(0)
    v_mfma_f32_16x16x32_bf16 v[28:31], v[60:63], v[88:91], v[28:31]
    v_mfma_f32_16x16x32_bf16 v[32:35], v[60:63], v[92:95], v[32:35]
    v_mfma_f32_16x16x32_bf16 v[36:39], v[60:63], v[96:99], v[36:39]
    v_mfma_f32_16x16x32_bf16 v[40:43], v[60:63], v[100:103], v[40:43]
    v_mfma_f32_16x16x32_bf16 v[44:47], v[60:63], v[104:107], v[44:47]
    v_mfma_f32_16x16x32_bf16 v[48:51], v[60:63], v[108:111], v[48:51]
    v_mfma_f32_16x16x32_bf16 v[52:55], v[60:63], v[112:115], v[52:55]
    s_waitcnt lgkmcnt(0)
    v_mfma_f32_16x16x32_bf16 v[52:55], v[64:67], v[108:111], v[52:55]
    v_mfma_f32_16x16x32_bf16 v[48:51], v[64:67], v[104:107], v[48:51]
    v_mfma_f32_16x16x32_bf16 v[44:47], v[64:67], v[100:103], v[44:47]
    v_mfma_f32_16x16x32_bf16 v[40:43], v[64:67], v[96:99], v[40:43]
    v_mfma_f32_16x16x32_bf16 v[36:39], v[64:67], v[92:95], v[36:39]
    v_mfma_f32_16x16x32_bf16 v[32:35], v[64:67], v[88:91], v[32:35]
    s_waitcnt lgkmcnt(0)
    v_mfma_f32_16x16x32_bf16 v[36:39], v[68:71], v[88:91], v[36:39]
    v_mfma_f32_16x16x32_bf16 v[40:43], v[68:71], v[92:95], v[40:43]
    v_mfma_f32_16x16x32_bf16 v[44:47], v[68:71], v[96:99], v[44:47]
    v_mfma_f32_16x16x32_bf16 v[48:51], v[68:71], v[100:103], v[48:51]
    v_mfma_f32_16x16x32_bf16 v[52:55], v[68:71], v[104:107], v[52:55]
    s_waitcnt lgkmcnt(0)
    v_mfma_f32_16x16x32_bf16 v[52:55], v[72:75], v[100:103], v[52:55]
    v_mfma_f32_16x16x32_bf16 v[48:51], v[72:75], v[96:99], v[48:51]
    v_mfma_f32_16x16x32_bf16 v[44:47], v[72:75], v[92:95], v[44:47]
    v_mfma_f32_16x16x32_bf16 v[40:43], v[72:75], v[88:91], v[40:43]
    s_waitcnt lgkmcnt(0)
    v_mfma_f32_16x16x32_bf16 v[44:47], v[76:79], v[88:91], v[44:47]
    v_mfma_f32_16x16x32_bf16 v[48:51], v[76:79], v[92:95], v[48:51]
    v_mfma_f32_16x16x32_bf16 v[52:55], v[76:79], v[96:99], v[52:55]
    s_waitcnt lgkmcnt(0)
    v_mfma_f32_16x16x32_bf16 v[52:55], v[80:83], v[92:95], v[52:55]
    v_mfma_f32_16x16x32_bf16 v[48:51], v[80:83], v[88:91], v[48:51]
    s_waitcnt lgkmcnt(0)
    v_mfma_f32_16x16x32_bf16 v[52:55], v[84:87], v[88:91], v[52:55]
    ds_read_b128 v[56:59], v16 offset:3904
    ds_read_b128 v[60:63], v16 offset:3392
    ds_read_b128 v[64:67], v16 offset:2880
    ds_read_b128 v[68:71], v16 offset:2368
    ds_read_b128 v[72:75], v16 offset:1856
    ds_read_b128 v[76:79], v16 offset:1344
    ds_read_b128 v[80:83], v16 offset:832
    ds_read_b128 v[84:87], v16 offset:320
    ds_read_b64 v[120:121], v17 offset:320
    ds_read_b64 v[122:123], v17 offset:328
    ds_read_b64 v[124:125], v17 offset:832
    ds_read_b64 v[126:127], v17 offset:840
    ds_read_b64 v[128:129], v17 offset:1344
    ds_read_b64 v[130:131], v17 offset:1352
    ds_read_b64 v[132:133], v17 offset:1856
    ds_read_b64 v[134:135], v17 offset:1864
    ds_read_b64 v[136:137], v17 offset:2368
    ds_read_b64 v[138:139], v17 offset:2376
    ds_read_b64 v[140:141], v17 offset:2880
    ds_read_b64 v[142:143], v17 offset:2888
    ds_read_b64 v[144:145], v17 offset:3392
    ds_read_b64 v[146:147], v17 offset:3400
    ds_read_b64 v[148:149], v17 offset:3904
    ds_read_b64 v[150:151], v17 offset:3912
    s_waitcnt lgkmcnt(0)
    v_mfma_f32_16x16x32_bf16 v[52:55], v[56:59], v[148:151], v[52:55]
    v_mfma_f32_16x16x32_bf16 v[48:51], v[56:59], v[144:147], v[48:51]
    v_mfma_f32_16x16x32_bf16 v[44:47], v[56:59], v[140:143], v[44:47]
    v_mfma_f32_16x16x32_bf16 v[40:43], v[56:59], v[136:139], v[40:43]
    v_mfma_f32_16x16x32_bf16 v[36:39], v[56:59], v[132:135], v[36:39]
    v_mfma_f32_16x16x32_bf16 v[32:35], v[56:59], v[128:131], v[32:35]
    v_mfma_f32_16x16x32_bf16 v[28:31], v[56:59], v[124:127], v[28:31]
    v_mfma_f32_16x16x32_bf16 v[24:27], v[56:59], v[120:123], v[24:27]
    s_waitcnt lgkmcnt(0)
    v_mfma_f32_16x16x32_bf16 v[28:31], v[60:63], v[120:123], v[28:31]
    v_mfma_f32_16x16x32_bf16 v[32:35], v[60:63], v[124:127], v[32:35]
    v_mfma_f32_16x16x32_bf16 v[36:39], v[60:63], v[128:131], v[36:39]
    v_mfma_f32_16x16x32_bf16 v[40:43], v[60:63], v[132:135], v[40:43]
    v_mfma_f32_16x16x32_bf16 v[44:47], v[60:63], v[136:139], v[44:47]
    v_mfma_f32_16x16x32_bf16 v[48:51], v[60:63], v[140:143], v[48:51]
    v_mfma_f32_16x16x32_bf16 v[52:55], v[60:63], v[144:147], v[52:55]
    s_waitcnt lgkmcnt(0)
    v_mfma_f32_16x16x32_bf16 v[52:55], v[64:67], v[140:143], v[52:55]
    v_mfma_f32_16x16x32_bf16 v[48:51], v[64:67], v[136:139], v[48:51]
    v_mfma_f32_16x16x32_bf16 v[44:47], v[64:67], v[132:135], v[44:47]
    v_mfma_f32_16x16x32_bf16 v[40:43], v[64:67], v[128:131], v[40:43]
    v_mfma_f32_16x16x32_bf16 v[36:39], v[64:67], v[124:127], v[36:39]
    v_mfma_f32_16x16x32_bf16 v[32:35], v[64:67], v[120:123], v[32:35]
    s_waitcnt lgkmcnt(0)
    v_mfma_f32_16x16x32_bf16 v[36:39], v[68:71], v[120:123], v[36:39]
    v_mfma_f32_16x16x32_bf16 v[40:43], v[68:71], v[124:127], v[40:43]
    v_mfma_f32_16x16x32_bf16 v[44:47], v[68:71], v[128:131], v[44:47]
    v_mfma_f32_16x16x32_bf16 v[48:51], v[68:71], v[132:135], v[48:51]
    v_mfma_f32_16x16x32_bf16 v[52:55], v[68:71], v[136:139], v[52:55]
    s_waitcnt lgkmcnt(0)
    v_mfma_f32_16x16x32_bf16 v[52:55], v[72:75], v[132:135], v[52:55]
    v_mfma_f32_16x16x32_bf16 v[48:51], v[72:75], v[128:131], v[48:51]
    v_mfma_f32_16x16x32_bf16 v[44:47], v[72:75], v[124:127], v[44:47]
    v_mfma_f32_16x16x32_bf16 v[40:43], v[72:75], v[120:123], v[40:43]
    s_waitcnt lgkmcnt(0)
    v_mfma_f32_16x16x32_bf16 v[44:47], v[76:79], v[120:123], v[44:47]
    v_mfma_f32_16x16x32_bf16 v[48:51], v[76:79], v[124:127], v[48:51]
    v_mfma_f32_16x16x32_bf16 v[52:55], v[76:79], v[128:131], v[52:55]
    s_waitcnt lgkmcnt(0)
    v_mfma_f32_16x16x32_bf16 v[52:55], v[80:83], v[124:127], v[52:55]
    v_mfma_f32_16x16x32_bf16 v[48:51], v[80:83], v[120:123], v[48:51]
    s_waitcnt lgkmcnt(0)
    v_mfma_f32_16x16x32_bf16 v[52:55], v[84:87], v[120:123], v[52:55]
    ds_read_b128 v[56:59], v16 offset:3968
    ds_read_b128 v[60:63], v16 offset:3456
    ds_read_b128 v[64:67], v16 offset:2944
    ds_read_b128 v[68:71], v16 offset:2432
    ds_read_b128 v[72:75], v16 offset:1920
    ds_read_b128 v[76:79], v16 offset:1408
    ds_read_b128 v[80:83], v16 offset:896
    ds_read_b128 v[84:87], v16 offset:384
    ds_read_b64 v[88:89], v17 offset:384
    ds_read_b64 v[90:91], v17 offset:392
    ds_read_b64 v[92:93], v17 offset:896
    ds_read_b64 v[94:95], v17 offset:904
    ds_read_b64 v[96:97], v17 offset:1408
    ds_read_b64 v[98:99], v17 offset:1416
    ds_read_b64 v[100:101], v17 offset:1920
    ds_read_b64 v[102:103], v17 offset:1928
    ds_read_b64 v[104:105], v17 offset:2432
    ds_read_b64 v[106:107], v17 offset:2440
    ds_read_b64 v[108:109], v17 offset:2944
    ds_read_b64 v[110:111], v17 offset:2952
    ds_read_b64 v[112:113], v17 offset:3456
    ds_read_b64 v[114:115], v17 offset:3464
    ds_read_b64 v[116:117], v17 offset:3968
    ds_read_b64 v[118:119], v17 offset:3976
    s_waitcnt lgkmcnt(0)
    v_mfma_f32_16x16x32_bf16 v[52:55], v[56:59], v[116:119], v[52:55]
    v_mfma_f32_16x16x32_bf16 v[48:51], v[56:59], v[112:115], v[48:51]
    v_mfma_f32_16x16x32_bf16 v[44:47], v[56:59], v[108:111], v[44:47]
    v_mfma_f32_16x16x32_bf16 v[40:43], v[56:59], v[104:107], v[40:43]
    v_mfma_f32_16x16x32_bf16 v[36:39], v[56:59], v[100:103], v[36:39]
    v_mfma_f32_16x16x32_bf16 v[32:35], v[56:59], v[96:99], v[32:35]
    v_mfma_f32_16x16x32_bf16 v[28:31], v[56:59], v[92:95], v[28:31]
    v_mfma_f32_16x16x32_bf16 v[24:27], v[56:59], v[88:91], v[24:27]
    s_waitcnt lgkmcnt(0)
    v_mfma_f32_16x16x32_bf16 v[28:31], v[60:63], v[88:91], v[28:31]
    v_mfma_f32_16x16x32_bf16 v[32:35], v[60:63], v[92:95], v[32:35]
    v_mfma_f32_16x16x32_bf16 v[36:39], v[60:63], v[96:99], v[36:39]
    v_mfma_f32_16x16x32_bf16 v[40:43], v[60:63], v[100:103], v[40:43]
    v_mfma_f32_16x16x32_bf16 v[44:47], v[60:63], v[104:107], v[44:47]
    v_mfma_f32_16x16x32_bf16 v[48:51], v[60:63], v[108:111], v[48:51]
    v_mfma_f32_16x16x32_bf16 v[52:55], v[60:63], v[112:115], v[52:55]
    s_waitcnt lgkmcnt(0)
    v_mfma_f32_16x16x32_bf16 v[52:55], v[64:67], v[108:111], v[52:55]
    v_mfma_f32_16x16x32_bf16 v[48:51], v[64:67], v[104:107], v[48:51]
    v_mfma_f32_16x16x32_bf16 v[44:47], v[64:67], v[100:103], v[44:47]
    v_mfma_f32_16x16x32_bf16 v[40:43], v[64:67], v[96:99], v[40:43]
    v_mfma_f32_16x16x32_bf16 v[36:39], v[64:67], v[92:95], v[36:39]
    v_mfma_f32_16x16x32_bf16 v[32:35], v[64:67], v[88:91], v[32:35]
    s_waitcnt lgkmcnt(0)
    v_mfma_f32_16x16x32_bf16 v[36:39], v[68:71], v[88:91], v[36:39]
    v_mfma_f32_16x16x32_bf16 v[40:43], v[68:71], v[92:95], v[40:43]
    v_mfma_f32_16x16x32_bf16 v[44:47], v[68:71], v[96:99], v[44:47]
    v_mfma_f32_16x16x32_bf16 v[48:51], v[68:71], v[100:103], v[48:51]
    v_mfma_f32_16x16x32_bf16 v[52:55], v[68:71], v[104:107], v[52:55]
    s_waitcnt lgkmcnt(0)
    v_mfma_f32_16x16x32_bf16 v[52:55], v[72:75], v[100:103], v[52:55]
    v_mfma_f32_16x16x32_bf16 v[48:51], v[72:75], v[96:99], v[48:51]
    v_mfma_f32_16x16x32_bf16 v[44:47], v[72:75], v[92:95], v[44:47]
    v_mfma_f32_16x16x32_bf16 v[40:43], v[72:75], v[88:91], v[40:43]
    s_waitcnt lgkmcnt(0)
    v_mfma_f32_16x16x32_bf16 v[44:47], v[76:79], v[88:91], v[44:47]
    v_mfma_f32_16x16x32_bf16 v[48:51], v[76:79], v[92:95], v[48:51]
    v_mfma_f32_16x16x32_bf16 v[52:55], v[76:79], v[96:99], v[52:55]
    s_waitcnt lgkmcnt(0)
    v_mfma_f32_16x16x32_bf16 v[52:55], v[80:83], v[92:95], v[52:55]
    v_mfma_f32_16x16x32_bf16 v[48:51], v[80:83], v[88:91], v[48:51]
    s_waitcnt lgkmcnt(0)
    v_mfma_f32_16x16x32_bf16 v[52:55], v[84:87], v[88:91], v[52:55]
    ds_read_b128 v[56:59], v16 offset:4032
    ds_read_b128 v[60:63], v16 offset:3520
    ds_read_b128 v[64:67], v16 offset:3008
    ds_read_b128 v[68:71], v16 offset:2496
    ds_read_b128 v[72:75], v16 offset:1984
    ds_read_b128 v[76:79], v16 offset:1472
    ds_read_b128 v[80:83], v16 offset:960
    ds_read_b128 v[84:87], v16 offset:448
    ds_read_b64 v[120:121], v17 offset:448
    ds_read_b64 v[122:123], v17 offset:456
    ds_read_b64 v[124:125], v17 offset:960
    ds_read_b64 v[126:127], v17 offset:968
    ds_read_b64 v[128:129], v17 offset:1472
    ds_read_b64 v[130:131], v17 offset:1480
    ds_read_b64 v[132:133], v17 offset:1984
    ds_read_b64 v[134:135], v17 offset:1992
    ds_read_b64 v[136:137], v17 offset:2496
    ds_read_b64 v[138:139], v17 offset:2504
    ds_read_b64 v[140:141], v17 offset:3008
    ds_read_b64 v[142:143], v17 offset:3016
    ds_read_b64 v[144:145], v17 offset:3520
    ds_read_b64 v[146:147], v17 offset:3528
    ds_read_b64 v[148:149], v17 offset:4032
    ds_read_b64 v[150:151], v17 offset:4040
    s_waitcnt lgkmcnt(0)
    v_mfma_f32_16x16x32_bf16 v[52:55], v[56:59], v[148:151], v[52:55]
    v_mfma_f32_16x16x32_bf16 v[48:51], v[56:59], v[144:147], v[48:51]
    v_mfma_f32_16x16x32_bf16 v[44:47], v[56:59], v[140:143], v[44:47]
    v_mfma_f32_16x16x32_bf16 v[40:43], v[56:59], v[136:139], v[40:43]
    v_mfma_f32_16x16x32_bf16 v[36:39], v[56:59], v[132:135], v[36:39]
    v_mfma_f32_16x16x32_bf16 v[32:35], v[56:59], v[128:131], v[32:35]
    v_mfma_f32_16x16x32_bf16 v[28:31], v[56:59], v[124:127], v[28:31]
    v_mfma_f32_16x16x32_bf16 v[24:27], v[56:59], v[120:123], v[24:27]
    s_waitcnt lgkmcnt(0)
    v_mfma_f32_16x16x32_bf16 v[28:31], v[60:63], v[120:123], v[28:31]
    v_mfma_f32_16x16x32_bf16 v[32:35], v[60:63], v[124:127], v[32:35]
    v_mfma_f32_16x16x32_bf16 v[36:39], v[60:63], v[128:131], v[36:39]
    v_mfma_f32_16x16x32_bf16 v[40:43], v[60:63], v[132:135], v[40:43]
    s_nop 2
    v_cvt_pk_bf16_f32 v152, v24, v25
    ds_write_b32 v10, v152 offset:0
    v_cvt_pk_bf16_f32 v153, v26, v27
    ds_write_b32 v10, v153 offset:64
    v_mfma_f32_16x16x32_bf16 v[44:47], v[60:63], v[136:139], v[44:47]
    v_mfma_f32_16x16x32_bf16 v[48:51], v[60:63], v[140:143], v[48:51]
    v_mfma_f32_16x16x32_bf16 v[52:55], v[60:63], v[144:147], v[52:55]
    s_waitcnt lgkmcnt(2)
    v_mfma_f32_16x16x32_bf16 v[52:55], v[64:67], v[140:143], v[52:55]
    v_mfma_f32_16x16x32_bf16 v[48:51], v[64:67], v[136:139], v[48:51]
    v_mfma_f32_16x16x32_bf16 v[44:47], v[64:67], v[132:135], v[44:47]
    v_mfma_f32_16x16x32_bf16 v[40:43], v[64:67], v[128:131], v[40:43]
    v_cvt_pk_bf16_f32 v154, v28, v29
    ds_write_b32 v10, v154 offset:512
    v_cvt_pk_bf16_f32 v155, v30, v31
    ds_write_b32 v10, v155 offset:576
    v_mfma_f32_16x16x32_bf16 v[36:39], v[64:67], v[124:127], v[36:39]
    v_mfma_f32_16x16x32_bf16 v[32:35], v[64:67], v[120:123], v[32:35]
    s_waitcnt lgkmcnt(4)
    v_mfma_f32_16x16x32_bf16 v[36:39], v[68:71], v[120:123], v[36:39]
    v_mfma_f32_16x16x32_bf16 v[40:43], v[68:71], v[124:127], v[40:43]
    v_mfma_f32_16x16x32_bf16 v[44:47], v[68:71], v[128:131], v[44:47]
    v_mfma_f32_16x16x32_bf16 v[48:51], v[68:71], v[132:135], v[48:51]
    s_nop 2
    v_cvt_pk_bf16_f32 v156, v32, v33
    ds_write_b32 v10, v156 offset:1024
    v_cvt_pk_bf16_f32 v157, v34, v35
    ds_write_b32 v10, v157 offset:1088
    v_mfma_f32_16x16x32_bf16 v[52:55], v[68:71], v[136:139], v[52:55]
    s_waitcnt lgkmcnt(6)
    v_mfma_f32_16x16x32_bf16 v[52:55], v[72:75], v[132:135], v[52:55]
    v_mfma_f32_16x16x32_bf16 v[48:51], v[72:75], v[128:131], v[48:51]
    v_mfma_f32_16x16x32_bf16 v[44:47], v[72:75], v[124:127], v[44:47]
    v_mfma_f32_16x16x32_bf16 v[40:43], v[72:75], v[120:123], v[40:43]
    v_cvt_pk_bf16_f32 v158, v36, v37
    ds_write_b32 v10, v158 offset:1536
    v_cvt_pk_bf16_f32 v159, v38, v39
    ds_write_b32 v10, v159 offset:1600
    s_waitcnt lgkmcnt(8)
    v_mfma_f32_16x16x32_bf16 v[44:47], v[76:79], v[120:123], v[44:47]
    v_mfma_f32_16x16x32_bf16 v[48:51], v[76:79], v[124:127], v[48:51]
    v_mfma_f32_16x16x32_bf16 v[52:55], v[76:79], v[128:131], v[52:55]
    v_cvt_pk_bf16_f32 v160, v40, v41
    ds_write_b32 v10, v160 offset:2048
    v_cvt_pk_bf16_f32 v161, v42, v43
    ds_write_b32 v10, v161 offset:2112
    s_waitcnt lgkmcnt(10)
    v_mfma_f32_16x16x32_bf16 v[52:55], v[80:83], v[124:127], v[52:55]
    v_mfma_f32_16x16x32_bf16 v[48:51], v[80:83], v[120:123], v[48:51]
    s_waitcnt lgkmcnt(10)
    v_mfma_f32_16x16x32_bf16 v[52:55], v[84:87], v[120:123], v[52:55]
    v_cvt_pk_bf16_f32 v162, v44, v45
    ds_write_b32 v10, v162 offset:2560
    v_cvt_pk_bf16_f32 v163, v46, v47
    ds_write_b32 v10, v163 offset:2624
    s_nop 1
    v_cvt_pk_bf16_f32 v164, v48, v49
    ds_write_b32 v10, v164 offset:3072
    v_cvt_pk_bf16_f32 v165, v50, v51
    ds_write_b32 v10, v165 offset:3136
    v_cvt_pk_bf16_f32 v166, v52, v53
    ds_write_b32 v10, v166 offset:3584
    v_cvt_pk_bf16_f32 v167, v54, v55
    ds_write_b32 v10, v167 offset:3648
    s_waitcnt lgkmcnt(0)
    v_mov_b32 v7, 156416
    v_mov_b32 v6, 1
    s_mov_b64 exec, 1
    ds_add_u32 v7, v6
    s_mov_b64 exec, -1
    s_mov_b32 s39, 0
L_spin_2:
    ds_read_b32 v6, v7
    s_add_u32 s39, s39, 1
    s_cmp_gt_u32 s39, 200000
    s_cbranch_scc1 L_spun_3
    s_waitcnt lgkmcnt(0)
    v_cmp_ne_u32 vcc, 4, v6
    s_cbranch_vccnz L_spin_2
L_spun_3:
    ds_read_b128 v[72:75], v19 offset:0
    ds_read_b128 v[76:79], v19 offset:256
    ds_read_b128 v[80:83], v19 offset:512
    ds_read_b128 v[84:87], v19 offset:768
    s_waitcnt lgkmcnt(3)
    buffer_store_dwordx4 v[72:75], v11, s[8:11], s38 offen sc1
    s_add_u32 s38, s38, 262144
    s_waitcnt lgkmcnt(2)
    buffer_store_dwordx4 v[76:79], v11, s[8:11], s38 offen sc1
    s_add_u32 s38, s38, 262144
    s_waitcnt lgkmcnt(1)
    buffer_store_dwordx4 v[80:83], v11, s[8:11], s38 offen sc1
    s_add_u32 s38, s38, 262144
    s_waitcnt lgkmcnt(0)
    buffer_store_dwordx4 v[84:87], v11, s[8:11], s38 offen sc1
    s_add_u32 s38, s38, 262144
    s_waitcnt vmcnt(0)
    s_barrier
    s_barrier
    s_barrier
    s_barrier
    s_barrier
    s_barrier
    s_cmp_lt_u32 s5, 28
    s_cbranch_scc1 L_A1
    s_barrier
    s_barrier
    s_barrier
    s_branch L_A3
L_A1:
    s_and_b32 s35, s3, 1
    s_lshr_b32 s36, s3, 1
    v_bfe_u32 v5, v2, 2, 2
    v_and_b32 v6, 3, v2
    v_lshl_add_u32 v7, v4, 3, v5
    v_lshlrev_b32 v7, 8, v7
    v_lshl_add_u32 v7, v6, 3, v7
    v_and_b32 v6, 1, v4
    v_xor_b32 v6, s35, v6
    v_lshl_add_u32 v7, v6, 7, v7
    v_xor_b32 v6, 0, v5
    v_lshl_add_u32 v8, v6, 5, v7
    v_xor_b32 v6, 1, v5
    v_lshl_add_u32 v9, v6, 5, v7
    v_xor_b32 v6, 2, v5
    v_lshl_add_u32 v10, v6, 5, v7
    v_xor_b32 v6, 3, v5
    v_lshl_add_u32 v11, v6, 5, v7
    s_mul_i32 s37, s36, 8192
    v_lshrrev_b32 v5, 1, v3
    v_xor_b32 v5, v5, v4
    v_lshlrev_b32 v5, 4, v5
    v_lshl_add_u32 v5, v3, 7, v5
    v_add_u32 v12, s37, v5
    v_add_u32 v12, 0, v12
    v_xor_b32 v13, 64, v12
    s_mov_b32 s40, 0x10000
    s_mov_b32 s44, s82
    s_and_b32 s45, s83, 0xffff
    s_mov_b32 s46, 4096
    s_mov_b32 s47, 0x00020000
    s_lshl_b32 s41, s58, 7
    s_lshl_b32 s42, s36, 6
    s_add_u32 s41, s41, s42
    v_add_u32 v6, s41, v3
    v_lshlrev_b32 v7, 1, v6
    v_and_b32 v1, 7, v2
    v_add_u32 v1, s41, v1
    v_mul_u32_u24 v1, 4096, v1
    v_lshl_add_u32 v1, v4, 4, v1
    v_bfe_u32 v6, v2, 3, 1
    v_lshl_add_u32 v1, v6, 6, v1
    s_lshl_b32 s34, s59, 1
    s_add_u32 s34, s34, s35
    s_add_u32 s41, s34, 4
    s_mul_i32 s41, s41, 37
    s_lshr_b32 s41, s41, 8
    s_add_u32 s34, s34, s41
    s_lshl_b32 s34, s34, 7
    v_mov_b32 v14, 0xc0135761
    v_mov_b32 v15, v14
    s_mov_b32 s42, 0xbdd2d3e7
    s_mov_b32 s43, s42
    buffer_load_ushort v248, v7, s[44:47], 0 offen offset:0
    buffer_load_ushort v249, v7, s[44:47], 0 offen offset:32
    buffer_load_ushort v250, v7, s[44:47], 0 offen offset:64
    buffer_load_ushort v251, v7, s[44:47], 0 offen offset:96
    s_barrier
    s_barrier
    ds_read_b128 v[160:163], v12 offset:16384
    ds_read_b64_tr_b16 v[144:145], v8 offset:0
    ds_read_b64_tr_b16 v[146:147], v8 offset:1024
    ds_read_b128 v[164:167], v12 offset:18432
    ds_read_b64_tr_b16 v[148:149], v9 offset:0
    ds_read_b64_tr_b16 v[150:151], v9 offset:1024
    ds_read_b128 v[168:171], v12 offset:20480
    ds_read_b64_tr_b16 v[152:153], v10 offset:0
    ds_read_b64_tr_b16 v[154:155], v10 offset:1024
    ds_read_b128 v[172:175], v12 offset:22528
    ds_read_b64_tr_b16 v[156:157], v11 offset:0
    ds_read_b64_tr_b16 v[158:159], v11 offset:1024
    s_waitcnt lgkmcnt(0)
    v_mfma_f32_16x16x32_bf16 v[16:19], v[144:147], v[160:163], 0
    ds_read_b128 v[192:195], v13 offset:16384
    ds_read_b64_tr_b16 v[176:177], v8 offset:8192
    v_mfma_f32_16x16x32_bf16 v[32:35], v[148:151], v[160:163], 0
    ds_read_b64_tr_b16 v[178:179], v8 offset:9216
    ds_read_b128 v[196:199], v13 offset:18432
    v_mfma_f32_16x16x32_bf16 v[48:51], v[152:155], v[160:163], 0
    ds_read_b64_tr_b16 v[180:181], v9 offset:8192
    ds_read_b64_tr_b16 v[182:183], v9 offset:9216
    v_mfma_f32_16x16x32_bf16 v[64:67], v[156:159], v[160:163], 0
    ds_read_b128 v[200:203], v13 offset:20480
    ds_read_b64_tr_b16 v[184:185], v10 offset:8192
    v_mfma_f32_16x16x32_bf16 v[68:71], v[156:159], v[164:167], 0
    ds_read_b64_tr_b16 v[186:187], v10 offset:9216
    ds_read_b128 v[204:207], v13 offset:22528
    v_mfma_f32_16x16x32_bf16 v[52:55], v[152:155], v[164:167], 0
    ds_read_b64_tr_b16 v[188:189], v11 offset:8192
    ds_read_b64_tr_b16 v[190:191], v11 offset:9216
    v_mfma_f32_16x16x32_bf16 v[36:39], v[148:151], v[164:167], 0
    v_mfma_f32_16x16x32_bf16 v[20:23], v[144:147], v[164:167], 0
    v_mfma_f32_16x16x32_bf16 v[24:27], v[144:147], v[168:171], 0
    v_mfma_f32_16x16x32_bf16 v[40:43], v[148:151], v[168:171], 0
    v_mfma_f32_16x16x32_bf16 v[56:59], v[152:155], v[168:171], 0
    v_mfma_f32_16x16x32_bf16 v[72:75], v[156:159], v[168:171], 0
    v_mfma_f32_16x16x32_bf16 v[76:79], v[156:159], v[172:175], 0
    v_mfma_f32_16x16x32_bf16 v[60:63], v[152:155], v[172:175], 0
    v_mfma_f32_16x16x32_bf16 v[44:47], v[148:151], v[172:175], 0
    v_mfma_f32_16x16x32_bf16 v[28:31], v[144:147], v[172:175], 0
    s_waitcnt lgkmcnt(0)
    s_barrier
    v_mfma_f32_16x16x32_bf16 v[16:19], v[176:179], v[192:195], v[16:19]
    ds_read_b128 v[160:163], v12 offset:49152
    ds_read_b64_tr_b16 v[144:145], v8 offset:32768
    v_mfma_f32_16x16x32_bf16 v[32:35], v[180:183], v[192:195], v[32:35]
    ds_read_b64_tr_b16 v[146:147], v8 offset:33792
    ds_read_b128 v[164:167], v12 offset:51200
    v_mfma_f32_16x16x32_bf16 v[48:51], v[184:187], v[192:195], v[48:51]
    ds_read_b64_tr_b16 v[148:149], v9 offset:32768
    ds_read_b64_tr_b16 v[150:151], v9 offset:33792
    v_mfma_f32_16x16x32_bf16 v[64:67], v[188:191], v[192:195], v[64:67]
    ds_read_b128 v[168:171], v12 offset:53248
    ds_read_b64_tr_b16 v[152:153], v10 offset:32768
    v_mfma_f32_16x16x32_bf16 v[68:71], v[188:191], v[196:199], v[68:71]
    ds_read_b64_tr_b16 v[154:155], v10 offset:33792
    ds_read_b128 v[172:175], v12 offset:55296
    v_mfma_f32_16x16x32_bf16 v[52:55], v[184:187], v[196:199], v[52:55]
    ds_read_b64_tr_b16 v[156:157], v11 offset:32768
    ds_read_b64_tr_b16 v[158:159], v11 offset:33792
    v_mfma_f32_16x16x32_bf16 v[36:39], v[180:183], v[196:199], v[36:39]
    v_mfma_f32_16x16x32_bf16 v[20:23], v[176:179], v[196:199], v[20:23]
    v_mfma_f32_16x16x32_bf16 v[24:27], v[176:179], v[200:203], v[24:27]
    v_mfma_f32_16x16x32_bf16 v[40:43], v[180:183], v[200:203], v[40:43]
    v_mfma_f32_16x16x32_bf16 v[56:59], v[184:187], v[200:203], v[56:59]
    v_mfma_f32_16x16x32_bf16 v[72:75], v[188:191], v[200:203], v[72:75]
    v_mfma_f32_16x16x32_bf16 v[76:79], v[188:191], v[204:207], v[76:79]
    v_mfma_f32_16x16x32_bf16 v[60:63], v[184:187], v[204:207], v[60:63]
    v_mfma_f32_16x16x32_bf16 v[44:47], v[180:183], v[204:207], v[44:47]
    v_mfma_f32_16x16x32_bf16 v[28:31], v[176:179], v[204:207], v[28:31]
    s_waitcnt lgkmcnt(0)
    v_mfma_f32_16x16x32_bf16 v[16:19], v[144:147], v[160:163], v[16:19]
    ds_read_b128 v[192:195], v13 offset:49152
    ds_read_b64_tr_b16 v[176:177], v8 offset:40960
    v_mfma_f32_16x16x32_bf16 v[32:35], v[148:151], v[160:163], v[32:35]
    ds_read_b64_tr_b16 v[178:179], v8 offset:41984
    ds_read_b128 v[196:199], v13 offset:51200
    v_mfma_f32_16x16x32_bf16 v[48:51], v[152:155], v[160:163], v[48:51]
    ds_read_b64_tr_b16 v[180:181], v9 offset:40960
    ds_read_b64_tr_b16 v[182:183], v9 offset:41984
    v_mfma_f32_16x16x32_bf16 v[64:67], v[156:159], v[160:163], v[64:67]
    ds_read_b128 v[200:203], v13 offset:53248
    ds_read_b64_tr_b16 v[184:185], v10 offset:40960
    v_mfma_f32_16x16x32_bf16 v[68:71], v[156:159], v[164:167], v[68:71]
    ds_read_b64_tr_b16 v[186:187], v10 offset:41984
    ds_read_b128 v[204:207], v13 offset:55296
    v_mfma_f32_16x16x32_bf16 v[52:55], v[152:155], v[164:167], v[52:55]
    ds_read_b64_tr_b16 v[188:189], v11 offset:40960
    ds_read_b64_tr_b16 v[190:191], v11 offset:41984
    v_xor_b32 v8, s40, v8
    v_mfma_f32_16x16x32_bf16 v[36:39], v[148:151], v[164:167], v[36:39]
    v_xor_b32 v9, s40, v9
    v_xor_b32 v10, s40, v10
    v_mfma_f32_16x16x32_bf16 v[20:23], v[144:147], v[164:167], v[20:23]
    v_xor_b32 v11, s40, v11
    v_xor_b32 v12, s40, v12
    v_mfma_f32_16x16x32_bf16 v[24:27], v[144:147], v[168:171], v[24:27]
    v_xor_b32 v13, s40, v13
    v_mfma_f32_16x16x32_bf16 v[40:43], v[148:151], v[168:171], v[40:43]
    v_mfma_f32_16x16x32_bf16 v[56:59], v[152:155], v[168:171], v[56:59]
    v_mfma_f32_16x16x32_bf16 v[72:75], v[156:159], v[168:171], v[72:75]
    v_mfma_f32_16x16x32_bf16 v[76:79], v[156:159], v[172:175], v[76:79]
    v_mfma_f32_16x16x32_bf16 v[60:63], v[152:155], v[172:175], v[60:63]
    v_mfma_f32_16x16x32_bf16 v[44:47], v[148:151], v[172:175], v[44:47]
    v_mfma_f32_16x16x32_bf16 v[28:31], v[144:147], v[172:175], v[28:31]
    s_waitcnt lgkmcnt(0)
    s_barrier
    v_mfma_f32_16x16x32_bf16 v[16:19], v[176:179], v[192:195], v[16:19]
    ds_read_b128 v[160:163], v12 offset:16384
    ds_read_b64_tr_b16 v[144:145], v8 offset:0
L_pad_2:
    s_cmp_eq_u32 s99, 1
    s_cbranch_scc1 L_padret_2
    v_mfma_f32_16x16x32_bf16 v[32:35], v[180:183], v[192:195], v[32:35]
    ds_read_b64_tr_b16 v[146:147], v8 offset:1024
    ds_read_b128 v[164:167], v12 offset:18432
    v_mfma_f32_16x16x32_bf16 v[48:51], v[184:187], v[192:195], v[48:51]
    ds_read_b64_tr_b16 v[148:149], v9 offset:0
    ds_read_b64_tr_b16 v[150:151], v9 offset:1024
    v_mfma_f32_16x16x32_bf16 v[64:67], v[188:191], v[192:195], v[64:67]
    ds_read_b128 v[168:171], v12 offset:20480
    ds_read_b64_tr_b16 v[152:153], v10 offset:0
    v_mfma_f32_16x16x32_bf16 v[68:71], v[188:191], v[196:199], v[68:71]
    ds_read_b64_tr_b16 v[154:155], v10 offset:1024
    ds_read_b128 v[172:175], v12 offset:22528
    v_mfma_f32_16x16x32_bf16 v[52:55], v[184:187], v[196:199], v[52:55]
    ds_read_b64_tr_b16 v[156:157], v11 offset:0
    ds_read_b64_tr_b16 v[158:159], v11 offset:1024
    v_mfma_f32_16x16x32_bf16 v[36:39], v[180:183], v[196:199], v[36:39]
    v_mfma_f32_16x16x32_bf16 v[20:23], v[176:179], v[196:199], v[20:23]
    v_mfma_f32_16x16x32_bf16 v[24:27], v[176:179], v[200:203], v[24:27]
    v_mfma_f32_16x16x32_bf16 v[40:43], v[180:183], v[200:203], v[40:43]
    v_mfma_f32_16x16x32_bf16 v[56:59], v[184:187], v[200:203], v[56:59]
    v_mfma_f32_16x16x32_bf16 v[72:75], v[188:191], v[200:203], v[72:75]
    v_mfma_f32_16x16x32_bf16 v[76:79], v[188:191], v[204:207], v[76:79]
    v_mfma_f32_16x16x32_bf16 v[60:63], v[184:187], v[204:207], v[60:63]
    v_mfma_f32_16x16x32_bf16 v[44:47], v[180:183], v[204:207], v[44:47]
    v_mfma_f32_16x16x32_bf16 v[28:31], v[176:179], v[204:207], v[28:31]
    s_waitcnt lgkmcnt(0)
    v_mfma_f32_16x16x32_bf16 v[16:19], v[144:147], v[160:163], v[16:19]
    ds_read_b128 v[192:195], v13 offset:16384
    ds_read_b64_tr_b16 v[176:177], v8 offset:8192
    v_mfma_f32_16x16x32_bf16 v[32:35], v[148:151], v[160:163], v[32:35]
    ds_read_b64_tr_b16 v[178:179], v8 offset:9216
    ds_read_b128 v[196:199], v13 offset:18432
    v_mfma_f32_16x16x32_bf16 v[48:51], v[152:155], v[160:163], v[48:51]
    ds_read_b64_tr_b16 v[180:181], v9 offset:8192
    ds_read_b64_tr_b16 v[182:183], v9 offset:9216
    v_mfma_f32_16x16x32_bf16 v[64:67], v[156:159], v[160:163], v[64:67]
    ds_read_b128 v[200:203], v13 offset:20480
    ds_read_b64_tr_b16 v[184:185], v10 offset:8192
    v_mfma_f32_16x16x32_bf16 v[68:71], v[156:159], v[164:167], v[68:71]
    ds_read_b64_tr_b16 v[186:187], v10 offset:9216
    ds_read_b128 v[204:207], v13 offset:22528
    v_mfma_f32_16x16x32_bf16 v[52:55], v[152:155], v[164:167], v[52:55]
    ds_read_b64_tr_b16 v[188:189], v11 offset:8192
    ds_read_b64_tr_b16 v[190:191], v11 offset:9216
    v_mfma_f32_16x16x32_bf16 v[36:39], v[148:151], v[164:167], v[36:39]
    v_mfma_f32_16x16x32_bf16 v[20:23], v[144:147], v[164:167], v[20:23]
    v_mfma_f32_16x16x32_bf16 v[24:27], v[144:147], v[168:171], v[24:27]
    v_mfma_f32_16x16x32_bf16 v[40:43], v[148:151], v[168:171], v[40:43]
    v_mfma_f32_16x16x32_bf16 v[56:59], v[152:155], v[168:171], v[56:59]
    v_mfma_f32_16x16x32_bf16 v[72:75], v[156:159], v[168:171], v[72:75]
    v_mfma_f32_16x16x32_bf16 v[76:79], v[156:159], v[172:175], v[76:79]
    v_mfma_f32_16x16x32_bf16 v[60:63], v[152:155], v[172:175], v[60:63]
    v_mfma_f32_16x16x32_bf16 v[44:47], v[148:151], v[172:175], v[44:47]
    v_mfma_f32_16x16x32_bf16 v[28:31], v[144:147], v[172:175], v[28:31]
    s_waitcnt lgkmcnt(0)
    s_barrier
    v_mfma_f32_16x16x32_bf16 v[16:19], v[176:179], v[192:195], v[16:19]
    ds_read_b128 v[160:163], v12 offset:49152
    ds_read_b64_tr_b16 v[144:145], v8 offset:32768
    v_mfma_f32_16x16x32_bf16 v[32:35], v[180:183], v[192:195], v[32:35]
    ds_read_b64_tr_b16 v[146:147], v8 offset:33792
    ds_read_b128 v[164:167], v12 offset:51200
    v_mfma_f32_16x16x32_bf16 v[48:51], v[184:187], v[192:195], v[48:51]
    ds_read_b64_tr_b16 v[148:149], v9 offset:32768
    ds_read_b64_tr_b16 v[150:151], v9 offset:33792
    v_mfma_f32_16x16x32_bf16 v[64:67], v[188:191], v[192:195], v[64:67]
    ds_read_b128 v[168:171], v12 offset:53248
    ds_read_b64_tr_b16 v[152:153], v10 offset:32768
    v_mfma_f32_16x16x32_bf16 v[68:71], v[188:191], v[196:199], v[68:71]
    ds_read_b64_tr_b16 v[154:155], v10 offset:33792
    ds_read_b128 v[172:175], v12 offset:55296
    v_mfma_f32_16x16x32_bf16 v[52:55], v[184:187], v[196:199], v[52:55]
    ds_read_b64_tr_b16 v[156:157], v11 offset:32768
    ds_read_b64_tr_b16 v[158:159], v11 offset:33792
    v_mfma_f32_16x16x32_bf16 v[36:39], v[180:183], v[196:199], v[36:39]
    v_mfma_f32_16x16x32_bf16 v[20:23], v[176:179], v[196:199], v[20:23]
    v_mfma_f32_16x16x32_bf16 v[24:27], v[176:179], v[200:203], v[24:27]
    v_mfma_f32_16x16x32_bf16 v[40:43], v[180:183], v[200:203], v[40:43]
    v_mfma_f32_16x16x32_bf16 v[56:59], v[184:187], v[200:203], v[56:59]
    v_mfma_f32_16x16x32_bf16 v[72:75], v[188:191], v[200:203], v[72:75]
    v_mfma_f32_16x16x32_bf16 v[76:79], v[188:191], v[204:207], v[76:79]
    v_mfma_f32_16x16x32_bf16 v[60:63], v[184:187], v[204:207], v[60:63]
    v_mfma_f32_16x16x32_bf16 v[44:47], v[180:183], v[204:207], v[44:47]
    v_mfma_f32_16x16x32_bf16 v[28:31], v[176:179], v[204:207], v[28:31]
    s_waitcnt lgkmcnt(0)
    v_mfma_f32_16x16x32_bf16 v[16:19], v[144:147], v[160:163], v[16:19]
    ds_read_b128 v[192:195], v13 offset:49152
    ds_read_b64_tr_b16 v[176:177], v8 offset:40960
    v_mfma_f32_16x16x32_bf16 v[32:35], v[148:151], v[160:163], v[32:35]
    ds_read_b64_tr_b16 v[178:179], v8 offset:41984
    ds_read_b128 v[196:199], v13 offset:51200
    v_mfma_f32_16x16x32_bf16 v[48:51], v[152:155], v[160:163], v[48:51]
    ds_read_b64_tr_b16 v[180:181], v9 offset:40960
    ds_read_b64_tr_b16 v[182:183], v9 offset:41984
    v_mfma_f32_16x16x32_bf16 v[64:67], v[156:159], v[160:163], v[64:67]
    ds_read_b128 v[200:203], v13 offset:53248
    ds_read_b64_tr_b16 v[184:185], v10 offset:40960
    v_mfma_f32_16x16x32_bf16 v[68:71], v[156:159], v[164:167], v[68:71]
    ds_read_b64_tr_b16 v[186:187], v10 offset:41984
    ds_read_b128 v[204:207], v13 offset:55296
    v_mfma_f32_16x16x32_bf16 v[52:55], v[152:155], v[164:167], v[52:55]
    ds_read_b64_tr_b16 v[188:189], v11 offset:40960
    ds_read_b64_tr_b16 v[190:191], v11 offset:41984
    v_xor_b32 v8, s40, v8
    v_mfma_f32_16x16x32_bf16 v[36:39], v[148:151], v[164:167], v[36:39]
    v_xor_b32 v9, s40, v9
    v_xor_b32 v10, s40, v10
    v_mfma_f32_16x16x32_bf16 v[20:23], v[144:147], v[164:167], v[20:23]
    v_xor_b32 v11, s40, v11
    v_xor_b32 v12, s40, v12
    v_mfma_f32_16x16x32_bf16 v[24:27], v[144:147], v[168:171], v[24:27]
    v_xor_b32 v13, s40, v13
    v_mfma_f32_16x16x32_bf16 v[40:43], v[148:151], v[168:171], v[40:43]
    v_mfma_f32_16x16x32_bf16 v[56:59], v[152:155], v[168:171], v[56:59]
    v_mfma_f32_16x16x32_bf16 v[72:75], v[156:159], v[168:171], v[72:75]
    v_mfma_f32_16x16x32_bf16 v[76:79], v[156:159], v[172:175], v[76:79]
    v_mfma_f32_16x16x32_bf16 v[60:63], v[152:155], v[172:175], v[60:63]
    v_mfma_f32_16x16x32_bf16 v[44:47], v[148:151], v[172:175], v[44:47]
    v_mfma_f32_16x16x32_bf16 v[28:31], v[144:147], v[172:175], v[28:31]
    s_waitcnt lgkmcnt(0)
    s_mov_b32 s39, 3
L_p1loop:
    s_barrier
    v_mfma_f32_16x16x32_bf16 v[16:19], v[176:179], v[192:195], v[16:19]
    ds_read_b128 v[160:163], v12 offset:16384
    ds_read_b64_tr_b16 v[144:145], v8 offset:0
    v_mfma_f32_16x16x32_bf16 v[32:35], v[180:183], v[192:195], v[32:35]
    ds_read_b64_tr_b16 v[146:147], v8 offset:1024
    ds_read_b128 v[164:167], v12 offset:18432
    v_mfma_f32_16x16x32_bf16 v[48:51], v[184:187], v[192:195], v[48:51]
    ds_read_b64_tr_b16 v[148:149], v9 offset:0
    ds_read_b64_tr_b16 v[150:151], v9 offset:1024
    v_mfma_f32_16x16x32_bf16 v[64:67], v[188:191], v[192:195], v[64:67]
    ds_read_b128 v[168:171], v12 offset:20480
    ds_read_b64_tr_b16 v[152:153], v10 offset:0
    v_mfma_f32_16x16x32_bf16 v[68:71], v[188:191], v[196:199], v[68:71]
    ds_read_b64_tr_b16 v[154:155], v10 offset:1024
    ds_read_b128 v[172:175], v12 offset:22528
    v_mfma_f32_16x16x32_bf16 v[52:55], v[184:187], v[196:199], v[52:55]
    ds_read_b64_tr_b16 v[156:157], v11 offset:0
    ds_read_b64_tr_b16 v[158:159], v11 offset:1024
    v_mfma_f32_16x16x32_bf16 v[36:39], v[180:183], v[196:199], v[36:39]
    v_mfma_f32_16x16x32_bf16 v[20:23], v[176:179], v[196:199], v[20:23]
    v_mfma_f32_16x16x32_bf16 v[24:27], v[176:179], v[200:203], v[24:27]
    v_mfma_f32_16x16x32_bf16 v[40:43], v[180:183], v[200:203], v[40:43]
    v_mfma_f32_16x16x32_bf16 v[56:59], v[184:187], v[200:203], v[56:59]
    v_mfma_f32_16x16x32_bf16 v[72:75], v[188:191], v[200:203], v[72:75]
    v_mfma_f32_16x16x32_bf16 v[76:79], v[188:191], v[204:207], v[76:79]
    v_mfma_f32_16x16x32_bf16 v[60:63], v[184:187], v[204:207], v[60:63]
    v_mfma_f32_16x16x32_bf16 v[44:47], v[180:183], v[204:207], v[44:47]
    v_mfma_f32_16x16x32_bf16 v[28:31], v[176:179], v[204:207], v[28:31]
    s_waitcnt lgkmcnt(0)
    v_mfma_f32_16x16x32_bf16 v[16:19], v[144:147], v[160:163], v[16:19]
    ds_read_b128 v[192:195], v13 offset:16384
    ds_read_b64_tr_b16 v[176:177], v8 offset:8192
    v_mfma_f32_16x16x32_bf16 v[32:35], v[148:151], v[160:163], v[32:35]
    ds_read_b64_tr_b16 v[178:179], v8 offset:9216
    ds_read_b128 v[196:199], v13 offset:18432
    v_mfma_f32_16x16x32_bf16 v[48:51], v[152:155], v[160:163], v[48:51]
    ds_read_b64_tr_b16 v[180:181], v9 offset:8192
    ds_read_b64_tr_b16 v[182:183], v9 offset:9216
    v_mfma_f32_16x16x32_bf16 v[64:67], v[156:159], v[160:163], v[64:67]
    ds_read_b128 v[200:203], v13 offset:20480
    ds_read_b64_tr_b16 v[184:185], v10 offset:8192
    v_mfma_f32_16x16x32_bf16 v[68:71], v[156:159], v[164:167], v[68:71]
    ds_read_b64_tr_b16 v[186:187], v10 offset:9216
    ds_read_b128 v[204:207], v13 offset:22528
    v_mfma_f32_16x16x32_bf16 v[52:55], v[152:155], v[164:167], v[52:55]
    ds_read_b64_tr_b16 v[188:189], v11 offset:8192
    ds_read_b64_tr_b16 v[190:191], v11 offset:9216
    v_mfma_f32_16x16x32_bf16 v[36:39], v[148:151], v[164:167], v[36:39]
    v_mfma_f32_16x16x32_bf16 v[20:23], v[144:147], v[164:167], v[20:23]
    v_mfma_f32_16x16x32_bf16 v[24:27], v[144:147], v[168:171], v[24:27]
    v_mfma_f32_16x16x32_bf16 v[40:43], v[148:151], v[168:171], v[40:43]
    v_mfma_f32_16x16x32_bf16 v[56:59], v[152:155], v[168:171], v[56:59]
    v_mfma_f32_16x16x32_bf16 v[72:75], v[156:159], v[168:171], v[72:75]
    v_mfma_f32_16x16x32_bf16 v[76:79], v[156:159], v[172:175], v[76:79]
    v_mfma_f32_16x16x32_bf16 v[60:63], v[152:155], v[172:175], v[60:63]
    v_mfma_f32_16x16x32_bf16 v[44:47], v[148:151], v[172:175], v[44:47]
    v_mfma_f32_16x16x32_bf16 v[28:31], v[144:147], v[172:175], v[28:31]
    s_waitcnt lgkmcnt(0)
    s_barrier
    v_mfma_f32_16x16x32_bf16 v[16:19], v[176:179], v[192:195], v[16:19]
    ds_read_b128 v[160:163], v12 offset:49152
    ds_read_b64_tr_b16 v[144:145], v8 offset:32768
    v_mfma_f32_16x16x32_bf16 v[32:35], v[180:183], v[192:195], v[32:35]
    ds_read_b64_tr_b16 v[146:147], v8 offset:33792
    ds_read_b128 v[164:167], v12 offset:51200
    v_mfma_f32_16x16x32_bf16 v[48:51], v[184:187], v[192:195], v[48:51]
    ds_read_b64_tr_b16 v[148:149], v9 offset:32768
    ds_read_b64_tr_b16 v[150:151], v9 offset:33792
    v_mfma_f32_16x16x32_bf16 v[64:67], v[188:191], v[192:195], v[64:67]
    ds_read_b128 v[168:171], v12 offset:53248
    ds_read_b64_tr_b16 v[152:153], v10 offset:32768
    v_mfma_f32_16x16x32_bf16 v[68:71], v[188:191], v[196:199], v[68:71]
    ds_read_b64_tr_b16 v[154:155], v10 offset:33792
    ds_read_b128 v[172:175], v12 offset:55296
    v_mfma_f32_16x16x32_bf16 v[52:55], v[184:187], v[196:199], v[52:55]
    ds_read_b64_tr_b16 v[156:157], v11 offset:32768
    ds_read_b64_tr_b16 v[158:159], v11 offset:33792
    v_mfma_f32_16x16x32_bf16 v[36:39], v[180:183], v[196:199], v[36:39]
    v_mfma_f32_16x16x32_bf16 v[20:23], v[176:179], v[196:199], v[20:23]
    v_mfma_f32_16x16x32_bf16 v[24:27], v[176:179], v[200:203], v[24:27]
    v_mfma_f32_16x16x32_bf16 v[40:43], v[180:183], v[200:203], v[40:43]
    v_mfma_f32_16x16x32_bf16 v[56:59], v[184:187], v[200:203], v[56:59]
    v_mfma_f32_16x16x32_bf16 v[72:75], v[188:191], v[200:203], v[72:75]
    v_mfma_f32_16x16x32_bf16 v[76:79], v[188:191], v[204:207], v[76:79]
    v_mfma_f32_16x16x32_bf16 v[60:63], v[184:187], v[204:207], v[60:63]
    v_mfma_f32_16x16x32_bf16 v[44:47], v[180:183], v[204:207], v[44:47]
    v_mfma_f32_16x16x32_bf16 v[28:31], v[176:179], v[204:207], v[28:31]
    s_waitcnt lgkmcnt(0)
    v_mfma_f32_16x16x32_bf16 v[16:19], v[144:147], v[160:163], v[16:19]
    ds_read_b128 v[192:195], v13 offset:49152
    ds_read_b64_tr_b16 v[176:177], v8 offset:40960
    v_mfma_f32_16x16x32_bf16 v[32:35], v[148:151], v[160:163], v[32:35]
    ds_read_b64_tr_b16 v[178:179], v8 offset:41984
    ds_read_b128 v[196:199], v13 offset:51200
    v_mfma_f32_16x16x32_bf16 v[48:51], v[152:155], v[160:163], v[48:51]
    ds_read_b64_tr_b16 v[180:181], v9 offset:40960
    ds_read_b64_tr_b16 v[182:183], v9 offset:41984
    v_mfma_f32_16x16x32_bf16 v[64:67], v[156:159], v[160:163], v[64:67]
    ds_read_b128 v[200:203], v13 offset:53248
    ds_read_b64_tr_b16 v[184:185], v10 offset:40960
    v_mfma_f32_16x16x32_bf16 v[68:71], v[156:159], v[164:167], v[68:71]
    ds_read_b64_tr_b16 v[186:187], v10 offset:41984
    ds_read_b128 v[204:207], v13 offset:55296
    v_mfma_f32_16x16x32_bf16 v[52:55], v[152:155], v[164:167], v[52:55]
    ds_read_b64_tr_b16 v[188:189], v11 offset:40960
    ds_read_b64_tr_b16 v[190:191], v11 offset:41984
    v_xor_b32 v8, s40, v8
    v_mfma_f32_16x16x32_bf16 v[36:39], v[148:151], v[164:167], v[36:39]
    v_xor_b32 v9, s40, v9
    v_xor_b32 v10, s40, v10
    v_mfma_f32_16x16x32_bf16 v[20:23], v[144:147], v[164:167], v[20:23]
    v_xor_b32 v11, s40, v11
    v_xor_b32 v12, s40, v12
    v_mfma_f32_16x16x32_bf16 v[24:27], v[144:147], v[168:171], v[24:27]
    v_xor_b32 v13, s40, v13
    v_mfma_f32_16x16x32_bf16 v[40:43], v[148:151], v[168:171], v[40:43]
    v_mfma_f32_16x16x32_bf16 v[56:59], v[152:155], v[168:171], v[56:59]
    v_mfma_f32_16x16x32_bf16 v[72:75], v[156:159], v[168:171], v[72:75]
    v_mfma_f32_16x16x32_bf16 v[76:79], v[156:159], v[172:175], v[76:79]
    v_mfma_f32_16x16x32_bf16 v[60:63], v[152:155], v[172:175], v[60:63]
    v_mfma_f32_16x16x32_bf16 v[44:47], v[148:151], v[172:175], v[44:47]
    v_mfma_f32_16x16x32_bf16 v[28:31], v[144:147], v[172:175], v[28:31]
    s_waitcnt lgkmcnt(0)
    s_barrier
    v_mfma_f32_16x16x32_bf16 v[16:19], v[176:179], v[192:195], v[16:19]
    ds_read_b128 v[160:163], v12 offset:16384
    ds_read_b64_tr_b16 v[144:145], v8 offset:0
    v_mfma_f32_16x16x32_bf16 v[32:35], v[180:183], v[192:195], v[32:35]
    ds_read_b64_tr_b16 v[146:147], v8 offset:1024
    ds_read_b128 v[164:167], v12 offset:18432
    v_mfma_f32_16x16x32_bf16 v[48:51], v[184:187], v[192:195], v[48:51]
    ds_read_b64_tr_b16 v[148:149], v9 offset:0
    ds_read_b64_tr_b16 v[150:151], v9 offset:1024
    v_mfma_f32_16x16x32_bf16 v[64:67], v[188:191], v[192:195], v[64:67]
    ds_read_b128 v[168:171], v12 offset:20480
    ds_read_b64_tr_b16 v[152:153], v10 offset:0
    v_mfma_f32_16x16x32_bf16 v[68:71], v[188:191], v[196:199], v[68:71]
    ds_read_b64_tr_b16 v[154:155], v10 offset:1024
    ds_read_b128 v[172:175], v12 offset:22528
    v_mfma_f32_16x16x32_bf16 v[52:55], v[184:187], v[196:199], v[52:55]
    ds_read_b64_tr_b16 v[156:157], v11 offset:0
    ds_read_b64_tr_b16 v[158:159], v11 offset:1024
    v_mfma_f32_16x16x32_bf16 v[36:39], v[180:183], v[196:199], v[36:39]
    v_mfma_f32_16x16x32_bf16 v[20:23], v[176:179], v[196:199], v[20:23]
    v_mfma_f32_16x16x32_bf16 v[24:27], v[176:179], v[200:203], v[24:27]
    v_mfma_f32_16x16x32_bf16 v[40:43], v[180:183], v[200:203], v[40:43]
    v_mfma_f32_16x16x32_bf16 v[56:59], v[184:187], v[200:203], v[56:59]
    v_mfma_f32_16x16x32_bf16 v[72:75], v[188:191], v[200:203], v[72:75]
    v_mfma_f32_16x16x32_bf16 v[76:79], v[188:191], v[204:207], v[76:79]
    v_mfma_f32_16x16x32_bf16 v[60:63], v[184:187], v[204:207], v[60:63]
    v_mfma_f32_16x16x32_bf16 v[44:47], v[180:183], v[204:207], v[44:47]
    v_mfma_f32_16x16x32_bf16 v[28:31], v[176:179], v[204:207], v[28:31]
    s_waitcnt lgkmcnt(0)
    v_mfma_f32_16x16x32_bf16 v[16:19], v[144:147], v[160:163], v[16:19]
    ds_read_b128 v[192:195], v13 offset:16384
    ds_read_b64_tr_b16 v[176:177], v8 offset:8192
    v_mfma_f32_16x16x32_bf16 v[32:35], v[148:151], v[160:163], v[32:35]
    ds_read_b64_tr_b16 v[178:179], v8 offset:9216
    ds_read_b128 v[196:199], v13 offset:18432
    v_mfma_f32_16x16x32_bf16 v[48:51], v[152:155], v[160:163], v[48:51]
    ds_read_b64_tr_b16 v[180:181], v9 offset:8192
    ds_read_b64_tr_b16 v[182:183], v9 offset:9216
    v_mfma_f32_16x16x32_bf16 v[64:67], v[156:159], v[160:163], v[64:67]
    ds_read_b128 v[200:203], v13 offset:20480
    ds_read_b64_tr_b16 v[184:185], v10 offset:8192
    v_mfma_f32_16x16x32_bf16 v[68:71], v[156:159], v[164:167], v[68:71]
    ds_read_b64_tr_b16 v[186:187], v10 offset:9216
    ds_read_b128 v[204:207], v13 offset:22528
    v_mfma_f32_16x16x32_bf16 v[52:55], v[152:155], v[164:167], v[52:55]
    ds_read_b64_tr_b16 v[188:189], v11 offset:8192
    ds_read_b64_tr_b16 v[190:191], v11 offset:9216
    v_mfma_f32_16x16x32_bf16 v[36:39], v[148:151], v[164:167], v[36:39]
    v_mfma_f32_16x16x32_bf16 v[20:23], v[144:147], v[164:167], v[20:23]
    v_mfma_f32_16x16x32_bf16 v[24:27], v[144:147], v[168:171], v[24:27]
    v_mfma_f32_16x16x32_bf16 v[40:43], v[148:151], v[168:171], v[40:43]
    v_mfma_f32_16x16x32_bf16 v[56:59], v[152:155], v[168:171], v[56:59]
    v_mfma_f32_16x16x32_bf16 v[72:75], v[156:159], v[168:171], v[72:75]
    v_mfma_f32_16x16x32_bf16 v[76:79], v[156:159], v[172:175], v[76:79]
    v_mfma_f32_16x16x32_bf16 v[60:63], v[152:155], v[172:175], v[60:63]
    v_mfma_f32_16x16x32_bf16 v[44:47], v[148:151], v[172:175], v[44:47]
    v_mfma_f32_16x16x32_bf16 v[28:31], v[144:147], v[172:175], v[28:31]
    s_waitcnt lgkmcnt(0)
    s_barrier
    v_mfma_f32_16x16x32_bf16 v[16:19], v[176:179], v[192:195], v[16:19]
    ds_read_b128 v[160:163], v12 offset:49152
    ds_read_b64_tr_b16 v[144:145], v8 offset:32768
    v_mfma_f32_16x16x32_bf16 v[32:35], v[180:183], v[192:195], v[32:35]
    ds_read_b64_tr_b16 v[146:147], v8 offset:33792
    ds_read_b128 v[164:167], v12 offset:51200
    v_mfma_f32_16x16x32_bf16 v[48:51], v[184:187], v[192:195], v[48:51]
    ds_read_b64_tr_b16 v[148:149], v9 offset:32768
    ds_read_b64_tr_b16 v[150:151], v9 offset:33792
    v_mfma_f32_16x16x32_bf16 v[64:67], v[188:191], v[192:195], v[64:67]
    ds_read_b128 v[168:171], v12 offset:53248
    ds_read_b64_tr_b16 v[152:153], v10 offset:32768
    v_mfma_f32_16x16x32_bf16 v[68:71], v[188:191], v[196:199], v[68:71]
    ds_read_b64_tr_b16 v[154:155], v10 offset:33792
    ds_read_b128 v[172:175], v12 offset:55296
    v_mfma_f32_16x16x32_bf16 v[52:55], v[184:187], v[196:199], v[52:55]
    ds_read_b64_tr_b16 v[156:157], v11 offset:32768
    ds_read_b64_tr_b16 v[158:159], v11 offset:33792
    v_mfma_f32_16x16x32_bf16 v[36:39], v[180:183], v[196:199], v[36:39]
    v_mfma_f32_16x16x32_bf16 v[20:23], v[176:179], v[196:199], v[20:23]
    v_mfma_f32_16x16x32_bf16 v[24:27], v[176:179], v[200:203], v[24:27]
    v_mfma_f32_16x16x32_bf16 v[40:43], v[180:183], v[200:203], v[40:43]
    v_mfma_f32_16x16x32_bf16 v[56:59], v[184:187], v[200:203], v[56:59]
    v_mfma_f32_16x16x32_bf16 v[72:75], v[188:191], v[200:203], v[72:75]
    v_mfma_f32_16x16x32_bf16 v[76:79], v[188:191], v[204:207], v[76:79]
    v_mfma_f32_16x16x32_bf16 v[60:63], v[184:187], v[204:207], v[60:63]
    v_mfma_f32_16x16x32_bf16 v[44:47], v[180:183], v[204:207], v[44:47]
    v_mfma_f32_16x16x32_bf16 v[28:31], v[176:179], v[204:207], v[28:31]
    s_waitcnt lgkmcnt(0)
    v_mfma_f32_16x16x32_bf16 v[16:19], v[144:147], v[160:163], v[16:19]
    ds_read_b128 v[192:195], v13 offset:49152
    ds_read_b64_tr_b16 v[176:177], v8 offset:40960
    v_mfma_f32_16x16x32_bf16 v[32:35], v[148:151], v[160:163], v[32:35]
    ds_read_b64_tr_b16 v[178:179], v8 offset:41984
    ds_read_b128 v[196:199], v13 offset:51200
    v_mfma_f32_16x16x32_bf16 v[48:51], v[152:155], v[160:163], v[48:51]
    ds_read_b64_tr_b16 v[180:181], v9 offset:40960
    ds_read_b64_tr_b16 v[182:183], v9 offset:41984
    v_mfma_f32_16x16x32_bf16 v[64:67], v[156:159], v[160:163], v[64:67]
    ds_read_b128 v[200:203], v13 offset:53248
    ds_read_b64_tr_b16 v[184:185], v10 offset:40960
    v_mfma_f32_16x16x32_bf16 v[68:71], v[156:159], v[164:167], v[68:71]
    ds_read_b64_tr_b16 v[186:187], v10 offset:41984
    ds_read_b128 v[204:207], v13 offset:55296
    v_mfma_f32_16x16x32_bf16 v[52:55], v[152:155], v[164:167], v[52:55]
    ds_read_b64_tr_b16 v[188:189], v11 offset:40960
    ds_read_b64_tr_b16 v[190:191], v11 offset:41984
    v_xor_b32 v8, s40, v8
    v_mfma_f32_16x16x32_bf16 v[36:39], v[148:151], v[164:167], v[36:39]
    v_xor_b32 v9, s40, v9
    v_xor_b32 v10, s40, v10
    v_mfma_f32_16x16x32_bf16 v[20:23], v[144:147], v[164:167], v[20:23]
    v_xor_b32 v11, s40, v11
    v_xor_b32 v12, s40, v12
    v_mfma_f32_16x16x32_bf16 v[24:27], v[144:147], v[168:171], v[24:27]
    v_xor_b32 v13, s40, v13
    v_mfma_f32_16x16x32_bf16 v[40:43], v[148:151], v[168:171], v[40:43]
    v_mfma_f32_16x16x32_bf16 v[56:59], v[152:155], v[168:171], v[56:59]
    v_mfma_f32_16x16x32_bf16 v[72:75], v[156:159], v[168:171], v[72:75]
    v_mfma_f32_16x16x32_bf16 v[76:79], v[156:159], v[172:175], v[76:79]
    v_mfma_f32_16x16x32_bf16 v[60:63], v[152:155], v[172:175], v[60:63]
    v_mfma_f32_16x16x32_bf16 v[44:47], v[148:151], v[172:175], v[44:47]
    v_mfma_f32_16x16x32_bf16 v[28:31], v[144:147], v[172:175], v[28:31]
    s_sub_u32 s39, s39, 1
    s_cmp_lg_u32 s39, 0
    s_waitcnt lgkmcnt(0)
    s_cbranch_scc1 L_p1loop
    s_barrier
    v_mfma_f32_16x16x32_bf16 v[16:19], v[176:179], v[192:195], v[16:19]
    ds_read_b128 v[160:163], v12 offset:16384
    ds_read_b64_tr_b16 v[144:145], v8 offset:0
    v_mfma_f32_16x16x32_bf16 v[32:35], v[180:183], v[192:195], v[32:35]
    ds_read_b64_tr_b16 v[146:147], v8 offset:1024
    ds_read_b128 v[164:167], v12 offset:18432
    v_mfma_f32_16x16x32_bf16 v[48:51], v[184:187], v[192:195], v[48:51]
    ds_read_b64_tr_b16 v[148:149], v9 offset:0
    ds_read_b64_tr_b16 v[150:151], v9 offset:1024
    v_mfma_f32_16x16x32_bf16 v[64:67], v[188:191], v[192:195], v[64:67]
    ds_read_b128 v[168:171], v12 offset:20480
    ds_read_b64_tr_b16 v[152:153], v10 offset:0
    v_mfma_f32_16x16x32_bf16 v[68:71], v[188:191], v[196:199], v[68:71]
    ds_read_b64_tr_b16 v[154:155], v10 offset:1024
    ds_read_b128 v[172:175], v12 offset:22528
    v_mfma_f32_16x16x32_bf16 v[52:55], v[184:187], v[196:199], v[52:55]
    ds_read_b64_tr_b16 v[156:157], v11 offset:0
    ds_read_b64_tr_b16 v[158:159], v11 offset:1024
    v_mfma_f32_16x16x32_bf16 v[36:39], v[180:183], v[196:199], v[36:39]
    v_mfma_f32_16x16x32_bf16 v[20:23], v[176:179], v[196:199], v[20:23]
    v_mfma_f32_16x16x32_bf16 v[24:27], v[176:179], v[200:203], v[24:27]
    v_mfma_f32_16x16x32_bf16 v[40:43], v[180:183], v[200:203], v[40:43]
    v_mfma_f32_16x16x32_bf16 v[56:59], v[184:187], v[200:203], v[56:59]
    v_mfma_f32_16x16x32_bf16 v[72:75], v[188:191], v[200:203], v[72:75]
    v_mfma_f32_16x16x32_bf16 v[76:79], v[188:191], v[204:207], v[76:79]
    v_mfma_f32_16x16x32_bf16 v[60:63], v[184:187], v[204:207], v[60:63]
    v_mfma_f32_16x16x32_bf16 v[44:47], v[180:183], v[204:207], v[44:47]
    v_mfma_f32_16x16x32_bf16 v[28:31], v[176:179], v[204:207], v[28:31]
    s_waitcnt lgkmcnt(0)
    v_pk_mul_f32 v[208:209], v[20:21], v[20:21]
    v_pk_mul_f32 v[210:211], v[22:23], v[22:23]
    v_pk_mul_f32 v[212:213], v[24:25], v[24:25]
    v_pk_mul_f32 v[214:215], v[26:27], v[26:27]
    v_pk_fma_f32 v[208:209], v[208:209], s[42:43], v[14:15]
    v_pk_fma_f32 v[210:211], v[210:211], s[42:43], v[14:15]
    v_pk_fma_f32 v[212:213], v[212:213], s[42:43], v[14:15]
    v_pk_fma_f32 v[214:215], v[214:215], s[42:43], v[14:15]
    v_pk_mul_f32 v[208:209], v[208:209], v[20:21]
    v_pk_mul_f32 v[210:211], v[210:211], v[22:23]
    v_pk_mul_f32 v[212:213], v[212:213], v[24:25]
    v_pk_mul_f32 v[214:215], v[214:215], v[26:27]
    v_exp_f32 v208, v208
    v_exp_f32 v209, v209
    v_exp_f32 v210, v210
    v_exp_f32 v211, v211
    v_exp_f32 v212, v212
    v_exp_f32 v213, v213
    v_exp_f32 v214, v214
    v_exp_f32 v215, v215
    v_pk_add_f32 v[208:209], v[208:209], 1.0 op_sel_hi:[1,0]
    v_pk_add_f32 v[210:211], v[210:211], 1.0 op_sel_hi:[1,0]
    v_pk_add_f32 v[212:213], v[212:213], 1.0 op_sel_hi:[1,0]
    v_pk_add_f32 v[214:215], v[214:215], 1.0 op_sel_hi:[1,0]
    v_rcp_f32 v208, v208
    v_rcp_f32 v209, v209
    v_rcp_f32 v210, v210
    v_rcp_f32 v211, v211
    v_rcp_f32 v212, v212
    v_rcp_f32 v213, v213
    v_rcp_f32 v214, v214
    v_rcp_f32 v215, v215
    v_pk_mul_f32 v[20:21], v[20:21], v[208:209]
    v_pk_mul_f32 v[22:23], v[22:23], v[210:211]
    v_pk_mul_f32 v[24:25], v[24:25], v[212:213]
    v_pk_mul_f32 v[26:27], v[26:27], v[214:215]
    v_pk_mul_f32 v[208:209], v[28:29], v[28:29]
    v_pk_mul_f32 v[210:211], v[30:31], v[30:31]
    v_pk_fma_f32 v[208:209], v[208:209], s[42:43], v[14:15]
    v_pk_fma_f32 v[210:211], v[210:211], s[42:43], v[14:15]
    v_pk_mul_f32 v[208:209], v[208:209], v[28:29]
    v_pk_mul_f32 v[210:211], v[210:211], v[30:31]
    v_exp_f32 v208, v208
    v_exp_f32 v209, v209
    v_exp_f32 v210, v210
    v_exp_f32 v211, v211
    v_pk_add_f32 v[208:209], v[208:209], 1.0 op_sel_hi:[1,0]
    v_pk_add_f32 v[210:211], v[210:211], 1.0 op_sel_hi:[1,0]
    v_rcp_f32 v208, v208
    v_rcp_f32 v209, v209
    v_rcp_f32 v210, v210
    v_rcp_f32 v211, v211
    v_pk_mul_f32 v[28:29], v[28:29], v[208:209]
    v_pk_mul_f32 v[30:31], v[30:31], v[210:211]
    v_pk_add_f32 v[218:219], v[20:21], v[22:23]
    v_pk_mul_f32 v[226:227], v[20:21], v[20:21]
    v_pk_fma_f32 v[226:227], v[22:23], v[22:23], v[226:227]
    v_pk_add_f32 v[220:221], v[24:25], v[26:27]
    v_pk_mul_f32 v[228:229], v[24:25], v[24:25]
    v_pk_fma_f32 v[228:229], v[26:27], v[26:27], v[228:229]
    v_pk_add_f32 v[222:223], v[28:29], v[30:31]
    v_pk_mul_f32 v[230:231], v[28:29], v[28:29]
    v_pk_fma_f32 v[230:231], v[30:31], v[30:31], v[230:231]
    v_mfma_f32_16x16x32_bf16 v[80:83], v[144:147], v[160:163], 0
    ds_read_b128 v[192:195], v13 offset:16384
    v_mul_f32 v232, v16, v16
    v_mfma_f32_16x16x32_bf16 v[96:99], v[148:151], v[160:163], 0
    ds_read_b64_tr_b16 v[176:177], v8 offset:8192
    v_mul_f32 v233, v17, v17
    v_mfma_f32_16x16x32_bf16 v[112:115], v[152:155], v[160:163], 0
    ds_read_b64_tr_b16 v[178:179], v8 offset:9216
    v_mul_f32 v234, v18, v18
    v_mfma_f32_16x16x32_bf16 v[128:131], v[156:159], v[160:163], 0
    ds_read_b128 v[196:199], v13 offset:18432
    v_mul_f32 v235, v19, v19
    v_mfma_f32_16x16x32_bf16 v[132:135], v[156:159], v[164:167], 0
    ds_read_b64_tr_b16 v[180:181], v9 offset:8192
    v_fma_f32 v232, v232, s42, v14
    v_mfma_f32_16x16x32_bf16 v[116:119], v[152:155], v[164:167], 0
    ds_read_b64_tr_b16 v[182:183], v9 offset:9216
    v_fma_f32 v233, v233, s42, v14
    v_mfma_f32_16x16x32_bf16 v[100:103], v[148:151], v[164:167], 0
    ds_read_b128 v[200:203], v13 offset:20480
    v_fma_f32 v234, v234, s42, v14
    v_mfma_f32_16x16x32_bf16 v[84:87], v[144:147], v[164:167], 0
    ds_read_b64_tr_b16 v[184:185], v10 offset:8192
    v_fma_f32 v235, v235, s42, v14
    v_mfma_f32_16x16x32_bf16 v[88:91], v[144:147], v[168:171], 0
    ds_read_b64_tr_b16 v[186:187], v10 offset:9216
    v_mul_f32 v232, v232, v16
    v_mfma_f32_16x16x32_bf16 v[104:107], v[148:151], v[168:171], 0
    ds_read_b128 v[204:207], v13 offset:22528
    v_mul_f32 v233, v233, v17
    v_mfma_f32_16x16x32_bf16 v[120:123], v[152:155], v[168:171], 0
    ds_read_b64_tr_b16 v[188:189], v11 offset:8192
    v_mul_f32 v234, v234, v18
    v_mfma_f32_16x16x32_bf16 v[136:139], v[156:159], v[168:171], 0
    ds_read_b64_tr_b16 v[190:191], v11 offset:9216
    v_mul_f32 v235, v235, v19
    v_exp_f32 v232, v232
    v_exp_f32 v233, v233
    v_mfma_f32_16x16x32_bf16 v[140:143], v[156:159], v[172:175], 0
    v_exp_f32 v234, v234
    v_exp_f32 v235, v235
    v_add_f32 v232, 1.0, v232
    v_mfma_f32_16x16x32_bf16 v[124:127], v[152:155], v[172:175], 0
    v_add_f32 v233, 1.0, v233
    v_add_f32 v234, 1.0, v234
    v_add_f32 v235, 1.0, v235
    v_rcp_f32 v232, v232
    v_rcp_f32 v233, v233
    v_mfma_f32_16x16x32_bf16 v[108:111], v[148:151], v[172:175], 0
    v_rcp_f32 v234, v234
    v_rcp_f32 v235, v235
    v_mul_f32 v16, v16, v232
    v_mul_f32 v17, v17, v233
    v_mfma_f32_16x16x32_bf16 v[92:95], v[144:147], v[172:175], 0
    v_mul_f32 v18, v18, v234
    v_mul_f32 v19, v19, v235
    v_add_f32 v216, v16, v18
    v_mul_f32 v224, v16, v16
    v_add_f32 v217, v17, v19
    v_mul_f32 v225, v17, v17
    v_fmac_f32 v224, v18, v18
    v_fmac_f32 v225, v19, v19
    s_waitcnt lgkmcnt(0)
    s_barrier
    v_mfma_f32_16x16x32_bf16 v[80:83], v[176:179], v[192:195], v[80:83]
    ds_read_b128 v[160:163], v12 offset:49152
    v_mul_f32 v232, v32, v32
    v_mfma_f32_16x16x32_bf16 v[96:99], v[180:183], v[192:195], v[96:99]
    ds_read_b64_tr_b16 v[144:145], v8 offset:32768
    v_mul_f32 v233, v33, v33
    v_mfma_f32_16x16x32_bf16 v[112:115], v[184:187], v[192:195], v[112:115]
    ds_read_b64_tr_b16 v[146:147], v8 offset:33792
    v_mul_f32 v234, v34, v34
    v_mfma_f32_16x16x32_bf16 v[128:131], v[188:191], v[192:195], v[128:131]
    ds_read_b128 v[164:167], v12 offset:51200
    v_mul_f32 v235, v35, v35
    v_mfma_f32_16x16x32_bf16 v[132:135], v[188:191], v[196:199], v[132:135]
    ds_read_b64_tr_b16 v[148:149], v9 offset:32768
    v_fma_f32 v232, v232, s42, v14
    v_mfma_f32_16x16x32_bf16 v[116:119], v[184:187], v[196:199], v[116:119]
    ds_read_b64_tr_b16 v[150:151], v9 offset:33792
    v_fma_f32 v233, v233, s42, v14
    v_mfma_f32_16x16x32_bf16 v[100:103], v[180:183], v[196:199], v[100:103]
    ds_read_b128 v[168:171], v12 offset:53248
    v_fma_f32 v234, v234, s42, v14
    v_mfma_f32_16x16x32_bf16 v[84:87], v[176:179], v[196:199], v[84:87]
    ds_read_b64_tr_b16 v[152:153], v10 offset:32768
    v_fma_f32 v235, v235, s42, v14
    v_mfma_f32_16x16x32_bf16 v[88:91], v[176:179], v[200:203], v[88:91]
    ds_read_b64_tr_b16 v[154:155], v10 offset:33792
    v_mul_f32 v232, v232, v32
    v_mfma_f32_16x16x32_bf16 v[104:107], v[180:183], v[200:203], v[104:107]
    ds_read_b128 v[172:175], v12 offset:55296
    v_mul_f32 v233, v233, v33
    v_mfma_f32_16x16x32_bf16 v[120:123], v[184:187], v[200:203], v[120:123]
    ds_read_b64_tr_b16 v[156:157], v11 offset:32768
    v_mul_f32 v234, v234, v34
    v_mfma_f32_16x16x32_bf16 v[136:139], v[188:191], v[200:203], v[136:139]
L_pad_3:
    s_cmp_eq_u32 s99, 1
    s_cbranch_scc1 L_padret_3
    ds_read_b64_tr_b16 v[158:159], v11 offset:33792
    v_mul_f32 v235, v235, v35
    v_exp_f32 v232, v232
    v_mfma_f32_16x16x32_bf16 v[140:143], v[188:191], v[204:207], v[140:143]
    v_exp_f32 v233, v233
    v_mfma_f32_16x16x32_bf16 v[124:127], v[184:187], v[204:207], v[124:127]
    v_exp_f32 v234, v234
    v_mfma_f32_16x16x32_bf16 v[108:111], v[180:183], v[204:207], v[108:111]
    v_exp_f32 v235, v235
    v_mfma_f32_16x16x32_bf16 v[92:95], v[176:179], v[204:207], v[92:95]
    v_add_f32 v232, 1.0, v232
    v_add_f32 v233, 1.0, v233
    s_waitcnt lgkmcnt(0)
    v_pk_mul_f32 v[208:209], v[36:37], v[36:37]
    v_pk_mul_f32 v[210:211], v[38:39], v[38:39]
    v_pk_mul_f32 v[212:213], v[40:41], v[40:41]
    v_pk_mul_f32 v[214:215], v[42:43], v[42:43]
    v_pk_fma_f32 v[208:209], v[208:209], s[42:43], v[14:15]
    v_pk_fma_f32 v[210:211], v[210:211], s[42:43], v[14:15]
    v_pk_fma_f32 v[212:213], v[212:213], s[42:43], v[14:15]
    v_pk_fma_f32 v[214:215], v[214:215], s[42:43], v[14:15]
    v_pk_mul_f32 v[208:209], v[208:209], v[36:37]
    v_pk_mul_f32 v[210:211], v[210:211], v[38:39]
    v_pk_mul_f32 v[212:213], v[212:213], v[40:41]
    v_pk_mul_f32 v[214:215], v[214:215], v[42:43]
    v_exp_f32 v208, v208
    v_exp_f32 v209, v209
    v_exp_f32 v210, v210
    v_exp_f32 v211, v211
    v_exp_f32 v212, v212
    v_exp_f32 v213, v213
    v_exp_f32 v214, v214
    v_exp_f32 v215, v215
    v_pk_add_f32 v[208:209], v[208:209], 1.0 op_sel_hi:[1,0]
    v_pk_add_f32 v[210:211], v[210:211], 1.0 op_sel_hi:[1,0]
    v_pk_add_f32 v[212:213], v[212:213], 1.0 op_sel_hi:[1,0]
    v_pk_add_f32 v[214:215], v[214:215], 1.0 op_sel_hi:[1,0]
    v_rcp_f32 v208, v208
    v_rcp_f32 v209, v209
    v_rcp_f32 v210, v210
    v_rcp_f32 v211, v211
    v_rcp_f32 v212, v212
    v_rcp_f32 v213, v213
    v_rcp_f32 v214, v214
    v_rcp_f32 v215, v215
    v_pk_mul_f32 v[36:37], v[36:37], v[208:209]
    v_pk_mul_f32 v[38:39], v[38:39], v[210:211]
    v_pk_mul_f32 v[40:41], v[40:41], v[212:213]
    v_pk_mul_f32 v[42:43], v[42:43], v[214:215]
    v_pk_mul_f32 v[208:209], v[44:45], v[44:45]
    v_pk_mul_f32 v[210:211], v[46:47], v[46:47]
    v_pk_fma_f32 v[208:209], v[208:209], s[42:43], v[14:15]
    v_pk_fma_f32 v[210:211], v[210:211], s[42:43], v[14:15]
    v_pk_mul_f32 v[208:209], v[208:209], v[44:45]
    v_pk_mul_f32 v[210:211], v[210:211], v[46:47]
    v_exp_f32 v208, v208
    v_exp_f32 v209, v209
    v_exp_f32 v210, v210
    v_exp_f32 v211, v211
    v_pk_add_f32 v[208:209], v[208:209], 1.0 op_sel_hi:[1,0]
    v_pk_add_f32 v[210:211], v[210:211], 1.0 op_sel_hi:[1,0]
    v_rcp_f32 v208, v208
    v_rcp_f32 v209, v209
    v_rcp_f32 v210, v210
    v_rcp_f32 v211, v211
    v_pk_mul_f32 v[44:45], v[44:45], v[208:209]
    v_pk_mul_f32 v[46:47], v[46:47], v[210:211]
    v_pk_add_f32 v[218:219], v[218:219], v[36:37]
    v_pk_fma_f32 v[226:227], v[36:37], v[36:37], v[226:227]
    v_pk_add_f32 v[218:219], v[218:219], v[38:39]
    v_pk_fma_f32 v[226:227], v[38:39], v[38:39], v[226:227]
    v_pk_add_f32 v[220:221], v[220:221], v[40:41]
    v_pk_fma_f32 v[228:229], v[40:41], v[40:41], v[228:229]
    v_pk_add_f32 v[220:221], v[220:221], v[42:43]
    v_pk_fma_f32 v[228:229], v[42:43], v[42:43], v[228:229]
    v_pk_add_f32 v[222:223], v[222:223], v[44:45]
    v_pk_fma_f32 v[230:231], v[44:45], v[44:45], v[230:231]
    v_pk_add_f32 v[222:223], v[222:223], v[46:47]
    v_pk_fma_f32 v[230:231], v[46:47], v[46:47], v[230:231]
    v_mfma_f32_16x16x32_bf16 v[80:83], v[144:147], v[160:163], v[80:83]
    ds_read_b128 v[192:195], v13 offset:49152
    v_add_f32 v234, 1.0, v234
    v_mfma_f32_16x16x32_bf16 v[96:99], v[148:151], v[160:163], v[96:99]
    ds_read_b64_tr_b16 v[176:177], v8 offset:40960
    v_add_f32 v235, 1.0, v235
    v_mfma_f32_16x16x32_bf16 v[112:115], v[152:155], v[160:163], v[112:115]
    ds_read_b64_tr_b16 v[178:179], v8 offset:41984
    v_rcp_f32 v232, v232
    v_mfma_f32_16x16x32_bf16 v[128:131], v[156:159], v[160:163], v[128:131]
    ds_read_b128 v[196:199], v13 offset:51200
    v_rcp_f32 v233, v233
    v_mfma_f32_16x16x32_bf16 v[132:135], v[156:159], v[164:167], v[132:135]
    ds_read_b64_tr_b16 v[180:181], v9 offset:40960
    v_rcp_f32 v234, v234
    v_mfma_f32_16x16x32_bf16 v[116:119], v[152:155], v[164:167], v[116:119]
    ds_read_b64_tr_b16 v[182:183], v9 offset:41984
    v_rcp_f32 v235, v235
    v_mfma_f32_16x16x32_bf16 v[100:103], v[148:151], v[164:167], v[100:103]
    ds_read_b128 v[200:203], v13 offset:53248
    v_mul_f32 v32, v32, v232
    v_mfma_f32_16x16x32_bf16 v[84:87], v[144:147], v[164:167], v[84:87]
    ds_read_b64_tr_b16 v[184:185], v10 offset:40960
    v_mul_f32 v33, v33, v233
    v_mfma_f32_16x16x32_bf16 v[88:91], v[144:147], v[168:171], v[88:91]
    ds_read_b64_tr_b16 v[186:187], v10 offset:41984
    v_mul_f32 v34, v34, v234
    v_mfma_f32_16x16x32_bf16 v[104:107], v[148:151], v[168:171], v[104:107]
    ds_read_b128 v[204:207], v13 offset:55296
    v_mul_f32 v35, v35, v235
    v_mfma_f32_16x16x32_bf16 v[120:123], v[152:155], v[168:171], v[120:123]
    ds_read_b64_tr_b16 v[188:189], v11 offset:40960
    v_add_f32 v216, v216, v32
    v_mfma_f32_16x16x32_bf16 v[136:139], v[156:159], v[168:171], v[136:139]
    ds_read_b64_tr_b16 v[190:191], v11 offset:41984
    v_xor_b32 v8, s40, v8
    v_xor_b32 v9, s40, v9
    v_xor_b32 v10, s40, v10
    v_mfma_f32_16x16x32_bf16 v[140:143], v[156:159], v[172:175], v[140:143]
    v_xor_b32 v11, s40, v11
    v_xor_b32 v12, s40, v12
    v_xor_b32 v13, s40, v13
    v_mfma_f32_16x16x32_bf16 v[124:127], v[152:155], v[172:175], v[124:127]
    v_fmac_f32 v224, v32, v32
    v_add_f32 v217, v217, v33
    v_fmac_f32 v225, v33, v33
    v_mfma_f32_16x16x32_bf16 v[108:111], v[148:151], v[172:175], v[108:111]
    v_add_f32 v216, v216, v34
    v_fmac_f32 v224, v34, v34
    v_mfma_f32_16x16x32_bf16 v[92:95], v[144:147], v[172:175], v[92:95]
    v_add_f32 v217, v217, v35
    v_fmac_f32 v225, v35, v35
    s_waitcnt lgkmcnt(0)
    s_barrier
    v_mfma_f32_16x16x32_bf16 v[80:83], v[176:179], v[192:195], v[80:83]
    ds_read_b128 v[160:163], v12 offset:16384
    v_mul_f32 v232, v48, v48
    v_mfma_f32_16x16x32_bf16 v[96:99], v[180:183], v[192:195], v[96:99]
    ds_read_b64_tr_b16 v[144:145], v8 offset:0
    v_mul_f32 v233, v49, v49
    v_mfma_f32_16x16x32_bf16 v[112:115], v[184:187], v[192:195], v[112:115]
    ds_read_b64_tr_b16 v[146:147], v8 offset:1024
    v_mul_f32 v234, v50, v50
    v_mfma_f32_16x16x32_bf16 v[128:131], v[188:191], v[192:195], v[128:131]
    ds_read_b128 v[164:167], v12 offset:18432
    v_mul_f32 v235, v51, v51
    v_mfma_f32_16x16x32_bf16 v[132:135], v[188:191], v[196:199], v[132:135]
    ds_read_b64_tr_b16 v[148:149], v9 offset:0
    v_fma_f32 v232, v232, s42, v14
    v_mfma_f32_16x16x32_bf16 v[116:119], v[184:187], v[196:199], v[116:119]
    ds_read_b64_tr_b16 v[150:151], v9 offset:1024
    v_fma_f32 v233, v233, s42, v14
    v_mfma_f32_16x16x32_bf16 v[100:103], v[180:183], v[196:199], v[100:103]
    ds_read_b128 v[168:171], v12 offset:20480
    v_fma_f32 v234, v234, s42, v14
    v_mfma_f32_16x16x32_bf16 v[84:87], v[176:179], v[196:199], v[84:87]
    ds_read_b64_tr_b16 v[152:153], v10 offset:0
    v_fma_f32 v235, v235, s42, v14
    v_mfma_f32_16x16x32_bf16 v[88:91], v[176:179], v[200:203], v[88:91]
    ds_read_b64_tr_b16 v[154:155], v10 offset:1024
    v_mul_f32 v232, v232, v48
    v_mfma_f32_16x16x32_bf16 v[104:107], v[180:183], v[200:203], v[104:107]
    ds_read_b128 v[172:175], v12 offset:22528
    v_mul_f32 v233, v233, v49
    v_mfma_f32_16x16x32_bf16 v[120:123], v[184:187], v[200:203], v[120:123]
    ds_read_b64_tr_b16 v[156:157], v11 offset:0
    v_mul_f32 v234, v234, v50
    v_mfma_f32_16x16x32_bf16 v[136:139], v[188:191], v[200:203], v[136:139]
    ds_read_b64_tr_b16 v[158:159], v11 offset:1024
    v_mul_f32 v235, v235, v51
    v_exp_f32 v232, v232
    v_mfma_f32_16x16x32_bf16 v[140:143], v[188:191], v[204:207], v[140:143]
    v_exp_f32 v233, v233
    v_mfma_f32_16x16x32_bf16 v[124:127], v[184:187], v[204:207], v[124:127]
    v_exp_f32 v234, v234
    v_mfma_f32_16x16x32_bf16 v[108:111], v[180:183], v[204:207], v[108:111]
    v_exp_f32 v235, v235
    v_mfma_f32_16x16x32_bf16 v[92:95], v[176:179], v[204:207], v[92:95]
    v_add_f32 v232, 1.0, v232
    v_add_f32 v233, 1.0, v233
    s_waitcnt lgkmcnt(0)
    v_pk_mul_f32 v[208:209], v[52:53], v[52:53]
    v_pk_mul_f32 v[210:211], v[54:55], v[54:55]
    v_pk_mul_f32 v[212:213], v[56:57], v[56:57]
    v_pk_mul_f32 v[214:215], v[58:59], v[58:59]
    v_pk_fma_f32 v[208:209], v[208:209], s[42:43], v[14:15]
    v_pk_fma_f32 v[210:211], v[210:211], s[42:43], v[14:15]
    v_pk_fma_f32 v[212:213], v[212:213], s[42:43], v[14:15]
    v_pk_fma_f32 v[214:215], v[214:215], s[42:43], v[14:15]
    v_pk_mul_f32 v[208:209], v[208:209], v[52:53]
    v_pk_mul_f32 v[210:211], v[210:211], v[54:55]
    v_pk_mul_f32 v[212:213], v[212:213], v[56:57]
    v_pk_mul_f32 v[214:215], v[214:215], v[58:59]
    v_exp_f32 v208, v208
    v_exp_f32 v209, v209
    v_exp_f32 v210, v210
    v_exp_f32 v211, v211
    v_exp_f32 v212, v212
    v_exp_f32 v213, v213
    v_exp_f32 v214, v214
    v_exp_f32 v215, v215
    v_pk_add_f32 v[208:209], v[208:209], 1.0 op_sel_hi:[1,0]
    v_pk_add_f32 v[210:211], v[210:211], 1.0 op_sel_hi:[1,0]
    v_pk_add_f32 v[212:213], v[212:213], 1.0 op_sel_hi:[1,0]
    v_pk_add_f32 v[214:215], v[214:215], 1.0 op_sel_hi:[1,0]
    v_rcp_f32 v208, v208
    v_rcp_f32 v209, v209
    v_rcp_f32 v210, v210
    v_rcp_f32 v211, v211
    v_rcp_f32 v212, v212
    v_rcp_f32 v213, v213
    v_rcp_f32 v214, v214
    v_rcp_f32 v215, v215
    v_pk_mul_f32 v[52:53], v[52:53], v[208:209]
    v_pk_mul_f32 v[54:55], v[54:55], v[210:211]
    v_pk_mul_f32 v[56:57], v[56:57], v[212:213]
    v_pk_mul_f32 v[58:59], v[58:59], v[214:215]
    v_pk_mul_f32 v[208:209], v[60:61], v[60:61]
    v_pk_mul_f32 v[210:211], v[62:63], v[62:63]
    v_pk_fma_f32 v[208:209], v[208:209], s[42:43], v[14:15]
    v_pk_fma_f32 v[210:211], v[210:211], s[42:43], v[14:15]
    v_pk_mul_f32 v[208:209], v[208:209], v[60:61]
    v_pk_mul_f32 v[210:211], v[210:211], v[62:63]
    v_exp_f32 v208, v208
    v_exp_f32 v209, v209
    v_exp_f32 v210, v210
    v_exp_f32 v211, v211
    v_pk_add_f32 v[208:209], v[208:209], 1.0 op_sel_hi:[1,0]
    v_pk_add_f32 v[210:211], v[210:211], 1.0 op_sel_hi:[1,0]
    v_rcp_f32 v208, v208
    v_rcp_f32 v209, v209
    v_rcp_f32 v210, v210
    v_rcp_f32 v211, v211
    v_pk_mul_f32 v[60:61], v[60:61], v[208:209]
    v_pk_mul_f32 v[62:63], v[62:63], v[210:211]
    v_pk_add_f32 v[218:219], v[218:219], v[52:53]
    v_pk_fma_f32 v[226:227], v[52:53], v[52:53], v[226:227]
    v_pk_add_f32 v[218:219], v[218:219], v[54:55]
    v_pk_fma_f32 v[226:227], v[54:55], v[54:55], v[226:227]
    v_pk_add_f32 v[220:221], v[220:221], v[56:57]
    v_pk_fma_f32 v[228:229], v[56:57], v[56:57], v[228:229]
    v_pk_add_f32 v[220:221], v[220:221], v[58:59]
    v_pk_fma_f32 v[228:229], v[58:59], v[58:59], v[228:229]
    v_pk_add_f32 v[222:223], v[222:223], v[60:61]
    v_pk_fma_f32 v[230:231], v[60:61], v[60:61], v[230:231]
    v_pk_add_f32 v[222:223], v[222:223], v[62:63]
    v_pk_fma_f32 v[230:231], v[62:63], v[62:63], v[230:231]
    v_mfma_f32_16x16x32_bf16 v[80:83], v[144:147], v[160:163], v[80:83]
    ds_read_b128 v[192:195], v13 offset:16384
    v_add_f32 v234, 1.0, v234
    v_mfma_f32_16x16x32_bf16 v[96:99], v[148:151], v[160:163], v[96:99]
    ds_read_b64_tr_b16 v[176:177], v8 offset:8192
    v_add_f32 v235, 1.0, v235
    v_mfma_f32_16x16x32_bf16 v[112:115], v[152:155], v[160:163], v[112:115]
    ds_read_b64_tr_b16 v[178:179], v8 offset:9216
    v_rcp_f32 v232, v232
    v_mfma_f32_16x16x32_bf16 v[128:131], v[156:159], v[160:163], v[128:131]
    ds_read_b128 v[196:199], v13 offset:18432
    v_rcp_f32 v233, v233
    v_mfma_f32_16x16x32_bf16 v[132:135], v[156:159], v[164:167], v[132:135]
    ds_read_b64_tr_b16 v[180:181], v9 offset:8192
    v_rcp_f32 v234, v234
    v_mfma_f32_16x16x32_bf16 v[116:119], v[152:155], v[164:167], v[116:119]
    ds_read_b64_tr_b16 v[182:183], v9 offset:9216
    v_rcp_f32 v235, v235
    v_mfma_f32_16x16x32_bf16 v[100:103], v[148:151], v[164:167], v[100:103]
    ds_read_b128 v[200:203], v13 offset:20480
    v_mul_f32 v48, v48, v232
    v_mfma_f32_16x16x32_bf16 v[84:87], v[144:147], v[164:167], v[84:87]
    ds_read_b64_tr_b16 v[184:185], v10 offset:8192
    v_mul_f32 v49, v49, v233
    v_mfma_f32_16x16x32_bf16 v[88:91], v[144:147], v[168:171], v[88:91]
    ds_read_b64_tr_b16 v[186:187], v10 offset:9216
    v_mul_f32 v50, v50, v234
    v_mfma_f32_16x16x32_bf16 v[104:107], v[148:151], v[168:171], v[104:107]
    ds_read_b128 v[204:207], v13 offset:22528
    v_mul_f32 v51, v51, v235
    v_mfma_f32_16x16x32_bf16 v[120:123], v[152:155], v[168:171], v[120:123]
    ds_read_b64_tr_b16 v[188:189], v11 offset:8192
    v_add_f32 v216, v216, v48
    v_mfma_f32_16x16x32_bf16 v[136:139], v[156:159], v[168:171], v[136:139]
    ds_read_b64_tr_b16 v[190:191], v11 offset:9216
    v_fmac_f32 v224, v48, v48
    v_add_f32 v217, v217, v49
    v_mfma_f32_16x16x32_bf16 v[140:143], v[156:159], v[172:175], v[140:143]
    v_fmac_f32 v225, v49, v49
    v_add_f32 v216, v216, v50
    v_mfma_f32_16x16x32_bf16 v[124:127], v[152:155], v[172:175], v[124:127]
    v_fmac_f32 v224, v50, v50
    v_add_f32 v217, v217, v51
    v_mfma_f32_16x16x32_bf16 v[108:111], v[148:151], v[172:175], v[108:111]
    v_fmac_f32 v225, v51, v51
    v_mfma_f32_16x16x32_bf16 v[92:95], v[144:147], v[172:175], v[92:95]
    s_waitcnt lgkmcnt(0)
    s_barrier
    v_mfma_f32_16x16x32_bf16 v[80:83], v[176:179], v[192:195], v[80:83]
    ds_read_b128 v[160:163], v12 offset:49152
    v_mul_f32 v232, v64, v64
    v_mfma_f32_16x16x32_bf16 v[96:99], v[180:183], v[192:195], v[96:99]
    ds_read_b64_tr_b16 v[144:145], v8 offset:32768
    v_mul_f32 v233, v65, v65
    v_mfma_f32_16x16x32_bf16 v[112:115], v[184:187], v[192:195], v[112:115]
    ds_read_b64_tr_b16 v[146:147], v8 offset:33792
    v_mul_f32 v234, v66, v66
    v_mfma_f32_16x16x32_bf16 v[128:131], v[188:191], v[192:195], v[128:131]
    ds_read_b128 v[164:167], v12 offset:51200
    v_mul_f32 v235, v67, v67
    v_mfma_f32_16x16x32_bf16 v[132:135], v[188:191], v[196:199], v[132:135]
    ds_read_b64_tr_b16 v[148:149], v9 offset:32768
    v_fma_f32 v232, v232, s42, v14
    v_mfma_f32_16x16x32_bf16 v[116:119], v[184:187], v[196:199], v[116:119]
    ds_read_b64_tr_b16 v[150:151], v9 offset:33792
    v_fma_f32 v233, v233, s42, v14
    v_mfma_f32_16x16x32_bf16 v[100:103], v[180:183], v[196:199], v[100:103]
    ds_read_b128 v[168:171], v12 offset:53248
    v_fma_f32 v234, v234, s42, v14
    v_mfma_f32_16x16x32_bf16 v[84:87], v[176:179], v[196:199], v[84:87]
    ds_read_b64_tr_b16 v[152:153], v10 offset:32768
    v_fma_f32 v235, v235, s42, v14
    v_mfma_f32_16x16x32_bf16 v[88:91], v[176:179], v[200:203], v[88:91]
    ds_read_b64_tr_b16 v[154:155], v10 offset:33792
    v_mul_f32 v232, v232, v64
    v_mfma_f32_16x16x32_bf16 v[104:107], v[180:183], v[200:203], v[104:107]
    ds_read_b128 v[172:175], v12 offset:55296
    v_mul_f32 v233, v233, v65
    v_mfma_f32_16x16x32_bf16 v[120:123], v[184:187], v[200:203], v[120:123]
    ds_read_b64_tr_b16 v[156:157], v11 offset:32768
    v_mul_f32 v234, v234, v66
    v_mfma_f32_16x16x32_bf16 v[136:139], v[188:191], v[200:203], v[136:139]
    ds_read_b64_tr_b16 v[158:159], v11 offset:33792
    v_mul_f32 v235, v235, v67
    v_exp_f32 v232, v232
    v_mfma_f32_16x16x32_bf16 v[140:143], v[188:191], v[204:207], v[140:143]
    v_exp_f32 v233, v233
    v_mfma_f32_16x16x32_bf16 v[124:127], v[184:187], v[204:207], v[124:127]
    v_exp_f32 v234, v234
    v_mfma_f32_16x16x32_bf16 v[108:111], v[180:183], v[204:207], v[108:111]
    v_exp_f32 v235, v235
    v_mfma_f32_16x16x32_bf16 v[92:95], v[176:179], v[204:207], v[92:95]
    v_add_f32 v232, 1.0, v232
    v_add_f32 v233, 1.0, v233
    s_waitcnt lgkmcnt(0)
    v_pk_mul_f32 v[208:209], v[68:69], v[68:69]
    v_pk_mul_f32 v[210:211], v[70:71], v[70:71]
    v_pk_mul_f32 v[212:213], v[72:73], v[72:73]
    v_pk_mul_f32 v[214:215], v[74:75], v[74:75]
    v_pk_fma_f32 v[208:209], v[208:209], s[42:43], v[14:15]
    v_pk_fma_f32 v[210:211], v[210:211], s[42:43], v[14:15]
    v_pk_fma_f32 v[212:213], v[212:213], s[42:43], v[14:15]
    v_pk_fma_f32 v[214:215], v[214:215], s[42:43], v[14:15]
    v_pk_mul_f32 v[208:209], v[208:209], v[68:69]
    v_pk_mul_f32 v[210:211], v[210:211], v[70:71]
    v_pk_mul_f32 v[212:213], v[212:213], v[72:73]
    v_pk_mul_f32 v[214:215], v[214:215], v[74:75]
    v_exp_f32 v208, v208
    v_exp_f32 v209, v209
    v_exp_f32 v210, v210
    v_exp_f32 v211, v211
    v_exp_f32 v212, v212
    v_exp_f32 v213, v213
    v_exp_f32 v214, v214
    v_exp_f32 v215, v215
    v_pk_add_f32 v[208:209], v[208:209], 1.0 op_sel_hi:[1,0]
    v_pk_add_f32 v[210:211], v[210:211], 1.0 op_sel_hi:[1,0]
    v_pk_add_f32 v[212:213], v[212:213], 1.0 op_sel_hi:[1,0]
    v_pk_add_f32 v[214:215], v[214:215], 1.0 op_sel_hi:[1,0]
    v_rcp_f32 v208, v208
    v_rcp_f32 v209, v209
    v_rcp_f32 v210, v210
    v_rcp_f32 v211, v211
    v_rcp_f32 v212, v212
    v_rcp_f32 v213, v213
    v_rcp_f32 v214, v214
    v_rcp_f32 v215, v215
    v_pk_mul_f32 v[68:69], v[68:69], v[208:209]
    v_pk_mul_f32 v[70:71], v[70:71], v[210:211]
    v_pk_mul_f32 v[72:73], v[72:73], v[212:213]
    v_pk_mul_f32 v[74:75], v[74:75], v[214:215]
    v_pk_mul_f32 v[208:209], v[76:77], v[76:77]
    v_pk_mul_f32 v[210:211], v[78:79], v[78:79]
    v_pk_fma_f32 v[208:209], v[208:209], s[42:43], v[14:15]
    v_pk_fma_f32 v[210:211], v[210:211], s[42:43], v[14:15]
    v_pk_mul_f32 v[208:209], v[208:209], v[76:77]
    v_pk_mul_f32 v[210:211], v[210:211], v[78:79]
    v_exp_f32 v208, v208
    v_exp_f32 v209, v209
    v_exp_f32 v210, v210
    v_exp_f32 v211, v211
    v_pk_add_f32 v[208:209], v[208:209], 1.0 op_sel_hi:[1,0]
    v_pk_add_f32 v[210:211], v[210:211], 1.0 op_sel_hi:[1,0]
    v_rcp_f32 v208, v208
    v_rcp_f32 v209, v209
    v_rcp_f32 v210, v210
    v_rcp_f32 v211, v211
    v_pk_mul_f32 v[76:77], v[76:77], v[208:209]
    v_pk_mul_f32 v[78:79], v[78:79], v[210:211]
    v_pk_add_f32 v[218:219], v[218:219], v[68:69]
    v_pk_fma_f32 v[226:227], v[68:69], v[68:69], v[226:227]
    v_pk_add_f32 v[218:219], v[218:219], v[70:71]
    v_pk_fma_f32 v[226:227], v[70:71], v[70:71], v[226:227]
    v_pk_add_f32 v[220:221], v[220:221], v[72:73]
    v_pk_fma_f32 v[228:229], v[72:73], v[72:73], v[228:229]
    v_pk_add_f32 v[220:221], v[220:221], v[74:75]
    v_pk_fma_f32 v[228:229], v[74:75], v[74:75], v[228:229]
    v_pk_add_f32 v[222:223], v[222:223], v[76:77]
    v_pk_fma_f32 v[230:231], v[76:77], v[76:77], v[230:231]
    v_pk_add_f32 v[222:223], v[222:223], v[78:79]
    v_pk_fma_f32 v[230:231], v[78:79], v[78:79], v[230:231]
    v_mfma_f32_16x16x32_bf16 v[80:83], v[144:147], v[160:163], v[80:83]
    ds_read_b128 v[192:195], v13 offset:49152
    v_add_f32 v234, 1.0, v234
    v_mfma_f32_16x16x32_bf16 v[96:99], v[148:151], v[160:163], v[96:99]
    ds_read_b64_tr_b16 v[176:177], v8 offset:40960
    v_add_f32 v235, 1.0, v235
    v_mfma_f32_16x16x32_bf16 v[112:115], v[152:155], v[160:163], v[112:115]
    ds_read_b64_tr_b16 v[178:179], v8 offset:41984
    v_rcp_f32 v232, v232
    v_mfma_f32_16x16x32_bf16 v[128:131], v[156:159], v[160:163], v[128:131]
    ds_read_b128 v[196:199], v13 offset:51200
    v_rcp_f32 v233, v233
    v_mfma_f32_16x16x32_bf16 v[132:135], v[156:159], v[164:167], v[132:135]
    ds_read_b64_tr_b16 v[180:181], v9 offset:40960
    v_rcp_f32 v234, v234
    v_mfma_f32_16x16x32_bf16 v[116:119], v[152:155], v[164:167], v[116:119]
    ds_read_b64_tr_b16 v[182:183], v9 offset:41984
    v_rcp_f32 v235, v235
    v_mfma_f32_16x16x32_bf16 v[100:103], v[148:151], v[164:167], v[100:103]
    ds_read_b128 v[200:203], v13 offset:53248
    v_mul_f32 v64, v64, v232
    v_mfma_f32_16x16x32_bf16 v[84:87], v[144:147], v[164:167], v[84:87]
    ds_read_b64_tr_b16 v[184:185], v10 offset:40960
    v_mul_f32 v65, v65, v233
    v_mfma_f32_16x16x32_bf16 v[88:91], v[144:147], v[168:171], v[88:91]
    ds_read_b64_tr_b16 v[186:187], v10 offset:41984
    v_mul_f32 v66, v66, v234
    v_mfma_f32_16x16x32_bf16 v[104:107], v[148:151], v[168:171], v[104:107]
    ds_read_b128 v[204:207], v13 offset:55296
    v_mul_f32 v67, v67, v235
    v_mfma_f32_16x16x32_bf16 v[120:123], v[152:155], v[168:171], v[120:123]
    ds_read_b64_tr_b16 v[188:189], v11 offset:40960
    v_add_f32 v216, v216, v64
    v_mfma_f32_16x16x32_bf16 v[136:139], v[156:159], v[168:171], v[136:139]
    ds_read_b64_tr_b16 v[190:191], v11 offset:41984
    v_xor_b32 v8, s40, v8
    v_xor_b32 v9, s40, v9
    v_xor_b32 v10, s40, v10
    v_mfma_f32_16x16x32_bf16 v[140:143], v[156:159], v[172:175], v[140:143]
    v_xor_b32 v11, s40, v11
    v_xor_b32 v12, s40, v12
    v_xor_b32 v13, s40, v13
    v_mfma_f32_16x16x32_bf16 v[124:127], v[152:155], v[172:175], v[124:127]
    v_fmac_f32 v224, v64, v64
    v_add_f32 v217, v217, v65
    v_fmac_f32 v225, v65, v65
    v_mfma_f32_16x16x32_bf16 v[108:111], v[148:151], v[172:175], v[108:111]
    v_add_f32 v216, v216, v66
    v_fmac_f32 v224, v66, v66
    v_mfma_f32_16x16x32_bf16 v[92:95], v[144:147], v[172:175], v[92:95]
    v_add_f32 v217, v217, v67
    v_fmac_f32 v225, v67, v67
    v_add_f32 v216, v216, v217
    v_add_f32 v218, v218, v219
    v_add_f32 v220, v220, v221
    v_add_f32 v222, v222, v223
    v_add_f32 v224, v224, v225
    v_add_f32 v226, v226, v227
    v_add_f32 v228, v228, v229
    v_add_f32 v230, v230, v231
    v_permlane32_swap_b32 v216, v218
    v_permlane32_swap_b32 v220, v222
    v_permlane32_swap_b32 v224, v226
    v_permlane32_swap_b32 v228, v230
    v_add_f32 v216, v216, v218
    v_add_f32 v220, v220, v222
    v_add_f32 v224, v224, v226
    v_add_f32 v228, v228, v230
    v_permlane16_swap_b32 v216, v220
    s_nop 0
    v_permlane16_swap_b32 v224, v228
    v_add_f32 v208, v216, v220
    v_add_f32 v209, v224, v228
    v_and_b32 v5, 1, v4
    v_lshrrev_b32 v6, 1, v4
    v_lshl_or_b32 v5, v5, 1, v6
    v_lshl_add_u32 v5, v5, 4, v3
    s_lshl_b32 s37, s36, 6
    v_add_u32 v5, s37, v5
    v_lshlrev_b32 v5, 4, v5
    s_lshl_b32 s41, s35, 3
    s_add_u32 s41, s41, 156672
    v_add_u32 v5, s41, v5
    ds_write_b64 v5, v[208:209]
    v_add_u32 v5, s37, v3
    v_lshlrev_b32 v5, 3, v5
    v_add_u32 v5, 158720, v5
    s_add_u32 s37, s34, 26214400
    s_waitcnt lgkmcnt(0)
    s_barrier
    v_mfma_f32_16x16x32_bf16 v[80:83], v[176:179], v[192:195], v[80:83]
    ds_read_b128 v[160:163], v12 offset:16384
    ds_read_b64_tr_b16 v[144:145], v8 offset:0
    v_mfma_f32_16x16x32_bf16 v[96:99], v[180:183], v[192:195], v[96:99]
    ds_read_b64_tr_b16 v[146:147], v8 offset:1024
    ds_read_b128 v[164:167], v12 offset:18432
    v_mfma_f32_16x16x32_bf16 v[112:115], v[184:187], v[192:195], v[112:115]
    ds_read_b64_tr_b16 v[148:149], v9 offset:0
    ds_read_b64_tr_b16 v[150:151], v9 offset:1024
    v_mfma_f32_16x16x32_bf16 v[128:131], v[188:191], v[192:195], v[128:131]
    ds_read_b128 v[168:171], v12 offset:20480
    ds_read_b64_tr_b16 v[152:153], v10 offset:0
    v_mfma_f32_16x16x32_bf16 v[132:135], v[188:191], v[196:199], v[132:135]
    ds_read_b64_tr_b16 v[154:155], v10 offset:1024
    ds_read_b128 v[172:175], v12 offset:22528
    v_mfma_f32_16x16x32_bf16 v[116:119], v[184:187], v[196:199], v[116:119]
    ds_read_b64_tr_b16 v[156:157], v11 offset:0
    ds_read_b64_tr_b16 v[158:159], v11 offset:1024
    v_mfma_f32_16x16x32_bf16 v[100:103], v[180:183], v[196:199], v[100:103]
    v_mfma_f32_16x16x32_bf16 v[84:87], v[176:179], v[196:199], v[84:87]
    v_mfma_f32_16x16x32_bf16 v[88:91], v[176:179], v[200:203], v[88:91]
    v_mfma_f32_16x16x32_bf16 v[104:107], v[180:183], v[200:203], v[104:107]
    v_mfma_f32_16x16x32_bf16 v[120:123], v[184:187], v[200:203], v[120:123]
    v_mfma_f32_16x16x32_bf16 v[136:139], v[188:191], v[200:203], v[136:139]
    v_mfma_f32_16x16x32_bf16 v[140:143], v[188:191], v[204:207], v[140:143]
    v_mfma_f32_16x16x32_bf16 v[124:127], v[184:187], v[204:207], v[124:127]
    v_mfma_f32_16x16x32_bf16 v[108:111], v[180:183], v[204:207], v[108:111]
    v_mfma_f32_16x16x32_bf16 v[92:95], v[176:179], v[204:207], v[92:95]
    s_waitcnt lgkmcnt(0)
    v_mfma_f32_16x16x32_bf16 v[80:83], v[144:147], v[160:163], v[80:83]
    ds_read_b128 v[192:195], v13 offset:16384
    ds_read_b64_tr_b16 v[176:177], v8 offset:8192
    v_mfma_f32_16x16x32_bf16 v[96:99], v[148:151], v[160:163], v[96:99]
    ds_read_b64_tr_b16 v[178:179], v8 offset:9216
    ds_read_b128 v[196:199], v13 offset:18432
    v_mfma_f32_16x16x32_bf16 v[112:115], v[152:155], v[160:163], v[112:115]
    ds_read_b64_tr_b16 v[180:181], v9 offset:8192
    ds_read_b64_tr_b16 v[182:183], v9 offset:9216
    v_mfma_f32_16x16x32_bf16 v[128:131], v[156:159], v[160:163], v[128:131]
    ds_read_b128 v[200:203], v13 offset:20480
    ds_read_b64_tr_b16 v[184:185], v10 offset:8192
    v_mfma_f32_16x16x32_bf16 v[132:135], v[156:159], v[164:167], v[132:135]
    ds_read_b64_tr_b16 v[186:187], v10 offset:9216
    ds_read_b128 v[204:207], v13 offset:22528
    v_mfma_f32_16x16x32_bf16 v[116:119], v[152:155], v[164:167], v[116:119]
    ds_read_b64_tr_b16 v[188:189], v11 offset:8192
    ds_read_b64_tr_b16 v[190:191], v11 offset:9216
    v_mfma_f32_16x16x32_bf16 v[100:103], v[148:151], v[164:167], v[100:103]
    v_mfma_f32_16x16x32_bf16 v[84:87], v[144:147], v[164:167], v[84:87]
    v_mfma_f32_16x16x32_bf16 v[88:91], v[144:147], v[168:171], v[88:91]
    v_mfma_f32_16x16x32_bf16 v[104:107], v[148:151], v[168:171], v[104:107]
    v_mfma_f32_16x16x32_bf16 v[120:123], v[152:155], v[168:171], v[120:123]
    v_mfma_f32_16x16x32_bf16 v[136:139], v[156:159], v[168:171], v[136:139]
    v_mfma_f32_16x16x32_bf16 v[140:143], v[156:159], v[172:175], v[140:143]
    v_mfma_f32_16x16x32_bf16 v[124:127], v[152:155], v[172:175], v[124:127]
    v_mfma_f32_16x16x32_bf16 v[108:111], v[148:151], v[172:175], v[108:111]
    v_mfma_f32_16x16x32_bf16 v[92:95], v[144:147], v[172:175], v[92:95]
    s_waitcnt lgkmcnt(0)
    s_barrier
    v_mfma_f32_16x16x32_bf16 v[80:83], v[176:179], v[192:195], v[80:83]
    ds_read_b128 v[160:163], v12 offset:49152
    ds_read_b64_tr_b16 v[144:145], v8 offset:32768
    v_mfma_f32_16x16x32_bf16 v[96:99], v[180:183], v[192:195], v[96:99]
    ds_read_b64_tr_b16 v[146:147], v8 offset:33792
    ds_read_b128 v[164:167], v12 offset:51200
    v_mfma_f32_16x16x32_bf16 v[112:115], v[184:187], v[192:195], v[112:115]
    ds_read_b64_tr_b16 v[148:149], v9 offset:32768
    ds_read_b64_tr_b16 v[150:151], v9 offset:33792
    v_mfma_f32_16x16x32_bf16 v[128:131], v[188:191], v[192:195], v[128:131]
    ds_read_b128 v[168:171], v12 offset:53248
    ds_read_b64_tr_b16 v[152:153], v10 offset:32768
    v_mfma_f32_16x16x32_bf16 v[132:135], v[188:191], v[196:199], v[132:135]
    ds_read_b64_tr_b16 v[154:155], v10 offset:33792
    ds_read_b128 v[172:175], v12 offset:55296
    v_mfma_f32_16x16x32_bf16 v[116:119], v[184:187], v[196:199], v[116:119]
    ds_read_b64_tr_b16 v[156:157], v11 offset:32768
    ds_read_b64_tr_b16 v[158:159], v11 offset:33792
    v_mfma_f32_16x16x32_bf16 v[100:103], v[180:183], v[196:199], v[100:103]
    v_mfma_f32_16x16x32_bf16 v[84:87], v[176:179], v[196:199], v[84:87]
    v_mfma_f32_16x16x32_bf16 v[88:91], v[176:179], v[200:203], v[88:91]
    v_mfma_f32_16x16x32_bf16 v[104:107], v[180:183], v[200:203], v[104:107]
    v_mfma_f32_16x16x32_bf16 v[120:123], v[184:187], v[200:203], v[120:123]
    v_mfma_f32_16x16x32_bf16 v[136:139], v[188:191], v[200:203], v[136:139]
    v_mfma_f32_16x16x32_bf16 v[140:143], v[188:191], v[204:207], v[140:143]
    v_mfma_f32_16x16x32_bf16 v[124:127], v[184:187], v[204:207], v[124:127]
    v_mfma_f32_16x16x32_bf16 v[108:111], v[180:183], v[204:207], v[108:111]
    v_mfma_f32_16x16x32_bf16 v[92:95], v[176:179], v[204:207], v[92:95]
    s_waitcnt lgkmcnt(0)
    v_mfma_f32_16x16x32_bf16 v[80:83], v[144:147], v[160:163], v[80:83]
    ds_read_b128 v[192:195], v13 offset:49152
    ds_read_b64_tr_b16 v[176:177], v8 offset:40960
    v_mfma_f32_16x16x32_bf16 v[96:99], v[148:151], v[160:163], v[96:99]
    ds_read_b64_tr_b16 v[178:179], v8 offset:41984
    ds_read_b128 v[196:199], v13 offset:51200
    v_mfma_f32_16x16x32_bf16 v[112:115], v[152:155], v[160:163], v[112:115]
    ds_read_b64_tr_b16 v[180:181], v9 offset:40960
    ds_read_b64_tr_b16 v[182:183], v9 offset:41984
    v_mfma_f32_16x16x32_bf16 v[128:131], v[156:159], v[160:163], v[128:131]
    ds_read_b128 v[200:203], v13 offset:53248
    ds_read_b64_tr_b16 v[184:185], v10 offset:40960
    v_mfma_f32_16x16x32_bf16 v[132:135], v[156:159], v[164:167], v[132:135]
    ds_read_b64_tr_b16 v[186:187], v10 offset:41984
    ds_read_b128 v[204:207], v13 offset:55296
    v_mfma_f32_16x16x32_bf16 v[116:119], v[152:155], v[164:167], v[116:119]
    ds_read_b64_tr_b16 v[188:189], v11 offset:40960
    ds_read_b64_tr_b16 v[190:191], v11 offset:41984
    v_xor_b32 v8, s40, v8
    v_mfma_f32_16x16x32_bf16 v[100:103], v[148:151], v[164:167], v[100:103]
    v_xor_b32 v9, s40, v9
    v_xor_b32 v10, s40, v10
    v_mfma_f32_16x16x32_bf16 v[84:87], v[144:147], v[164:167], v[84:87]
    v_xor_b32 v11, s40, v11
    v_xor_b32 v12, s40, v12
    v_mfma_f32_16x16x32_bf16 v[88:91], v[144:147], v[168:171], v[88:91]
    v_xor_b32 v13, s40, v13
    v_mfma_f32_16x16x32_bf16 v[104:107], v[148:151], v[168:171], v[104:107]
    v_mfma_f32_16x16x32_bf16 v[120:123], v[152:155], v[168:171], v[120:123]
    v_mfma_f32_16x16x32_bf16 v[136:139], v[156:159], v[168:171], v[136:139]
    v_mfma_f32_16x16x32_bf16 v[140:143], v[156:159], v[172:175], v[140:143]
    v_mfma_f32_16x16x32_bf16 v[124:127], v[152:155], v[172:175], v[124:127]
    v_mfma_f32_16x16x32_bf16 v[108:111], v[148:151], v[172:175], v[108:111]
    v_mfma_f32_16x16x32_bf16 v[92:95], v[144:147], v[172:175], v[92:95]
    s_waitcnt lgkmcnt(0)
    s_barrier
    v_mfma_f32_16x16x32_bf16 v[80:83], v[176:179], v[192:195], v[80:83]
    ds_read_b128 v[160:163], v12 offset:16384
L_pad_4:
    s_cmp_eq_u32 s99, 1
    s_cbranch_scc1 L_padret_4
    ds_read_b64_tr_b16 v[144:145], v8 offset:0
    v_mfma_f32_16x16x32_bf16 v[96:99], v[180:183], v[192:195], v[96:99]
    ds_read_b64_tr_b16 v[146:147], v8 offset:1024
    ds_read_b128 v[164:167], v12 offset:18432
    v_mfma_f32_16x16x32_bf16 v[112:115], v[184:187], v[192:195], v[112:115]
    ds_read_b64_tr_b16 v[148:149], v9 offset:0
    ds_read_b64_tr_b16 v[150:151], v9 offset:1024
    v_mfma_f32_16x16x32_bf16 v[128:131], v[188:191], v[192:195], v[128:131]
    ds_read_b128 v[168:171], v12 offset:20480
    ds_read_b64_tr_b16 v[152:153], v10 offset:0
    v_mfma_f32_16x16x32_bf16 v[132:135], v[188:191], v[196:199], v[132:135]
    ds_read_b64_tr_b16 v[154:155], v10 offset:1024
    ds_read_b128 v[172:175], v12 offset:22528
    v_mfma_f32_16x16x32_bf16 v[116:119], v[184:187], v[196:199], v[116:119]
    ds_read_b64_tr_b16 v[156:157], v11 offset:0
    ds_read_b64_tr_b16 v[158:159], v11 offset:1024
    v_mfma_f32_16x16x32_bf16 v[100:103], v[180:183], v[196:199], v[100:103]
    v_mfma_f32_16x16x32_bf16 v[84:87], v[176:179], v[196:199], v[84:87]
    v_mfma_f32_16x16x32_bf16 v[88:91], v[176:179], v[200:203], v[88:91]
    v_mfma_f32_16x16x32_bf16 v[104:107], v[180:183], v[200:203], v[104:107]
    v_mfma_f32_16x16x32_bf16 v[120:123], v[184:187], v[200:203], v[120:123]
    v_mfma_f32_16x16x32_bf16 v[136:139], v[188:191], v[200:203], v[136:139]
    v_mfma_f32_16x16x32_bf16 v[140:143], v[188:191], v[204:207], v[140:143]
    v_mfma_f32_16x16x32_bf16 v[124:127], v[184:187], v[204:207], v[124:127]
    v_mfma_f32_16x16x32_bf16 v[108:111], v[180:183], v[204:207], v[108:111]
    v_mfma_f32_16x16x32_bf16 v[92:95], v[176:179], v[204:207], v[92:95]
    s_waitcnt lgkmcnt(0)
    v_mfma_f32_16x16x32_bf16 v[80:83], v[144:147], v[160:163], v[80:83]
    ds_read_b128 v[192:195], v13 offset:16384
    ds_read_b64_tr_b16 v[176:177], v8 offset:8192
    v_mfma_f32_16x16x32_bf16 v[96:99], v[148:151], v[160:163], v[96:99]
    ds_read_b64_tr_b16 v[178:179], v8 offset:9216
    ds_read_b128 v[196:199], v13 offset:18432
    v_mfma_f32_16x16x32_bf16 v[112:115], v[152:155], v[160:163], v[112:115]
    ds_read_b64_tr_b16 v[180:181], v9 offset:8192
    ds_read_b64_tr_b16 v[182:183], v9 offset:9216
    v_mfma_f32_16x16x32_bf16 v[128:131], v[156:159], v[160:163], v[128:131]
    ds_read_b128 v[200:203], v13 offset:20480
    ds_read_b64_tr_b16 v[184:185], v10 offset:8192
    v_mfma_f32_16x16x32_bf16 v[132:135], v[156:159], v[164:167], v[132:135]
    ds_read_b64_tr_b16 v[186:187], v10 offset:9216
    ds_read_b128 v[204:207], v13 offset:22528
    v_mfma_f32_16x16x32_bf16 v[116:119], v[152:155], v[164:167], v[116:119]
    ds_read_b64_tr_b16 v[188:189], v11 offset:8192
    ds_read_b64_tr_b16 v[190:191], v11 offset:9216
    v_mfma_f32_16x16x32_bf16 v[100:103], v[148:151], v[164:167], v[100:103]
    v_mfma_f32_16x16x32_bf16 v[84:87], v[144:147], v[164:167], v[84:87]
    v_mfma_f32_16x16x32_bf16 v[88:91], v[144:147], v[168:171], v[88:91]
    v_mfma_f32_16x16x32_bf16 v[104:107], v[148:151], v[168:171], v[104:107]
    v_mfma_f32_16x16x32_bf16 v[120:123], v[152:155], v[168:171], v[120:123]
    v_mfma_f32_16x16x32_bf16 v[136:139], v[156:159], v[168:171], v[136:139]
    v_mfma_f32_16x16x32_bf16 v[140:143], v[156:159], v[172:175], v[140:143]
    v_mfma_f32_16x16x32_bf16 v[124:127], v[152:155], v[172:175], v[124:127]
    v_mfma_f32_16x16x32_bf16 v[108:111], v[148:151], v[172:175], v[108:111]
    v_mfma_f32_16x16x32_bf16 v[92:95], v[144:147], v[172:175], v[92:95]
    s_waitcnt lgkmcnt(0)
    s_barrier
    v_mfma_f32_16x16x32_bf16 v[80:83], v[176:179], v[192:195], v[80:83]
    ds_read_b128 v[160:163], v12 offset:49152
    ds_read_b64_tr_b16 v[144:145], v8 offset:32768
    v_mfma_f32_16x16x32_bf16 v[96:99], v[180:183], v[192:195], v[96:99]
    ds_read_b64_tr_b16 v[146:147], v8 offset:33792
    ds_read_b128 v[164:167], v12 offset:51200
    v_mfma_f32_16x16x32_bf16 v[112:115], v[184:187], v[192:195], v[112:115]
    ds_read_b64_tr_b16 v[148:149], v9 offset:32768
    ds_read_b64_tr_b16 v[150:151], v9 offset:33792
    v_mfma_f32_16x16x32_bf16 v[128:131], v[188:191], v[192:195], v[128:131]
    ds_read_b128 v[168:171], v12 offset:53248
    ds_read_b64_tr_b16 v[152:153], v10 offset:32768
    v_mfma_f32_16x16x32_bf16 v[132:135], v[188:191], v[196:199], v[132:135]
    ds_read_b64_tr_b16 v[154:155], v10 offset:33792
    ds_read_b128 v[172:175], v12 offset:55296
    v_mfma_f32_16x16x32_bf16 v[116:119], v[184:187], v[196:199], v[116:119]
    ds_read_b64_tr_b16 v[156:157], v11 offset:32768
    ds_read_b64_tr_b16 v[158:159], v11 offset:33792
    v_mfma_f32_16x16x32_bf16 v[100:103], v[180:183], v[196:199], v[100:103]
    v_mfma_f32_16x16x32_bf16 v[84:87], v[176:179], v[196:199], v[84:87]
    v_mfma_f32_16x16x32_bf16 v[88:91], v[176:179], v[200:203], v[88:91]
    v_mfma_f32_16x16x32_bf16 v[104:107], v[180:183], v[200:203], v[104:107]
    v_mfma_f32_16x16x32_bf16 v[120:123], v[184:187], v[200:203], v[120:123]
    v_mfma_f32_16x16x32_bf16 v[136:139], v[188:191], v[200:203], v[136:139]
    v_mfma_f32_16x16x32_bf16 v[140:143], v[188:191], v[204:207], v[140:143]
    v_mfma_f32_16x16x32_bf16 v[124:127], v[184:187], v[204:207], v[124:127]
    v_mfma_f32_16x16x32_bf16 v[108:111], v[180:183], v[204:207], v[108:111]
    v_mfma_f32_16x16x32_bf16 v[92:95], v[176:179], v[204:207], v[92:95]
    s_waitcnt lgkmcnt(0)
    v_mfma_f32_16x16x32_bf16 v[80:83], v[144:147], v[160:163], v[80:83]
    ds_read_b128 v[192:195], v13 offset:49152
    ds_read_b64_tr_b16 v[176:177], v8 offset:40960
    v_mfma_f32_16x16x32_bf16 v[96:99], v[148:151], v[160:163], v[96:99]
    ds_read_b64_tr_b16 v[178:179], v8 offset:41984
    ds_read_b128 v[196:199], v13 offset:51200
    v_mfma_f32_16x16x32_bf16 v[112:115], v[152:155], v[160:163], v[112:115]
    ds_read_b64_tr_b16 v[180:181], v9 offset:40960
    ds_read_b64_tr_b16 v[182:183], v9 offset:41984
    v_mfma_f32_16x16x32_bf16 v[128:131], v[156:159], v[160:163], v[128:131]
    ds_read_b128 v[200:203], v13 offset:53248
    ds_read_b64_tr_b16 v[184:185], v10 offset:40960
    v_mfma_f32_16x16x32_bf16 v[132:135], v[156:159], v[164:167], v[132:135]
    ds_read_b64_tr_b16 v[186:187], v10 offset:41984
    ds_read_b128 v[204:207], v13 offset:55296
    v_mfma_f32_16x16x32_bf16 v[116:119], v[152:155], v[164:167], v[116:119]
    ds_read_b64_tr_b16 v[188:189], v11 offset:40960
    ds_read_b64_tr_b16 v[190:191], v11 offset:41984
    v_xor_b32 v8, s40, v8
    v_mfma_f32_16x16x32_bf16 v[100:103], v[148:151], v[164:167], v[100:103]
    v_xor_b32 v9, s40, v9
    v_xor_b32 v10, s40, v10
    v_mfma_f32_16x16x32_bf16 v[84:87], v[144:147], v[164:167], v[84:87]
    v_xor_b32 v11, s40, v11
    v_xor_b32 v12, s40, v12
    v_mfma_f32_16x16x32_bf16 v[88:91], v[144:147], v[168:171], v[88:91]
    v_xor_b32 v13, s40, v13
    v_mfma_f32_16x16x32_bf16 v[104:107], v[148:151], v[168:171], v[104:107]
    v_mfma_f32_16x16x32_bf16 v[120:123], v[152:155], v[168:171], v[120:123]
    v_mfma_f32_16x16x32_bf16 v[136:139], v[156:159], v[168:171], v[136:139]
    v_mfma_f32_16x16x32_bf16 v[140:143], v[156:159], v[172:175], v[140:143]
    v_mfma_f32_16x16x32_bf16 v[124:127], v[152:155], v[172:175], v[124:127]
    v_mfma_f32_16x16x32_bf16 v[108:111], v[148:151], v[172:175], v[108:111]
    v_mfma_f32_16x16x32_bf16 v[92:95], v[144:147], v[172:175], v[92:95]
    s_waitcnt lgkmcnt(0)
    s_barrier
    v_mfma_f32_16x16x32_bf16 v[80:83], v[176:179], v[192:195], v[80:83]
    ds_read_b128 v[160:163], v12 offset:16384
    ds_read_b64_tr_b16 v[144:145], v8 offset:0
    v_mfma_f32_16x16x32_bf16 v[96:99], v[180:183], v[192:195], v[96:99]
    ds_read_b64_tr_b16 v[146:147], v8 offset:1024
    ds_read_b128 v[164:167], v12 offset:18432
    v_mfma_f32_16x16x32_bf16 v[112:115], v[184:187], v[192:195], v[112:115]
    ds_read_b64_tr_b16 v[148:149], v9 offset:0
    ds_read_b64_tr_b16 v[150:151], v9 offset:1024
    v_mfma_f32_16x16x32_bf16 v[128:131], v[188:191], v[192:195], v[128:131]
    ds_read_b128 v[168:171], v12 offset:20480
    ds_read_b64_tr_b16 v[152:153], v10 offset:0
    v_mfma_f32_16x16x32_bf16 v[132:135], v[188:191], v[196:199], v[132:135]
    ds_read_b64_tr_b16 v[154:155], v10 offset:1024
    ds_read_b128 v[172:175], v12 offset:22528
    v_mfma_f32_16x16x32_bf16 v[116:119], v[184:187], v[196:199], v[116:119]
    ds_read_b64_tr_b16 v[156:157], v11 offset:0
    ds_read_b64_tr_b16 v[158:159], v11 offset:1024
    v_mfma_f32_16x16x32_bf16 v[100:103], v[180:183], v[196:199], v[100:103]
    v_mfma_f32_16x16x32_bf16 v[84:87], v[176:179], v[196:199], v[84:87]
    v_mfma_f32_16x16x32_bf16 v[88:91], v[176:179], v[200:203], v[88:91]
    v_mfma_f32_16x16x32_bf16 v[104:107], v[180:183], v[200:203], v[104:107]
    v_mfma_f32_16x16x32_bf16 v[120:123], v[184:187], v[200:203], v[120:123]
    v_mfma_f32_16x16x32_bf16 v[136:139], v[188:191], v[200:203], v[136:139]
    v_mfma_f32_16x16x32_bf16 v[140:143], v[188:191], v[204:207], v[140:143]
    v_mfma_f32_16x16x32_bf16 v[124:127], v[184:187], v[204:207], v[124:127]
    v_mfma_f32_16x16x32_bf16 v[108:111], v[180:183], v[204:207], v[108:111]
    v_mfma_f32_16x16x32_bf16 v[92:95], v[176:179], v[204:207], v[92:95]
    s_waitcnt lgkmcnt(0)
    v_mfma_f32_16x16x32_bf16 v[80:83], v[144:147], v[160:163], v[80:83]
    ds_read_b128 v[192:195], v13 offset:16384
    ds_read_b64_tr_b16 v[176:177], v8 offset:8192
    v_mfma_f32_16x16x32_bf16 v[96:99], v[148:151], v[160:163], v[96:99]
    ds_read_b64_tr_b16 v[178:179], v8 offset:9216
    ds_read_b128 v[196:199], v13 offset:18432
    v_mfma_f32_16x16x32_bf16 v[112:115], v[152:155], v[160:163], v[112:115]
    ds_read_b64_tr_b16 v[180:181], v9 offset:8192
    ds_read_b64_tr_b16 v[182:183], v9 offset:9216
    v_mfma_f32_16x16x32_bf16 v[128:131], v[156:159], v[160:163], v[128:131]
    ds_read_b128 v[200:203], v13 offset:20480
    ds_read_b64_tr_b16 v[184:185], v10 offset:8192
    v_mfma_f32_16x16x32_bf16 v[132:135], v[156:159], v[164:167], v[132:135]
    ds_read_b64_tr_b16 v[186:187], v10 offset:9216
    ds_read_b128 v[204:207], v13 offset:22528
    v_mfma_f32_16x16x32_bf16 v[116:119], v[152:155], v[164:167], v[116:119]
    ds_read_b64_tr_b16 v[188:189], v11 offset:8192
    ds_read_b64_tr_b16 v[190:191], v11 offset:9216
    v_mfma_f32_16x16x32_bf16 v[100:103], v[148:151], v[164:167], v[100:103]
    v_mfma_f32_16x16x32_bf16 v[84:87], v[144:147], v[164:167], v[84:87]
    v_mfma_f32_16x16x32_bf16 v[88:91], v[144:147], v[168:171], v[88:91]
    v_mfma_f32_16x16x32_bf16 v[104:107], v[148:151], v[168:171], v[104:107]
    v_mfma_f32_16x16x32_bf16 v[120:123], v[152:155], v[168:171], v[120:123]
    v_mfma_f32_16x16x32_bf16 v[136:139], v[156:159], v[168:171], v[136:139]
    v_mfma_f32_16x16x32_bf16 v[140:143], v[156:159], v[172:175], v[140:143]
    v_mfma_f32_16x16x32_bf16 v[124:127], v[152:155], v[172:175], v[124:127]
    v_mfma_f32_16x16x32_bf16 v[108:111], v[148:151], v[172:175], v[108:111]
    v_mfma_f32_16x16x32_bf16 v[92:95], v[144:147], v[172:175], v[92:95]
    s_waitcnt lgkmcnt(0)
    s_barrier
    ds_read_b64 v[216:217], v5 offset:0
    ds_read_b64 v[218:219], v5 offset:128
    ds_read_b64 v[220:221], v5 offset:256
    ds_read_b64 v[222:223], v5 offset:384
    v_mfma_f32_16x16x32_bf16 v[80:83], v[176:179], v[192:195], v[80:83]
    ds_read_b128 v[160:163], v12 offset:49152
    ds_read_b64_tr_b16 v[144:145], v8 offset:32768
    v_mfma_f32_16x16x32_bf16 v[96:99], v[180:183], v[192:195], v[96:99]
    ds_read_b64_tr_b16 v[146:147], v8 offset:33792
    ds_read_b128 v[164:167], v12 offset:51200
    v_mfma_f32_16x16x32_bf16 v[112:115], v[184:187], v[192:195], v[112:115]
    ds_read_b64_tr_b16 v[148:149], v9 offset:32768
    ds_read_b64_tr_b16 v[150:151], v9 offset:33792
    v_mfma_f32_16x16x32_bf16 v[128:131], v[188:191], v[192:195], v[128:131]
    ds_read_b128 v[168:171], v12 offset:53248
    ds_read_b64_tr_b16 v[152:153], v10 offset:32768
    v_mfma_f32_16x16x32_bf16 v[132:135], v[188:191], v[196:199], v[132:135]
    ds_read_b64_tr_b16 v[154:155], v10 offset:33792
    ds_read_b128 v[172:175], v12 offset:55296
    v_mfma_f32_16x16x32_bf16 v[116:119], v[184:187], v[196:199], v[116:119]
    ds_read_b64_tr_b16 v[156:157], v11 offset:32768
    ds_read_b64_tr_b16 v[158:159], v11 offset:33792
    v_mfma_f32_16x16x32_bf16 v[100:103], v[180:183], v[196:199], v[100:103]
    v_mfma_f32_16x16x32_bf16 v[84:87], v[176:179], v[196:199], v[84:87]
    v_mfma_f32_16x16x32_bf16 v[88:91], v[176:179], v[200:203], v[88:91]
    v_mfma_f32_16x16x32_bf16 v[104:107], v[180:183], v[200:203], v[104:107]
    v_mfma_f32_16x16x32_bf16 v[120:123], v[184:187], v[200:203], v[120:123]
    v_mfma_f32_16x16x32_bf16 v[136:139], v[188:191], v[200:203], v[136:139]
    v_mfma_f32_16x16x32_bf16 v[140:143], v[188:191], v[204:207], v[140:143]
    v_mfma_f32_16x16x32_bf16 v[124:127], v[184:187], v[204:207], v[124:127]
    v_mfma_f32_16x16x32_bf16 v[108:111], v[180:183], v[204:207], v[108:111]
    v_mfma_f32_16x16x32_bf16 v[92:95], v[176:179], v[204:207], v[92:95]
    s_waitcnt lgkmcnt(0)
    v_pk_fma_f32 v[16:17], v[16:17], v[216:217], v[216:217] op_sel:[0,0,1] op_sel_hi:[1,0,1]
    v_pk_fma_f32 v[18:19], v[18:19], v[216:217], v[216:217] op_sel:[0,0,1] op_sel_hi:[1,0,1]
    v_cvt_pk_bf16_f32 v232, v16, v17
    v_cvt_pk_bf16_f32 v233, v18, v19
    v_pk_fma_f32 v[32:33], v[32:33], v[216:217], v[216:217] op_sel:[0,0,1] op_sel_hi:[1,0,1]
    v_pk_fma_f32 v[34:35], v[34:35], v[216:217], v[216:217] op_sel:[0,0,1] op_sel_hi:[1,0,1]
    v_cvt_pk_bf16_f32 v234, v32, v33
    v_cvt_pk_bf16_f32 v235, v34, v35
    s_nop 0
    v_permlane32_swap_b32 v232, v234
    v_permlane32_swap_b32 v233, v235
    s_nop 0
    v_permlane16_swap_b32 v232, v234
    v_permlane16_swap_b32 v233, v235
    v_pk_fma_f32 v[48:49], v[48:49], v[216:217], v[216:217] op_sel:[0,0,1] op_sel_hi:[1,0,1]
    v_pk_fma_f32 v[50:51], v[50:51], v[216:217], v[216:217] op_sel:[0,0,1] op_sel_hi:[1,0,1]
    v_cvt_pk_bf16_f32 v236, v48, v49
    v_cvt_pk_bf16_f32 v237, v50, v51
    v_pk_fma_f32 v[64:65], v[64:65], v[216:217], v[216:217] op_sel:[0,0,1] op_sel_hi:[1,0,1]
    v_pk_fma_f32 v[66:67], v[66:67], v[216:217], v[216:217] op_sel:[0,0,1] op_sel_hi:[1,0,1]
    v_cvt_pk_bf16_f32 v238, v64, v65
    v_cvt_pk_bf16_f32 v239, v66, v67
    s_nop 0
    v_permlane32_swap_b32 v236, v238
    v_permlane32_swap_b32 v237, v239
    s_nop 0
    v_permlane16_swap_b32 v236, v238
    v_permlane16_swap_b32 v237, v239
    v_mov_b32_dpp v208, v232 row_ror:8 row_mask:0xf bank_mask:0xf
    v_mov_b32_dpp v209, v233 row_ror:8 row_mask:0xf bank_mask:0xf
    v_mov_b32_dpp v210, v234 row_ror:8 row_mask:0xf bank_mask:0xf
    v_mov_b32_dpp v211, v235 row_ror:8 row_mask:0xf bank_mask:0xf
    v_mov_b32_dpp v232, v236 row_ror:8 row_mask:0xf bank_mask:0xc
    v_mov_b32_dpp v233, v237 row_ror:8 row_mask:0xf bank_mask:0xc
    v_mov_b32_dpp v234, v238 row_ror:8 row_mask:0xf bank_mask:0xc
    v_mov_b32_dpp v235, v239 row_ror:8 row_mask:0xf bank_mask:0xc
    buffer_store_dwordx4 v[232:235], v1, s[8:11], s37 offen sc1
    s_add_u32 s37, s37, 32768
    v_mov_b32_dpp v236, v208 quad_perm:[0,1,2,3] row_mask:0xf bank_mask:0x3
    v_mov_b32_dpp v237, v209 quad_perm:[0,1,2,3] row_mask:0xf bank_mask:0x3
    v_mov_b32_dpp v238, v210 quad_perm:[0,1,2,3] row_mask:0xf bank_mask:0x3
    v_mov_b32_dpp v239, v211 quad_perm:[0,1,2,3] row_mask:0xf bank_mask:0x3
    buffer_store_dwordx4 v[236:239], v1, s[8:11], s37 offen sc1
    s_add_u32 s37, s37, 32768
    v_mfma_f32_16x16x32_bf16 v[80:83], v[144:147], v[160:163], v[80:83]
    ds_read_b128 v[192:195], v13 offset:49152
    ds_read_b64_tr_b16 v[176:177], v8 offset:40960
    v_mfma_f32_16x16x32_bf16 v[96:99], v[148:151], v[160:163], v[96:99]
    ds_read_b64_tr_b16 v[178:179], v8 offset:41984
    ds_read_b128 v[196:199], v13 offset:51200
    v_mfma_f32_16x16x32_bf16 v[112:115], v[152:155], v[160:163], v[112:115]
    ds_read_b64_tr_b16 v[180:181], v9 offset:40960
    ds_read_b64_tr_b16 v[182:183], v9 offset:41984
    v_mfma_f32_16x16x32_bf16 v[128:131], v[156:159], v[160:163], v[128:131]
    ds_read_b128 v[200:203], v13 offset:53248
    ds_read_b64_tr_b16 v[184:185], v10 offset:40960
    v_mfma_f32_16x16x32_bf16 v[132:135], v[156:159], v[164:167], v[132:135]
    ds_read_b64_tr_b16 v[186:187], v10 offset:41984
    ds_read_b128 v[204:207], v13 offset:55296
    v_mfma_f32_16x16x32_bf16 v[116:119], v[152:155], v[164:167], v[116:119]
    ds_read_b64_tr_b16 v[188:189], v11 offset:40960
    ds_read_b64_tr_b16 v[190:191], v11 offset:41984
    v_xor_b32 v8, s40, v8
    v_mfma_f32_16x16x32_bf16 v[100:103], v[148:151], v[164:167], v[100:103]
    v_xor_b32 v9, s40, v9
    v_xor_b32 v10, s40, v10
    v_mfma_f32_16x16x32_bf16 v[84:87], v[144:147], v[164:167], v[84:87]
    v_xor_b32 v11, s40, v11
    v_xor_b32 v12, s40, v12
    v_mfma_f32_16x16x32_bf16 v[88:91], v[144:147], v[168:171], v[88:91]
    v_xor_b32 v13, s40, v13
    v_mfma_f32_16x16x32_bf16 v[104:107], v[148:151], v[168:171], v[104:107]
    v_mfma_f32_16x16x32_bf16 v[120:123], v[152:155], v[168:171], v[120:123]
    v_mfma_f32_16x16x32_bf16 v[136:139], v[156:159], v[168:171], v[136:139]
    v_mfma_f32_16x16x32_bf16 v[140:143], v[156:159], v[172:175], v[140:143]
    v_mfma_f32_16x16x32_bf16 v[124:127], v[152:155], v[172:175], v[124:127]
    v_mfma_f32_16x16x32_bf16 v[108:111], v[148:151], v[172:175], v[108:111]
    v_mfma_f32_16x16x32_bf16 v[92:95], v[144:147], v[172:175], v[92:95]
    v_pk_fma_f32 v[20:21], v[20:21], v[218:219], v[218:219] op_sel:[0,0,1] op_sel_hi:[1,0,1]
    v_pk_fma_f32 v[22:23], v[22:23], v[218:219], v[218:219] op_sel:[0,0,1] op_sel_hi:[1,0,1]
    v_cvt_pk_bf16_f32 v240, v20, v21
    v_cvt_pk_bf16_f32 v241, v22, v23
    v_pk_fma_f32 v[36:37], v[36:37], v[218:219], v[218:219] op_sel:[0,0,1] op_sel_hi:[1,0,1]
    v_pk_fma_f32 v[38:39], v[38:39], v[218:219], v[218:219] op_sel:[0,0,1] op_sel_hi:[1,0,1]
    v_cvt_pk_bf16_f32 v242, v36, v37
    v_cvt_pk_bf16_f32 v243, v38, v39
    s_nop 0
    v_permlane32_swap_b32 v240, v242
    v_permlane32_swap_b32 v241, v243
    s_nop 0
    v_permlane16_swap_b32 v240, v242
    v_permlane16_swap_b32 v241, v243
    v_pk_fma_f32 v[52:53], v[52:53], v[218:219], v[218:219] op_sel:[0,0,1] op_sel_hi:[1,0,1]
    v_pk_fma_f32 v[54:55], v[54:55], v[218:219], v[218:219] op_sel:[0,0,1] op_sel_hi:[1,0,1]
    v_cvt_pk_bf16_f32 v244, v52, v53
    v_cvt_pk_bf16_f32 v245, v54, v55
    v_pk_fma_f32 v[68:69], v[68:69], v[218:219], v[218:219] op_sel:[0,0,1] op_sel_hi:[1,0,1]
    v_pk_fma_f32 v[70:71], v[70:71], v[218:219], v[218:219] op_sel:[0,0,1] op_sel_hi:[1,0,1]
    v_cvt_pk_bf16_f32 v246, v68, v69
    v_cvt_pk_bf16_f32 v247, v70, v71
    s_nop 0
    v_permlane32_swap_b32 v244, v246
    v_permlane32_swap_b32 v245, v247
    s_nop 0
    v_permlane16_swap_b32 v244, v246
    v_permlane16_swap_b32 v245, v247
    v_mov_b32_dpp v208, v240 row_ror:8 row_mask:0xf bank_mask:0xf
    v_mov_b32_dpp v209, v241 row_ror:8 row_mask:0xf bank_mask:0xf
    v_mov_b32_dpp v210, v242 row_ror:8 row_mask:0xf bank_mask:0xf
    v_mov_b32_dpp v211, v243 row_ror:8 row_mask:0xf bank_mask:0xf
    v_mov_b32_dpp v240, v244 row_ror:8 row_mask:0xf bank_mask:0xc
    v_mov_b32_dpp v241, v245 row_ror:8 row_mask:0xf bank_mask:0xc
    v_mov_b32_dpp v242, v246 row_ror:8 row_mask:0xf bank_mask:0xc
    v_mov_b32_dpp v243, v247 row_ror:8 row_mask:0xf bank_mask:0xc
    buffer_store_dwordx4 v[240:243], v1, s[8:11], s37 offen sc1
    s_add_u32 s37, s37, 32768
    v_mov_b32_dpp v244, v208 quad_perm:[0,1,2,3] row_mask:0xf bank_mask:0x3
    v_mov_b32_dpp v245, v209 quad_perm:[0,1,2,3] row_mask:0xf bank_mask:0x3
    v_mov_b32_dpp v246, v210 quad_perm:[0,1,2,3] row_mask:0xf bank_mask:0x3
    v_mov_b32_dpp v247, v211 quad_perm:[0,1,2,3] row_mask:0xf bank_mask:0x3
    buffer_store_dwordx4 v[244:247], v1, s[8:11], s37 offen sc1
    s_add_u32 s37, s37, 32768
    s_waitcnt lgkmcnt(0)
    s_barrier
    v_mfma_f32_16x16x32_bf16 v[80:83], v[176:179], v[192:195], v[80:83]
    ds_read_b128 v[160:163], v12 offset:16384
    ds_read_b64_tr_b16 v[144:145], v8 offset:0
    v_mfma_f32_16x16x32_bf16 v[96:99], v[180:183], v[192:195], v[96:99]
    ds_read_b64_tr_b16 v[146:147], v8 offset:1024
    ds_read_b128 v[164:167], v12 offset:18432
    v_mfma_f32_16x16x32_bf16 v[112:115], v[184:187], v[192:195], v[112:115]
    ds_read_b64_tr_b16 v[148:149], v9 offset:0
    ds_read_b64_tr_b16 v[150:151], v9 offset:1024
    v_mfma_f32_16x16x32_bf16 v[128:131], v[188:191], v[192:195], v[128:131]
    ds_read_b128 v[168:171], v12 offset:20480
    ds_read_b64_tr_b16 v[152:153], v10 offset:0
    v_mfma_f32_16x16x32_bf16 v[132:135], v[188:191], v[196:199], v[132:135]
    ds_read_b64_tr_b16 v[154:155], v10 offset:1024
    ds_read_b128 v[172:175], v12 offset:22528
    v_mfma_f32_16x16x32_bf16 v[116:119], v[184:187], v[196:199], v[116:119]
    ds_read_b64_tr_b16 v[156:157], v11 offset:0
    ds_read_b64_tr_b16 v[158:159], v11 offset:1024
    v_mfma_f32_16x16x32_bf16 v[100:103], v[180:183], v[196:199], v[100:103]
    v_mfma_f32_16x16x32_bf16 v[84:87], v[176:179], v[196:199], v[84:87]
    v_mfma_f32_16x16x32_bf16 v[88:91], v[176:179], v[200:203], v[88:91]
    v_mfma_f32_16x16x32_bf16 v[104:107], v[180:183], v[200:203], v[104:107]
    v_mfma_f32_16x16x32_bf16 v[120:123], v[184:187], v[200:203], v[120:123]
    v_mfma_f32_16x16x32_bf16 v[136:139], v[188:191], v[200:203], v[136:139]
    v_mfma_f32_16x16x32_bf16 v[140:143], v[188:191], v[204:207], v[140:143]
    v_mfma_f32_16x16x32_bf16 v[124:127], v[184:187], v[204:207], v[124:127]
    v_mfma_f32_16x16x32_bf16 v[108:111], v[180:183], v[204:207], v[108:111]
    v_mfma_f32_16x16x32_bf16 v[92:95], v[176:179], v[204:207], v[92:95]
    s_waitcnt lgkmcnt(0)
    v_pk_fma_f32 v[24:25], v[24:25], v[220:221], v[220:221] op_sel:[0,0,1] op_sel_hi:[1,0,1]
    v_pk_fma_f32 v[26:27], v[26:27], v[220:221], v[220:221] op_sel:[0,0,1] op_sel_hi:[1,0,1]
    v_cvt_pk_bf16_f32 v232, v24, v25
    v_cvt_pk_bf16_f32 v233, v26, v27
    v_pk_fma_f32 v[40:41], v[40:41], v[220:221], v[220:221] op_sel:[0,0,1] op_sel_hi:[1,0,1]
    v_pk_fma_f32 v[42:43], v[42:43], v[220:221], v[220:221] op_sel:[0,0,1] op_sel_hi:[1,0,1]
    v_cvt_pk_bf16_f32 v234, v40, v41
    v_cvt_pk_bf16_f32 v235, v42, v43
    s_nop 0
    v_permlane32_swap_b32 v232, v234
    v_permlane32_swap_b32 v233, v235
    s_nop 0
    v_permlane16_swap_b32 v232, v234
    v_permlane16_swap_b32 v233, v235
    v_pk_fma_f32 v[56:57], v[56:57], v[220:221], v[220:221] op_sel:[0,0,1] op_sel_hi:[1,0,1]
    v_pk_fma_f32 v[58:59], v[58:59], v[220:221], v[220:221] op_sel:[0,0,1] op_sel_hi:[1,0,1]
    v_cvt_pk_bf16_f32 v236, v56, v57
    v_cvt_pk_bf16_f32 v237, v58, v59
    v_pk_fma_f32 v[72:73], v[72:73], v[220:221], v[220:221] op_sel:[0,0,1] op_sel_hi:[1,0,1]
    v_pk_fma_f32 v[74:75], v[74:75], v[220:221], v[220:221] op_sel:[0,0,1] op_sel_hi:[1,0,1]
    v_cvt_pk_bf16_f32 v238, v72, v73
    v_cvt_pk_bf16_f32 v239, v74, v75
    s_nop 0
    v_permlane32_swap_b32 v236, v238
    v_permlane32_swap_b32 v237, v239
    s_nop 0
    v_permlane16_swap_b32 v236, v238
    v_permlane16_swap_b32 v237, v239
    v_mov_b32_dpp v208, v232 row_ror:8 row_mask:0xf bank_mask:0xf
    v_mov_b32_dpp v209, v233 row_ror:8 row_mask:0xf bank_mask:0xf
    v_mov_b32_dpp v210, v234 row_ror:8 row_mask:0xf bank_mask:0xf
    v_mov_b32_dpp v211, v235 row_ror:8 row_mask:0xf bank_mask:0xf
    v_mov_b32_dpp v232, v236 row_ror:8 row_mask:0xf bank_mask:0xc
    v_mov_b32_dpp v233, v237 row_ror:8 row_mask:0xf bank_mask:0xc
    v_mov_b32_dpp v234, v238 row_ror:8 row_mask:0xf bank_mask:0xc
    v_mov_b32_dpp v235, v239 row_ror:8 row_mask:0xf bank_mask:0xc
    buffer_store_dwordx4 v[232:235], v1, s[8:11], s37 offen sc1
    s_add_u32 s37, s37, 32768
    v_mov_b32_dpp v236, v208 quad_perm:[0,1,2,3] row_mask:0xf bank_mask:0x3
    v_mov_b32_dpp v237, v209 quad_perm:[0,1,2,3] row_mask:0xf bank_mask:0x3
    v_mov_b32_dpp v238, v210 quad_perm:[0,1,2,3] row_mask:0xf bank_mask:0x3
    v_mov_b32_dpp v239, v211 quad_perm:[0,1,2,3] row_mask:0xf bank_mask:0x3
    buffer_store_dwordx4 v[236:239], v1, s[8:11], s37 offen sc1
    s_add_u32 s37, s37, 32768
    v_mfma_f32_16x16x32_bf16 v[80:83], v[144:147], v[160:163], v[80:83]
    ds_read_b128 v[192:195], v13 offset:16384
    ds_read_b64_tr_b16 v[176:177], v8 offset:8192
    v_mfma_f32_16x16x32_bf16 v[96:99], v[148:151], v[160:163], v[96:99]
    ds_read_b64_tr_b16 v[178:179], v8 offset:9216
    ds_read_b128 v[196:199], v13 offset:18432
    v_mfma_f32_16x16x32_bf16 v[112:115], v[152:155], v[160:163], v[112:115]
    ds_read_b64_tr_b16 v[180:181], v9 offset:8192
    ds_read_b64_tr_b16 v[182:183], v9 offset:9216
    v_mfma_f32_16x16x32_bf16 v[128:131], v[156:159], v[160:163], v[128:131]
    ds_read_b128 v[200:203], v13 offset:20480
    ds_read_b64_tr_b16 v[184:185], v10 offset:8192
    v_mfma_f32_16x16x32_bf16 v[132:135], v[156:159], v[164:167], v[132:135]
    ds_read_b64_tr_b16 v[186:187], v10 offset:9216
    ds_read_b128 v[204:207], v13 offset:22528
    v_mfma_f32_16x16x32_bf16 v[116:119], v[152:155], v[164:167], v[116:119]
    ds_read_b64_tr_b16 v[188:189], v11 offset:8192
    ds_read_b64_tr_b16 v[190:191], v11 offset:9216
    v_mfma_f32_16x16x32_bf16 v[100:103], v[148:151], v[164:167], v[100:103]
    v_mfma_f32_16x16x32_bf16 v[84:87], v[144:147], v[164:167], v[84:87]
    v_mfma_f32_16x16x32_bf16 v[88:91], v[144:147], v[168:171], v[88:91]
    v_mfma_f32_16x16x32_bf16 v[104:107], v[148:151], v[168:171], v[104:107]
    v_mfma_f32_16x16x32_bf16 v[120:123], v[152:155], v[168:171], v[120:123]
    v_mfma_f32_16x16x32_bf16 v[136:139], v[156:159], v[168:171], v[136:139]
    v_mfma_f32_16x16x32_bf16 v[140:143], v[156:159], v[172:175], v[140:143]
    v_mfma_f32_16x16x32_bf16 v[124:127], v[152:155], v[172:175], v[124:127]
    v_mfma_f32_16x16x32_bf16 v[108:111], v[148:151], v[172:175], v[108:111]
    v_mfma_f32_16x16x32_bf16 v[92:95], v[144:147], v[172:175], v[92:95]
    v_pk_fma_f32 v[28:29], v[28:29], v[222:223], v[222:223] op_sel:[0,0,1] op_sel_hi:[1,0,1]
    v_pk_fma_f32 v[30:31], v[30:31], v[222:223], v[222:223] op_sel:[0,0,1] op_sel_hi:[1,0,1]
    v_cvt_pk_bf16_f32 v240, v28, v29
    v_cvt_pk_bf16_f32 v241, v30, v31
    v_pk_fma_f32 v[44:45], v[44:45], v[222:223], v[222:223] op_sel:[0,0,1] op_sel_hi:[1,0,1]
    v_pk_fma_f32 v[46:47], v[46:47], v[222:223], v[222:223] op_sel:[0,0,1] op_sel_hi:[1,0,1]
    v_cvt_pk_bf16_f32 v242, v44, v45
    v_cvt_pk_bf16_f32 v243, v46, v47
    s_nop 0
    v_permlane32_swap_b32 v240, v242
    v_permlane32_swap_b32 v241, v243
    s_nop 0
    v_permlane16_swap_b32 v240, v242
    v_permlane16_swap_b32 v241, v243
    v_pk_fma_f32 v[60:61], v[60:61], v[222:223], v[222:223] op_sel:[0,0,1] op_sel_hi:[1,0,1]
    v_pk_fma_f32 v[62:63], v[62:63], v[222:223], v[222:223] op_sel:[0,0,1] op_sel_hi:[1,0,1]
    v_cvt_pk_bf16_f32 v244, v60, v61
    v_cvt_pk_bf16_f32 v245, v62, v63
    v_pk_fma_f32 v[76:77], v[76:77], v[222:223], v[222:223] op_sel:[0,0,1] op_sel_hi:[1,0,1]
    v_pk_fma_f32 v[78:79], v[78:79], v[222:223], v[222:223] op_sel:[0,0,1] op_sel_hi:[1,0,1]
    v_cvt_pk_bf16_f32 v246, v76, v77
    v_cvt_pk_bf16_f32 v247, v78, v79
    s_nop 0
    v_permlane32_swap_b32 v244, v246
    v_permlane32_swap_b32 v245, v247
    s_nop 0
    v_permlane16_swap_b32 v244, v246
    v_permlane16_swap_b32 v245, v247
    v_mov_b32_dpp v208, v240 row_ror:8 row_mask:0xf bank_mask:0xf
    v_mov_b32_dpp v209, v241 row_ror:8 row_mask:0xf bank_mask:0xf
    v_mov_b32_dpp v210, v242 row_ror:8 row_mask:0xf bank_mask:0xf
    v_mov_b32_dpp v211, v243 row_ror:8 row_mask:0xf bank_mask:0xf
    v_mov_b32_dpp v240, v244 row_ror:8 row_mask:0xf bank_mask:0xc
    v_mov_b32_dpp v241, v245 row_ror:8 row_mask:0xf bank_mask:0xc
    v_mov_b32_dpp v242, v246 row_ror:8 row_mask:0xf bank_mask:0xc
    v_mov_b32_dpp v243, v247 row_ror:8 row_mask:0xf bank_mask:0xc
    buffer_store_dwordx4 v[240:243], v1, s[8:11], s37 offen sc1
    s_add_u32 s37, s37, 32768
    v_mov_b32_dpp v244, v208 quad_perm:[0,1,2,3] row_mask:0xf bank_mask:0x3
    v_mov_b32_dpp v245, v209 quad_perm:[0,1,2,3] row_mask:0xf bank_mask:0x3
    v_mov_b32_dpp v246, v210 quad_perm:[0,1,2,3] row_mask:0xf bank_mask:0x3
    v_mov_b32_dpp v247, v211 quad_perm:[0,1,2,3] row_mask:0xf bank_mask:0x3
    buffer_store_dwordx4 v[244:247], v1, s[8:11], s37 offen sc1
    s_add_u32 s37, s37, 32768
    s_waitcnt lgkmcnt(0)
    s_barrier
    s_waitcnt vmcnt(8)
    v_lshlrev_b32 v248, 16, v248
    v_lshlrev_b32 v249, 16, v249
    v_lshlrev_b32 v250, 16, v250
    v_lshlrev_b32 v251, 16, v251
    v_mfma_f32_16x16x32_bf16 v[80:83], v[176:179], v[192:195], v[80:83]
    ds_read_b128 v[160:163], v12 offset:49152
    v_mov_b32 v16, v248
    v_mfma_f32_16x16x32_bf16 v[96:99], v[180:183], v[192:195], v[96:99]
    ds_read_b64_tr_b16 v[144:145], v8 offset:32768
    v_mov_b32 v17, v248
    v_mfma_f32_16x16x32_bf16 v[112:115], v[184:187], v[192:195], v[112:115]
    ds_read_b64_tr_b16 v[146:147], v8 offset:33792
    v_mov_b32 v18, v248
    v_mfma_f32_16x16x32_bf16 v[128:131], v[188:191], v[192:195], v[128:131]
    ds_read_b128 v[164:167], v12 offset:51200
    v_mov_b32 v19, v248
    v_mfma_f32_16x16x32_bf16 v[132:135], v[188:191], v[196:199], v[132:135]
    ds_read_b64_tr_b16 v[148:149], v9 offset:32768
    v_mov_b32 v20, v249
    v_mfma_f32_16x16x32_bf16 v[116:119], v[184:187], v[196:199], v[116:119]
    ds_read_b64_tr_b16 v[150:151], v9 offset:33792
    v_mov_b32 v21, v249
    v_mfma_f32_16x16x32_bf16 v[100:103], v[180:183], v[196:199], v[100:103]
    ds_read_b128 v[168:171], v12 offset:53248
    v_mov_b32 v22, v249
    v_mfma_f32_16x16x32_bf16 v[84:87], v[176:179], v[196:199], v[84:87]
    ds_read_b64_tr_b16 v[152:153], v10 offset:32768
    v_mov_b32 v23, v249
    v_mfma_f32_16x16x32_bf16 v[88:91], v[176:179], v[200:203], v[88:91]
    ds_read_b64_tr_b16 v[154:155], v10 offset:33792
    v_mov_b32 v24, v250
    v_mfma_f32_16x16x32_bf16 v[104:107], v[180:183], v[200:203], v[104:107]
    ds_read_b128 v[172:175], v12 offset:55296
    v_mov_b32 v25, v250
    v_mfma_f32_16x16x32_bf16 v[120:123], v[184:187], v[200:203], v[120:123]
    ds_read_b64_tr_b16 v[156:157], v11 offset:32768
    v_mov_b32 v26, v250
    v_mfma_f32_16x16x32_bf16 v[136:139], v[188:191], v[200:203], v[136:139]
    ds_read_b64_tr_b16 v[158:159], v11 offset:33792
    v_mov_b32 v27, v250
    v_mfma_f32_16x16x32_bf16 v[140:143], v[188:191], v[204:207], v[140:143]
    v_mov_b32 v28, v251
    v_mov_b32 v29, v251
    v_mfma_f32_16x16x32_bf16 v[124:127], v[184:187], v[204:207], v[124:127]
    v_mov_b32 v30, v251
    v_mov_b32 v31, v251
    v_mfma_f32_16x16x32_bf16 v[108:111], v[180:183], v[204:207], v[108:111]
    v_mfma_f32_16x16x32_bf16 v[92:95], v[176:179], v[204:207], v[92:95]
    s_waitcnt lgkmcnt(0)
    v_mfma_f32_16x16x32_bf16 v[80:83], v[144:147], v[160:163], v[80:83]
    ds_read_b128 v[192:195], v13 offset:49152
    v_mov_b32 v32, v248
    v_mfma_f32_16x16x32_bf16 v[96:99], v[148:151], v[160:163], v[96:99]
    ds_read_b64_tr_b16 v[176:177], v8 offset:40960
    v_mov_b32 v33, v248
    v_mfma_f32_16x16x32_bf16 v[112:115], v[152:155], v[160:163], v[112:115]
    ds_read_b64_tr_b16 v[178:179], v8 offset:41984
    v_mov_b32 v34, v248
    v_mfma_f32_16x16x32_bf16 v[128:131], v[156:159], v[160:163], v[128:131]
    ds_read_b128 v[196:199], v13 offset:51200
    v_mov_b32 v35, v248
    v_mfma_f32_16x16x32_bf16 v[132:135], v[156:159], v[164:167], v[132:135]
    ds_read_b64_tr_b16 v[180:181], v9 offset:40960
    v_mov_b32 v36, v249
    v_mfma_f32_16x16x32_bf16 v[116:119], v[152:155], v[164:167], v[116:119]
    ds_read_b64_tr_b16 v[182:183], v9 offset:41984
    v_mov_b32 v37, v249
    v_mfma_f32_16x16x32_bf16 v[100:103], v[148:151], v[164:167], v[100:103]
    ds_read_b128 v[200:203], v13 offset:53248
    v_mov_b32 v38, v249
    v_mfma_f32_16x16x32_bf16 v[84:87], v[144:147], v[164:167], v[84:87]
    ds_read_b64_tr_b16 v[184:185], v10 offset:40960
    v_mov_b32 v39, v249
    v_mfma_f32_16x16x32_bf16 v[88:91], v[144:147], v[168:171], v[88:91]
    ds_read_b64_tr_b16 v[186:187], v10 offset:41984
    v_mov_b32 v40, v250
    v_mfma_f32_16x16x32_bf16 v[104:107], v[148:151], v[168:171], v[104:107]
    ds_read_b128 v[204:207], v13 offset:55296
L_pad_5:
    s_cmp_eq_u32 s99, 1
    s_cbranch_scc1 L_padret_5
    v_mov_b32 v41, v250
    v_mfma_f32_16x16x32_bf16 v[120:123], v[152:155], v[168:171], v[120:123]
    ds_read_b64_tr_b16 v[188:189], v11 offset:40960
    v_mov_b32 v42, v250
    v_mfma_f32_16x16x32_bf16 v[136:139], v[156:159], v[168:171], v[136:139]
    ds_read_b64_tr_b16 v[190:191], v11 offset:41984
    v_xor_b32 v8, s40, v8
    v_xor_b32 v9, s40, v9
    v_xor_b32 v10, s40, v10
    v_mfma_f32_16x16x32_bf16 v[140:143], v[156:159], v[172:175], v[140:143]
    v_xor_b32 v11, s40, v11
    v_xor_b32 v12, s40, v12
    v_mfma_f32_16x16x32_bf16 v[124:127], v[152:155], v[172:175], v[124:127]
    v_xor_b32 v13, s40, v13
    v_mov_b32 v43, v250
    v_mfma_f32_16x16x32_bf16 v[108:111], v[148:151], v[172:175], v[108:111]
    v_mov_b32 v44, v251
    v_mov_b32 v45, v251
    v_mfma_f32_16x16x32_bf16 v[92:95], v[144:147], v[172:175], v[92:95]
    v_mov_b32 v46, v251
    v_mov_b32 v47, v251
    s_waitcnt lgkmcnt(0)
    s_barrier
    v_mfma_f32_16x16x32_bf16 v[80:83], v[176:179], v[192:195], v[80:83]
    ds_read_b128 v[160:163], v12 offset:16384
    v_mov_b32 v48, v248
    v_mfma_f32_16x16x32_bf16 v[96:99], v[180:183], v[192:195], v[96:99]
    ds_read_b64_tr_b16 v[144:145], v8 offset:0
    v_mov_b32 v49, v248
    v_mfma_f32_16x16x32_bf16 v[112:115], v[184:187], v[192:195], v[112:115]
    ds_read_b64_tr_b16 v[146:147], v8 offset:1024
    v_mov_b32 v50, v248
    v_mfma_f32_16x16x32_bf16 v[128:131], v[188:191], v[192:195], v[128:131]
    ds_read_b128 v[164:167], v12 offset:18432
    v_mov_b32 v51, v248
    v_mfma_f32_16x16x32_bf16 v[132:135], v[188:191], v[196:199], v[132:135]
    ds_read_b64_tr_b16 v[148:149], v9 offset:0
    v_mov_b32 v52, v249
    v_mfma_f32_16x16x32_bf16 v[116:119], v[184:187], v[196:199], v[116:119]
    ds_read_b64_tr_b16 v[150:151], v9 offset:1024
    v_mov_b32 v53, v249
    v_mfma_f32_16x16x32_bf16 v[100:103], v[180:183], v[196:199], v[100:103]
    ds_read_b128 v[168:171], v12 offset:20480
    v_mov_b32 v54, v249
    v_mfma_f32_16x16x32_bf16 v[84:87], v[176:179], v[196:199], v[84:87]
    ds_read_b64_tr_b16 v[152:153], v10 offset:0
    v_mov_b32 v55, v249
    v_mfma_f32_16x16x32_bf16 v[88:91], v[176:179], v[200:203], v[88:91]
    ds_read_b64_tr_b16 v[154:155], v10 offset:1024
    v_mov_b32 v56, v250
    v_mfma_f32_16x16x32_bf16 v[104:107], v[180:183], v[200:203], v[104:107]
    ds_read_b128 v[172:175], v12 offset:22528
    v_mov_b32 v57, v250
    v_mfma_f32_16x16x32_bf16 v[120:123], v[184:187], v[200:203], v[120:123]
    ds_read_b64_tr_b16 v[156:157], v11 offset:0
    v_mov_b32 v58, v250
    v_mfma_f32_16x16x32_bf16 v[136:139], v[188:191], v[200:203], v[136:139]
    ds_read_b64_tr_b16 v[158:159], v11 offset:1024
    v_mov_b32 v59, v250
    v_mfma_f32_16x16x32_bf16 v[140:143], v[188:191], v[204:207], v[140:143]
    v_mov_b32 v60, v251
    v_mov_b32 v61, v251
    v_mfma_f32_16x16x32_bf16 v[124:127], v[184:187], v[204:207], v[124:127]
    v_mov_b32 v62, v251
    v_mov_b32 v63, v251
    v_mfma_f32_16x16x32_bf16 v[108:111], v[180:183], v[204:207], v[108:111]
    v_mfma_f32_16x16x32_bf16 v[92:95], v[176:179], v[204:207], v[92:95]
    s_waitcnt lgkmcnt(0)
    v_mfma_f32_16x16x32_bf16 v[80:83], v[144:147], v[160:163], v[80:83]
    ds_read_b128 v[192:195], v13 offset:16384
    v_mov_b32 v64, v248
    v_mfma_f32_16x16x32_bf16 v[96:99], v[148:151], v[160:163], v[96:99]
    ds_read_b64_tr_b16 v[176:177], v8 offset:8192
    v_mov_b32 v65, v248
    v_mfma_f32_16x16x32_bf16 v[112:115], v[152:155], v[160:163], v[112:115]
    ds_read_b64_tr_b16 v[178:179], v8 offset:9216
    v_mov_b32 v66, v248
    v_mfma_f32_16x16x32_bf16 v[128:131], v[156:159], v[160:163], v[128:131]
    ds_read_b128 v[196:199], v13 offset:18432
    v_mov_b32 v67, v248
    v_mfma_f32_16x16x32_bf16 v[132:135], v[156:159], v[164:167], v[132:135]
    ds_read_b64_tr_b16 v[180:181], v9 offset:8192
    v_mov_b32 v68, v249
    v_mfma_f32_16x16x32_bf16 v[116:119], v[152:155], v[164:167], v[116:119]
    ds_read_b64_tr_b16 v[182:183], v9 offset:9216
    v_mov_b32 v69, v249
    v_mfma_f32_16x16x32_bf16 v[100:103], v[148:151], v[164:167], v[100:103]
    ds_read_b128 v[200:203], v13 offset:20480
    v_mov_b32 v70, v249
    v_mfma_f32_16x16x32_bf16 v[84:87], v[144:147], v[164:167], v[84:87]
    ds_read_b64_tr_b16 v[184:185], v10 offset:8192
    v_mov_b32 v71, v249
    v_mfma_f32_16x16x32_bf16 v[88:91], v[144:147], v[168:171], v[88:91]
    ds_read_b64_tr_b16 v[186:187], v10 offset:9216
    v_mov_b32 v72, v250
    v_mfma_f32_16x16x32_bf16 v[104:107], v[148:151], v[168:171], v[104:107]
    ds_read_b128 v[204:207], v13 offset:22528
    v_mov_b32 v73, v250
    v_mfma_f32_16x16x32_bf16 v[120:123], v[152:155], v[168:171], v[120:123]
    ds_read_b64_tr_b16 v[188:189], v11 offset:8192
    v_mov_b32 v74, v250
    v_mfma_f32_16x16x32_bf16 v[136:139], v[156:159], v[168:171], v[136:139]
    ds_read_b64_tr_b16 v[190:191], v11 offset:9216
    v_mov_b32 v75, v250
    v_mfma_f32_16x16x32_bf16 v[140:143], v[156:159], v[172:175], v[140:143]
    v_mov_b32 v76, v251
    v_mov_b32 v77, v251
    v_mfma_f32_16x16x32_bf16 v[124:127], v[152:155], v[172:175], v[124:127]
    v_mov_b32 v78, v251
    v_mov_b32 v79, v251
    v_mfma_f32_16x16x32_bf16 v[108:111], v[148:151], v[172:175], v[108:111]
    v_mfma_f32_16x16x32_bf16 v[92:95], v[144:147], v[172:175], v[92:95]
    s_waitcnt vmcnt(0)
    s_waitcnt lgkmcnt(0)
    s_barrier
    v_mfma_f32_16x16x32_bf16 v[80:83], v[176:179], v[192:195], v[80:83]
    ds_read_b128 v[160:163], v12 offset:49152
    ds_read_b64_tr_b16 v[144:145], v8 offset:32768
    v_mfma_f32_16x16x32_bf16 v[96:99], v[180:183], v[192:195], v[96:99]
    ds_read_b64_tr_b16 v[146:147], v8 offset:33792
    ds_read_b128 v[164:167], v12 offset:51200
    v_mfma_f32_16x16x32_bf16 v[112:115], v[184:187], v[192:195], v[112:115]
    ds_read_b64_tr_b16 v[148:149], v9 offset:32768
    ds_read_b64_tr_b16 v[150:151], v9 offset:33792
    v_mfma_f32_16x16x32_bf16 v[128:131], v[188:191], v[192:195], v[128:131]
    ds_read_b128 v[168:171], v12 offset:53248
    ds_read_b64_tr_b16 v[152:153], v10 offset:32768
    v_mfma_f32_16x16x32_bf16 v[132:135], v[188:191], v[196:199], v[132:135]
    ds_read_b64_tr_b16 v[154:155], v10 offset:33792
    ds_read_b128 v[172:175], v12 offset:55296
    v_mfma_f32_16x16x32_bf16 v[116:119], v[184:187], v[196:199], v[116:119]
    ds_read_b64_tr_b16 v[156:157], v11 offset:32768
    ds_read_b64_tr_b16 v[158:159], v11 offset:33792
    v_mfma_f32_16x16x32_bf16 v[100:103], v[180:183], v[196:199], v[100:103]
    v_mfma_f32_16x16x32_bf16 v[84:87], v[176:179], v[196:199], v[84:87]
    v_mfma_f32_16x16x32_bf16 v[88:91], v[176:179], v[200:203], v[88:91]
    v_mfma_f32_16x16x32_bf16 v[104:107], v[180:183], v[200:203], v[104:107]
    v_mfma_f32_16x16x32_bf16 v[120:123], v[184:187], v[200:203], v[120:123]
    v_mfma_f32_16x16x32_bf16 v[136:139], v[188:191], v[200:203], v[136:139]
    v_mfma_f32_16x16x32_bf16 v[140:143], v[188:191], v[204:207], v[140:143]
    v_mfma_f32_16x16x32_bf16 v[124:127], v[184:187], v[204:207], v[124:127]
    v_mfma_f32_16x16x32_bf16 v[108:111], v[180:183], v[204:207], v[108:111]
    v_mfma_f32_16x16x32_bf16 v[92:95], v[176:179], v[204:207], v[92:95]
    s_waitcnt lgkmcnt(0)
    v_mfma_f32_16x16x32_bf16 v[80:83], v[144:147], v[160:163], v[80:83]
    ds_read_b128 v[192:195], v13 offset:49152
    ds_read_b64_tr_b16 v[176:177], v8 offset:40960
    v_mfma_f32_16x16x32_bf16 v[96:99], v[148:151], v[160:163], v[96:99]
    ds_read_b64_tr_b16 v[178:179], v8 offset:41984
    ds_read_b128 v[196:199], v13 offset:51200
    v_mfma_f32_16x16x32_bf16 v[112:115], v[152:155], v[160:163], v[112:115]
    ds_read_b64_tr_b16 v[180:181], v9 offset:40960
    ds_read_b64_tr_b16 v[182:183], v9 offset:41984
    v_mfma_f32_16x16x32_bf16 v[128:131], v[156:159], v[160:163], v[128:131]
    ds_read_b128 v[200:203], v13 offset:53248
    ds_read_b64_tr_b16 v[184:185], v10 offset:40960
    v_mfma_f32_16x16x32_bf16 v[132:135], v[156:159], v[164:167], v[132:135]
    ds_read_b64_tr_b16 v[186:187], v10 offset:41984
    ds_read_b128 v[204:207], v13 offset:55296
    v_mfma_f32_16x16x32_bf16 v[116:119], v[152:155], v[164:167], v[116:119]
    ds_read_b64_tr_b16 v[188:189], v11 offset:40960
    ds_read_b64_tr_b16 v[190:191], v11 offset:41984
    v_xor_b32 v8, s40, v8
    v_mfma_f32_16x16x32_bf16 v[100:103], v[148:151], v[164:167], v[100:103]
    v_xor_b32 v9, s40, v9
    v_xor_b32 v10, s40, v10
    v_mfma_f32_16x16x32_bf16 v[84:87], v[144:147], v[164:167], v[84:87]
    v_xor_b32 v11, s40, v11
    v_xor_b32 v12, s40, v12
    v_mfma_f32_16x16x32_bf16 v[88:91], v[144:147], v[168:171], v[88:91]
    v_xor_b32 v13, s40, v13
    v_mfma_f32_16x16x32_bf16 v[104:107], v[148:151], v[168:171], v[104:107]
    v_mfma_f32_16x16x32_bf16 v[120:123], v[152:155], v[168:171], v[120:123]
    v_mfma_f32_16x16x32_bf16 v[136:139], v[156:159], v[168:171], v[136:139]
    v_mfma_f32_16x16x32_bf16 v[140:143], v[156:159], v[172:175], v[140:143]
    v_mfma_f32_16x16x32_bf16 v[124:127], v[152:155], v[172:175], v[124:127]
    v_mfma_f32_16x16x32_bf16 v[108:111], v[148:151], v[172:175], v[108:111]
    v_mfma_f32_16x16x32_bf16 v[92:95], v[144:147], v[172:175], v[92:95]
    s_waitcnt lgkmcnt(0)
    s_barrier
    v_mfma_f32_16x16x32_bf16 v[80:83], v[176:179], v[192:195], v[80:83]
    ds_read_b128 v[160:163], v12 offset:16384
    ds_read_b64_tr_b16 v[144:145], v8 offset:0
    v_mfma_f32_16x16x32_bf16 v[96:99], v[180:183], v[192:195], v[96:99]
    ds_read_b64_tr_b16 v[146:147], v8 offset:1024
    ds_read_b128 v[164:167], v12 offset:18432
    v_mfma_f32_16x16x32_bf16 v[112:115], v[184:187], v[192:195], v[112:115]
    ds_read_b64_tr_b16 v[148:149], v9 offset:0
    ds_read_b64_tr_b16 v[150:151], v9 offset:1024
    v_mfma_f32_16x16x32_bf16 v[128:131], v[188:191], v[192:195], v[128:131]
    ds_read_b128 v[168:171], v12 offset:20480
    ds_read_b64_tr_b16 v[152:153], v10 offset:0
    v_mfma_f32_16x16x32_bf16 v[132:135], v[188:191], v[196:199], v[132:135]
    ds_read_b64_tr_b16 v[154:155], v10 offset:1024
    ds_read_b128 v[172:175], v12 offset:22528
    v_mfma_f32_16x16x32_bf16 v[116:119], v[184:187], v[196:199], v[116:119]
    ds_read_b64_tr_b16 v[156:157], v11 offset:0
    ds_read_b64_tr_b16 v[158:159], v11 offset:1024
    v_mfma_f32_16x16x32_bf16 v[100:103], v[180:183], v[196:199], v[100:103]
    v_mfma_f32_16x16x32_bf16 v[84:87], v[176:179], v[196:199], v[84:87]
    v_mfma_f32_16x16x32_bf16 v[88:91], v[176:179], v[200:203], v[88:91]
    v_mfma_f32_16x16x32_bf16 v[104:107], v[180:183], v[200:203], v[104:107]
    v_mfma_f32_16x16x32_bf16 v[120:123], v[184:187], v[200:203], v[120:123]
    v_mfma_f32_16x16x32_bf16 v[136:139], v[188:191], v[200:203], v[136:139]
    v_mfma_f32_16x16x32_bf16 v[140:143], v[188:191], v[204:207], v[140:143]
    v_mfma_f32_16x16x32_bf16 v[124:127], v[184:187], v[204:207], v[124:127]
    v_mfma_f32_16x16x32_bf16 v[108:111], v[180:183], v[204:207], v[108:111]
    v_mfma_f32_16x16x32_bf16 v[92:95], v[176:179], v[204:207], v[92:95]
    s_waitcnt lgkmcnt(0)
    v_mfma_f32_16x16x32_bf16 v[80:83], v[144:147], v[160:163], v[80:83]
    ds_read_b128 v[192:195], v13 offset:16384
    ds_read_b64_tr_b16 v[176:177], v8 offset:8192
    v_mfma_f32_16x16x32_bf16 v[96:99], v[148:151], v[160:163], v[96:99]
    ds_read_b64_tr_b16 v[178:179], v8 offset:9216
    ds_read_b128 v[196:199], v13 offset:18432
    v_mfma_f32_16x16x32_bf16 v[112:115], v[152:155], v[160:163], v[112:115]
    ds_read_b64_tr_b16 v[180:181], v9 offset:8192
    ds_read_b64_tr_b16 v[182:183], v9 offset:9216
    v_mfma_f32_16x16x32_bf16 v[128:131], v[156:159], v[160:163], v[128:131]
    ds_read_b128 v[200:203], v13 offset:20480
    ds_read_b64_tr_b16 v[184:185], v10 offset:8192
    v_mfma_f32_16x16x32_bf16 v[132:135], v[156:159], v[164:167], v[132:135]
    ds_read_b64_tr_b16 v[186:187], v10 offset:9216
    ds_read_b128 v[204:207], v13 offset:22528
    v_mfma_f32_16x16x32_bf16 v[116:119], v[152:155], v[164:167], v[116:119]
    ds_read_b64_tr_b16 v[188:189], v11 offset:8192
    ds_read_b64_tr_b16 v[190:191], v11 offset:9216
    v_mfma_f32_16x16x32_bf16 v[100:103], v[148:151], v[164:167], v[100:103]
    v_mfma_f32_16x16x32_bf16 v[84:87], v[144:147], v[164:167], v[84:87]
    v_mfma_f32_16x16x32_bf16 v[88:91], v[144:147], v[168:171], v[88:91]
    v_mfma_f32_16x16x32_bf16 v[104:107], v[148:151], v[168:171], v[104:107]
    v_mfma_f32_16x16x32_bf16 v[120:123], v[152:155], v[168:171], v[120:123]
    v_mfma_f32_16x16x32_bf16 v[136:139], v[156:159], v[168:171], v[136:139]
    v_mfma_f32_16x16x32_bf16 v[140:143], v[156:159], v[172:175], v[140:143]
    v_mfma_f32_16x16x32_bf16 v[124:127], v[152:155], v[172:175], v[124:127]
    v_mfma_f32_16x16x32_bf16 v[108:111], v[148:151], v[172:175], v[108:111]
    v_mfma_f32_16x16x32_bf16 v[92:95], v[144:147], v[172:175], v[92:95]
    s_waitcnt lgkmcnt(0)
    s_barrier
    v_mfma_f32_16x16x32_bf16 v[80:83], v[176:179], v[192:195], v[80:83]
    ds_read_b128 v[160:163], v12 offset:49152
    ds_read_b64_tr_b16 v[144:145], v8 offset:32768
    v_mfma_f32_16x16x32_bf16 v[96:99], v[180:183], v[192:195], v[96:99]
    ds_read_b64_tr_b16 v[146:147], v8 offset:33792
    ds_read_b128 v[164:167], v12 offset:51200
    v_mfma_f32_16x16x32_bf16 v[112:115], v[184:187], v[192:195], v[112:115]
    ds_read_b64_tr_b16 v[148:149], v9 offset:32768
    ds_read_b64_tr_b16 v[150:151], v9 offset:33792
    v_mfma_f32_16x16x32_bf16 v[128:131], v[188:191], v[192:195], v[128:131]
    ds_read_b128 v[168:171], v12 offset:53248
    ds_read_b64_tr_b16 v[152:153], v10 offset:32768
    v_mfma_f32_16x16x32_bf16 v[132:135], v[188:191], v[196:199], v[132:135]
    ds_read_b64_tr_b16 v[154:155], v10 offset:33792
    ds_read_b128 v[172:175], v12 offset:55296
    v_mfma_f32_16x16x32_bf16 v[116:119], v[184:187], v[196:199], v[116:119]
    ds_read_b64_tr_b16 v[156:157], v11 offset:32768
    ds_read_b64_tr_b16 v[158:159], v11 offset:33792
    v_mfma_f32_16x16x32_bf16 v[100:103], v[180:183], v[196:199], v[100:103]
    v_mfma_f32_16x16x32_bf16 v[84:87], v[176:179], v[196:199], v[84:87]
    v_mfma_f32_16x16x32_bf16 v[88:91], v[176:179], v[200:203], v[88:91]
    v_mfma_f32_16x16x32_bf16 v[104:107], v[180:183], v[200:203], v[104:107]
    v_mfma_f32_16x16x32_bf16 v[120:123], v[184:187], v[200:203], v[120:123]
    v_mfma_f32_16x16x32_bf16 v[136:139], v[188:191], v[200:203], v[136:139]
    v_mfma_f32_16x16x32_bf16 v[140:143], v[188:191], v[204:207], v[140:143]
    v_mfma_f32_16x16x32_bf16 v[124:127], v[184:187], v[204:207], v[124:127]
    v_mfma_f32_16x16x32_bf16 v[108:111], v[180:183], v[204:207], v[108:111]
    v_mfma_f32_16x16x32_bf16 v[92:95], v[176:179], v[204:207], v[92:95]
    s_waitcnt lgkmcnt(0)
    v_mfma_f32_16x16x32_bf16 v[80:83], v[144:147], v[160:163], v[80:83]
    ds_read_b128 v[192:195], v13 offset:49152
    ds_read_b64_tr_b16 v[176:177], v8 offset:40960
    v_mfma_f32_16x16x32_bf16 v[96:99], v[148:151], v[160:163], v[96:99]
    ds_read_b64_tr_b16 v[178:179], v8 offset:41984
    ds_read_b128 v[196:199], v13 offset:51200
    v_mfma_f32_16x16x32_bf16 v[112:115], v[152:155], v[160:163], v[112:115]
    ds_read_b64_tr_b16 v[180:181], v9 offset:40960
    ds_read_b64_tr_b16 v[182:183], v9 offset:41984
    v_mfma_f32_16x16x32_bf16 v[128:131], v[156:159], v[160:163], v[128:131]
    ds_read_b128 v[200:203], v13 offset:53248
    ds_read_b64_tr_b16 v[184:185], v10 offset:40960
    v_mfma_f32_16x16x32_bf16 v[132:135], v[156:159], v[164:167], v[132:135]
    ds_read_b64_tr_b16 v[186:187], v10 offset:41984
    ds_read_b128 v[204:207], v13 offset:55296
    v_mfma_f32_16x16x32_bf16 v[116:119], v[152:155], v[164:167], v[116:119]
    ds_read_b64_tr_b16 v[188:189], v11 offset:40960
    ds_read_b64_tr_b16 v[190:191], v11 offset:41984
    v_xor_b32 v8, s40, v8
    v_mfma_f32_16x16x32_bf16 v[100:103], v[148:151], v[164:167], v[100:103]
    v_xor_b32 v9, s40, v9
    v_xor_b32 v10, s40, v10
    v_mfma_f32_16x16x32_bf16 v[84:87], v[144:147], v[164:167], v[84:87]
    v_xor_b32 v11, s40, v11
    v_xor_b32 v12, s40, v12
    v_mfma_f32_16x16x32_bf16 v[88:91], v[144:147], v[168:171], v[88:91]
    v_xor_b32 v13, s40, v13
    v_mfma_f32_16x16x32_bf16 v[104:107], v[148:151], v[168:171], v[104:107]
    v_mfma_f32_16x16x32_bf16 v[120:123], v[152:155], v[168:171], v[120:123]
    v_mfma_f32_16x16x32_bf16 v[136:139], v[156:159], v[168:171], v[136:139]
    v_mfma_f32_16x16x32_bf16 v[140:143], v[156:159], v[172:175], v[140:143]
    v_mfma_f32_16x16x32_bf16 v[124:127], v[152:155], v[172:175], v[124:127]
    v_mfma_f32_16x16x32_bf16 v[108:111], v[148:151], v[172:175], v[108:111]
    v_mfma_f32_16x16x32_bf16 v[92:95], v[144:147], v[172:175], v[92:95]
    s_waitcnt lgkmcnt(0)
    s_barrier
    v_mfma_f32_16x16x32_bf16 v[80:83], v[176:179], v[192:195], v[80:83]
    v_mfma_f32_16x16x32_bf16 v[96:99], v[180:183], v[192:195], v[96:99]
    v_mfma_f32_16x16x32_bf16 v[112:115], v[184:187], v[192:195], v[112:115]
    v_mfma_f32_16x16x32_bf16 v[128:131], v[188:191], v[192:195], v[128:131]
    v_mfma_f32_16x16x32_bf16 v[132:135], v[188:191], v[196:199], v[132:135]
    v_mfma_f32_16x16x32_bf16 v[116:119], v[184:187], v[196:199], v[116:119]
    v_mfma_f32_16x16x32_bf16 v[100:103], v[180:183], v[196:199], v[100:103]
    v_mfma_f32_16x16x32_bf16 v[84:87], v[176:179], v[196:199], v[84:87]
    v_mfma_f32_16x16x32_bf16 v[88:91], v[176:179], v[200:203], v[88:91]
    v_mfma_f32_16x16x32_bf16 v[104:107], v[180:183], v[200:203], v[104:107]
    v_mfma_f32_16x16x32_bf16 v[120:123], v[184:187], v[200:203], v[120:123]
    v_mfma_f32_16x16x32_bf16 v[136:139], v[188:191], v[200:203], v[136:139]
    v_mfma_f32_16x16x32_bf16 v[140:143], v[188:191], v[204:207], v[140:143]
    v_mfma_f32_16x16x32_bf16 v[124:127], v[184:187], v[204:207], v[124:127]
    v_mfma_f32_16x16x32_bf16 v[108:111], v[180:183], v[204:207], v[108:111]
    v_mfma_f32_16x16x32_bf16 v[92:95], v[176:179], v[204:207], v[92:95]
    v_pk_mul_f32 v[208:209], v[80:81], v[80:81]
    v_pk_mul_f32 v[210:211], v[82:83], v[82:83]
    v_pk_mul_f32 v[212:213], v[84:85], v[84:85]
    v_pk_mul_f32 v[214:215], v[86:87], v[86:87]
    v_pk_fma_f32 v[208:209], v[208:209], s[42:43], v[14:15]
    v_pk_fma_f32 v[210:211], v[210:211], s[42:43], v[14:15]
    v_pk_fma_f32 v[212:213], v[212:213], s[42:43], v[14:15]
    v_pk_fma_f32 v[214:215], v[214:215], s[42:43], v[14:15]
    v_pk_mul_f32 v[208:209], v[208:209], v[80:81]
    v_pk_mul_f32 v[210:211], v[210:211], v[82:83]
    v_pk_mul_f32 v[212:213], v[212:213], v[84:85]
    v_pk_mul_f32 v[214:215], v[214:215], v[86:87]
    v_exp_f32 v208, v208
    v_exp_f32 v209, v209
    v_exp_f32 v210, v210
    v_exp_f32 v211, v211
    v_exp_f32 v212, v212
    v_exp_f32 v213, v213
    v_exp_f32 v214, v214
    v_exp_f32 v215, v215
    v_pk_add_f32 v[208:209], v[208:209], 1.0 op_sel_hi:[1,0]
    v_pk_add_f32 v[210:211], v[210:211], 1.0 op_sel_hi:[1,0]
    v_pk_add_f32 v[212:213], v[212:213], 1.0 op_sel_hi:[1,0]
    v_pk_add_f32 v[214:215], v[214:215], 1.0 op_sel_hi:[1,0]
    v_rcp_f32 v208, v208
    v_rcp_f32 v209, v209
    v_rcp_f32 v210, v210
    v_rcp_f32 v211, v211
    v_rcp_f32 v212, v212
    v_rcp_f32 v213, v213
    v_rcp_f32 v214, v214
    v_rcp_f32 v215, v215
    v_pk_mul_f32 v[80:81], v[80:81], v[208:209]
    v_pk_mul_f32 v[82:83], v[82:83], v[210:211]
    v_pk_mul_f32 v[84:85], v[84:85], v[212:213]
    v_pk_mul_f32 v[86:87], v[86:87], v[214:215]
    v_pk_mul_f32 v[208:209], v[88:89], v[88:89]
    v_pk_mul_f32 v[210:211], v[90:91], v[90:91]
    v_pk_mul_f32 v[212:213], v[92:93], v[92:93]
    v_pk_mul_f32 v[214:215], v[94:95], v[94:95]
    v_pk_fma_f32 v[208:209], v[208:209], s[42:43], v[14:15]
    v_pk_fma_f32 v[210:211], v[210:211], s[42:43], v[14:15]
    v_pk_fma_f32 v[212:213], v[212:213], s[42:43], v[14:15]
    v_pk_fma_f32 v[214:215], v[214:215], s[42:43], v[14:15]
    v_pk_mul_f32 v[208:209], v[208:209], v[88:89]
    v_pk_mul_f32 v[210:211], v[210:211], v[90:91]
    v_pk_mul_f32 v[212:213], v[212:213], v[92:93]
    v_pk_mul_f32 v[214:215], v[214:215], v[94:95]
    v_exp_f32 v208, v208
    v_exp_f32 v209, v209
    v_exp_f32 v210, v210
    v_exp_f32 v211, v211
    v_exp_f32 v212, v212
    v_exp_f32 v213, v213
    v_exp_f32 v214, v214
    v_exp_f32 v215, v215
    v_pk_add_f32 v[208:209], v[208:209], 1.0 op_sel_hi:[1,0]
    v_pk_add_f32 v[210:211], v[210:211], 1.0 op_sel_hi:[1,0]
    v_pk_add_f32 v[212:213], v[212:213], 1.0 op_sel_hi:[1,0]
    v_pk_add_f32 v[214:215], v[214:215], 1.0 op_sel_hi:[1,0]
    v_rcp_f32 v208, v208
    v_rcp_f32 v209, v209
    v_rcp_f32 v210, v210
    v_rcp_f32 v211, v211
    v_rcp_f32 v212, v212
    v_rcp_f32 v213, v213
    v_rcp_f32 v214, v214
    v_rcp_f32 v215, v215
    v_pk_mul_f32 v[88:89], v[88:89], v[208:209]
    v_pk_mul_f32 v[90:91], v[90:91], v[210:211]
    v_pk_mul_f32 v[92:93], v[92:93], v[212:213]
    v_pk_mul_f32 v[94:95], v[94:95], v[214:215]
    s_barrier
    ds_read_b128 v[160:163], v12 offset:16384
    ds_read_b64_tr_b16 v[144:145], v8 offset:0
    ds_read_b64_tr_b16 v[146:147], v8 offset:1024
    ds_read_b128 v[164:167], v12 offset:18432
    ds_read_b64_tr_b16 v[148:149], v9 offset:0
    ds_read_b64_tr_b16 v[150:151], v9 offset:1024
    ds_read_b128 v[168:171], v12 offset:20480
    ds_read_b64_tr_b16 v[152:153], v10 offset:0
    ds_read_b64_tr_b16 v[154:155], v10 offset:1024
    ds_read_b128 v[172:175], v12 offset:22528
    ds_read_b64_tr_b16 v[156:157], v11 offset:0
    ds_read_b64_tr_b16 v[158:159], v11 offset:1024
    s_waitcnt lgkmcnt(0)
    v_mfma_f32_16x16x32_bf16 v[16:19], v[144:147], v[160:163], v[16:19]
    ds_read_b128 v[192:195], v13 offset:16384
    v_mul_f32 v208, v96, v96
    v_mfma_f32_16x16x32_bf16 v[32:35], v[148:151], v[160:163], v[32:35]
    ds_read_b64_tr_b16 v[176:177], v8 offset:8192
    v_mul_f32 v209, v97, v97
    v_mfma_f32_16x16x32_bf16 v[48:51], v[152:155], v[160:163], v[48:51]
    ds_read_b64_tr_b16 v[178:179], v8 offset:9216
    v_mul_f32 v210, v98, v98
    v_mfma_f32_16x16x32_bf16 v[64:67], v[156:159], v[160:163], v[64:67]
    ds_read_b128 v[196:199], v13 offset:18432
    v_mul_f32 v211, v99, v99
    v_mfma_f32_16x16x32_bf16 v[68:71], v[156:159], v[164:167], v[68:71]
    ds_read_b64_tr_b16 v[180:181], v9 offset:8192
    v_fma_f32 v208, v208, s42, v14
    v_mfma_f32_16x16x32_bf16 v[52:55], v[152:155], v[164:167], v[52:55]
    ds_read_b64_tr_b16 v[182:183], v9 offset:9216
    v_fma_f32 v209, v209, s42, v14
    v_mfma_f32_16x16x32_bf16 v[36:39], v[148:151], v[164:167], v[36:39]
    ds_read_b128 v[200:203], v13 offset:20480
    v_fma_f32 v210, v210, s42, v14
    v_mfma_f32_16x16x32_bf16 v[20:23], v[144:147], v[164:167], v[20:23]
    ds_read_b64_tr_b16 v[184:185], v10 offset:8192
    v_fma_f32 v211, v211, s42, v14
    v_mfma_f32_16x16x32_bf16 v[24:27], v[144:147], v[168:171], v[24:27]
    ds_read_b64_tr_b16 v[186:187], v10 offset:9216
    v_mul_f32 v208, v208, v96
    v_mfma_f32_16x16x32_bf16 v[40:43], v[148:151], v[168:171], v[40:43]
    ds_read_b128 v[204:207], v13 offset:22528
    v_mul_f32 v209, v209, v97
    v_mfma_f32_16x16x32_bf16 v[56:59], v[152:155], v[168:171], v[56:59]
    ds_read_b64_tr_b16 v[188:189], v11 offset:8192
    v_mul_f32 v210, v210, v98
    v_mfma_f32_16x16x32_bf16 v[72:75], v[156:159], v[168:171], v[72:75]
    ds_read_b64_tr_b16 v[190:191], v11 offset:9216
    v_mul_f32 v211, v211, v99
    v_exp_f32 v208, v208
    v_exp_f32 v209, v209
    v_mfma_f32_16x16x32_bf16 v[76:79], v[156:159], v[172:175], v[76:79]
    v_exp_f32 v210, v210
    v_exp_f32 v211, v211
    v_mfma_f32_16x16x32_bf16 v[60:63], v[152:155], v[172:175], v[60:63]
    v_add_f32 v208, 1.0, v208
    v_add_f32 v209, 1.0, v209
    v_add_f32 v210, 1.0, v210
    v_add_f32 v211, 1.0, v211
    v_mfma_f32_16x16x32_bf16 v[44:47], v[148:151], v[172:175], v[44:47]
    v_rcp_f32 v208, v208
    v_rcp_f32 v209, v209
    v_mfma_f32_16x16x32_bf16 v[28:31], v[144:147], v[172:175], v[28:31]
    v_rcp_f32 v210, v210
    v_rcp_f32 v211, v211
    v_mul_f32 v96, v96, v208
    v_mul_f32 v97, v97, v209
    v_mul_f32 v98, v98, v210
    v_mul_f32 v99, v99, v211
    s_waitcnt lgkmcnt(0)
    s_barrier
    v_mfma_f32_16x16x32_bf16 v[16:19], v[176:179], v[192:195], v[16:19]
    ds_read_b128 v[160:163], v12 offset:49152
    v_mul_f32 v208, v100, v100
    v_mfma_f32_16x16x32_bf16 v[32:35], v[180:183], v[192:195], v[32:35]
    ds_read_b64_tr_b16 v[144:145], v8 offset:32768
    v_mul_f32 v209, v101, v101
    v_mfma_f32_16x16x32_bf16 v[48:51], v[184:187], v[192:195], v[48:51]
    ds_read_b64_tr_b16 v[146:147], v8 offset:33792
    v_mul_f32 v210, v102, v102
    v_mfma_f32_16x16x32_bf16 v[64:67], v[188:191], v[192:195], v[64:67]
    ds_read_b128 v[164:167], v12 offset:51200
    v_mul_f32 v211, v103, v103
    v_mfma_f32_16x16x32_bf16 v[68:71], v[188:191], v[196:199], v[68:71]
    ds_read_b64_tr_b16 v[148:149], v9 offset:32768
    v_fma_f32 v208, v208, s42, v14
    v_mfma_f32_16x16x32_bf16 v[52:55], v[184:187], v[196:199], v[52:55]
    ds_read_b64_tr_b16 v[150:151], v9 offset:33792
    v_fma_f32 v209, v209, s42, v14
    v_mfma_f32_16x16x32_bf16 v[36:39], v[180:183], v[196:199], v[36:39]
    ds_read_b128 v[168:171], v12 offset:53248
    v_fma_f32 v210, v210, s42, v14
    v_mfma_f32_16x16x32_bf16 v[20:23], v[176:179], v[196:199], v[20:23]
    ds_read_b64_tr_b16 v[152:153], v10 offset:32768
    v_fma_f32 v211, v211, s42, v14
    v_mfma_f32_16x16x32_bf16 v[24:27], v[176:179], v[200:203], v[24:27]
    ds_read_b64_tr_b16 v[154:155], v10 offset:33792
    v_mul_f32 v208, v208, v100
    v_mfma_f32_16x16x32_bf16 v[40:43], v[180:183], v[200:203], v[40:43]
    ds_read_b128 v[172:175], v12 offset:55296
    v_mul_f32 v209, v209, v101
    v_mfma_f32_16x16x32_bf16 v[56:59], v[184:187], v[200:203], v[56:59]
    ds_read_b64_tr_b16 v[156:157], v11 offset:32768
    v_mul_f32 v210, v210, v102
    v_mfma_f32_16x16x32_bf16 v[72:75], v[188:191], v[200:203], v[72:75]
    ds_read_b64_tr_b16 v[158:159], v11 offset:33792
    v_mul_f32 v211, v211, v103
    v_mfma_f32_16x16x32_bf16 v[76:79], v[188:191], v[204:207], v[76:79]
    v_exp_f32 v208, v208
    v_mfma_f32_16x16x32_bf16 v[60:63], v[184:187], v[204:207], v[60:63]
    v_exp_f32 v209, v209
    v_mfma_f32_16x16x32_bf16 v[44:47], v[180:183], v[204:207], v[44:47]
    v_mfma_f32_16x16x32_bf16 v[28:31], v[176:179], v[204:207], v[28:31]
    s_waitcnt lgkmcnt(0)
    v_mfma_f32_16x16x32_bf16 v[16:19], v[144:147], v[160:163], v[16:19]
    ds_read_b128 v[192:195], v13 offset:49152
    v_exp_f32 v210, v210
    v_mfma_f32_16x16x32_bf16 v[32:35], v[148:151], v[160:163], v[32:35]
    ds_read_b64_tr_b16 v[176:177], v8 offset:40960
    v_exp_f32 v211, v211
    v_mfma_f32_16x16x32_bf16 v[48:51], v[152:155], v[160:163], v[48:51]
    ds_read_b64_tr_b16 v[178:179], v8 offset:41984
    v_add_f32 v208, 1.0, v208
    v_mfma_f32_16x16x32_bf16 v[64:67], v[156:159], v[160:163], v[64:67]
    ds_read_b128 v[196:199], v13 offset:51200
    v_add_f32 v209, 1.0, v209
    v_mfma_f32_16x16x32_bf16 v[68:71], v[156:159], v[164:167], v[68:71]
    ds_read_b64_tr_b16 v[180:181], v9 offset:40960
    v_add_f32 v210, 1.0, v210
    v_mfma_f32_16x16x32_bf16 v[52:55], v[152:155], v[164:167], v[52:55]
    ds_read_b64_tr_b16 v[182:183], v9 offset:41984
    v_add_f32 v211, 1.0, v211
    v_mfma_f32_16x16x32_bf16 v[36:39], v[148:151], v[164:167], v[36:39]
    ds_read_b128 v[200:203], v13 offset:53248
    v_rcp_f32 v208, v208
    v_mfma_f32_16x16x32_bf16 v[20:23], v[144:147], v[164:167], v[20:23]
    ds_read_b64_tr_b16 v[184:185], v10 offset:40960
    v_rcp_f32 v209, v209
    v_mfma_f32_16x16x32_bf16 v[24:27], v[144:147], v[168:171], v[24:27]
    ds_read_b64_tr_b16 v[186:187], v10 offset:41984
    v_rcp_f32 v210, v210
    v_mfma_f32_16x16x32_bf16 v[40:43], v[148:151], v[168:171], v[40:43]
    ds_read_b128 v[204:207], v13 offset:55296
    v_rcp_f32 v211, v211
    v_mfma_f32_16x16x32_bf16 v[56:59], v[152:155], v[168:171], v[56:59]
    ds_read_b64_tr_b16 v[188:189], v11 offset:40960
    v_mul_f32 v100, v100, v208
    v_mfma_f32_16x16x32_bf16 v[72:75], v[156:159], v[168:171], v[72:75]
    ds_read_b64_tr_b16 v[190:191], v11 offset:41984
    v_xor_b32 v8, s40, v8
    v_xor_b32 v9, s40, v9
    v_mfma_f32_16x16x32_bf16 v[76:79], v[156:159], v[172:175], v[76:79]
    v_xor_b32 v10, s40, v10
    v_xor_b32 v11, s40, v11
    v_mfma_f32_16x16x32_bf16 v[60:63], v[152:155], v[172:175], v[60:63]
    v_xor_b32 v12, s40, v12
    v_xor_b32 v13, s40, v13
    v_mfma_f32_16x16x32_bf16 v[44:47], v[148:151], v[172:175], v[44:47]
    v_mul_f32 v101, v101, v209
    v_mul_f32 v102, v102, v210
    v_mfma_f32_16x16x32_bf16 v[28:31], v[144:147], v[172:175], v[28:31]
    v_mul_f32 v103, v103, v211
    s_waitcnt lgkmcnt(0)
    s_barrier
    v_mfma_f32_16x16x32_bf16 v[16:19], v[176:179], v[192:195], v[16:19]
    ds_read_b128 v[160:163], v12 offset:16384
    v_mul_f32 v208, v104, v104
    v_mfma_f32_16x16x32_bf16 v[32:35], v[180:183], v[192:195], v[32:35]
    ds_read_b64_tr_b16 v[144:145], v8 offset:0
    v_mul_f32 v209, v105, v105
    v_mfma_f32_16x16x32_bf16 v[48:51], v[184:187], v[192:195], v[48:51]
    ds_read_b64_tr_b16 v[146:147], v8 offset:1024
    v_mul_f32 v210, v106, v106
    v_mfma_f32_16x16x32_bf16 v[64:67], v[188:191], v[192:195], v[64:67]
    ds_read_b128 v[164:167], v12 offset:18432
    v_mul_f32 v211, v107, v107
    v_mfma_f32_16x16x32_bf16 v[68:71], v[188:191], v[196:199], v[68:71]
    ds_read_b64_tr_b16 v[148:149], v9 offset:0
    v_fma_f32 v208, v208, s42, v14
    v_mfma_f32_16x16x32_bf16 v[52:55], v[184:187], v[196:199], v[52:55]
    ds_read_b64_tr_b16 v[150:151], v9 offset:1024
    v_fma_f32 v209, v209, s42, v14
    v_mfma_f32_16x16x32_bf16 v[36:39], v[180:183], v[196:199], v[36:39]
    ds_read_b128 v[168:171], v12 offset:20480
    v_fma_f32 v210, v210, s42, v14
    v_mfma_f32_16x16x32_bf16 v[20:23], v[176:179], v[196:199], v[20:23]
    ds_read_b64_tr_b16 v[152:153], v10 offset:0
    v_fma_f32 v211, v211, s42, v14
    v_mfma_f32_16x16x32_bf16 v[24:27], v[176:179], v[200:203], v[24:27]
    ds_read_b64_tr_b16 v[154:155], v10 offset:1024
    v_mul_f32 v208, v208, v104
    v_mfma_f32_16x16x32_bf16 v[40:43], v[180:183], v[200:203], v[40:43]
    ds_read_b128 v[172:175], v12 offset:22528
    v_mul_f32 v209, v209, v105
    v_mfma_f32_16x16x32_bf16 v[56:59], v[184:187], v[200:203], v[56:59]
    ds_read_b64_tr_b16 v[156:157], v11 offset:0
    v_mul_f32 v210, v210, v106
    v_mfma_f32_16x16x32_bf16 v[72:75], v[188:191], v[200:203], v[72:75]
    ds_read_b64_tr_b16 v[158:159], v11 offset:1024
    v_mul_f32 v211, v211, v107
    v_mfma_f32_16x16x32_bf16 v[76:79], v[188:191], v[204:207], v[76:79]
    v_exp_f32 v208, v208
    v_mfma_f32_16x16x32_bf16 v[60:63], v[184:187], v[204:207], v[60:63]
    v_exp_f32 v209, v209
    v_mfma_f32_16x16x32_bf16 v[44:47], v[180:183], v[204:207], v[44:47]
    v_mfma_f32_16x16x32_bf16 v[28:31], v[176:179], v[204:207], v[28:31]
    s_waitcnt lgkmcnt(0)
L_pad_6:
    s_cmp_eq_u32 s99, 1
    s_cbranch_scc1 L_padret_6
    v_mfma_f32_16x16x32_bf16 v[16:19], v[144:147], v[160:163], v[16:19]
    ds_read_b128 v[192:195], v13 offset:16384
    v_exp_f32 v210, v210
    v_mfma_f32_16x16x32_bf16 v[32:35], v[148:151], v[160:163], v[32:35]
    ds_read_b64_tr_b16 v[176:177], v8 offset:8192
    v_exp_f32 v211, v211
    v_mfma_f32_16x16x32_bf16 v[48:51], v[152:155], v[160:163], v[48:51]
    ds_read_b64_tr_b16 v[178:179], v8 offset:9216
    v_add_f32 v208, 1.0, v208
    v_mfma_f32_16x16x32_bf16 v[64:67], v[156:159], v[160:163], v[64:67]
    ds_read_b128 v[196:199], v13 offset:18432
    v_add_f32 v209, 1.0, v209
    v_mfma_f32_16x16x32_bf16 v[68:71], v[156:159], v[164:167], v[68:71]
    ds_read_b64_tr_b16 v[180:181], v9 offset:8192
    v_add_f32 v210, 1.0, v210
    v_mfma_f32_16x16x32_bf16 v[52:55], v[152:155], v[164:167], v[52:55]
    ds_read_b64_tr_b16 v[182:183], v9 offset:9216
    v_add_f32 v211, 1.0, v211
    v_mfma_f32_16x16x32_bf16 v[36:39], v[148:151], v[164:167], v[36:39]
    ds_read_b128 v[200:203], v13 offset:20480
    v_rcp_f32 v208, v208
    v_mfma_f32_16x16x32_bf16 v[20:23], v[144:147], v[164:167], v[20:23]
    ds_read_b64_tr_b16 v[184:185], v10 offset:8192
    v_rcp_f32 v209, v209
    v_mfma_f32_16x16x32_bf16 v[24:27], v[144:147], v[168:171], v[24:27]
    ds_read_b64_tr_b16 v[186:187], v10 offset:9216
    v_rcp_f32 v210, v210
    v_mfma_f32_16x16x32_bf16 v[40:43], v[148:151], v[168:171], v[40:43]
    ds_read_b128 v[204:207], v13 offset:22528
    v_rcp_f32 v211, v211
    v_mfma_f32_16x16x32_bf16 v[56:59], v[152:155], v[168:171], v[56:59]
    ds_read_b64_tr_b16 v[188:189], v11 offset:8192
    v_mul_f32 v104, v104, v208
    v_mfma_f32_16x16x32_bf16 v[72:75], v[156:159], v[168:171], v[72:75]
    ds_read_b64_tr_b16 v[190:191], v11 offset:9216
    v_mul_f32 v105, v105, v209
    v_mfma_f32_16x16x32_bf16 v[76:79], v[156:159], v[172:175], v[76:79]
    v_mul_f32 v106, v106, v210
    v_mul_f32 v107, v107, v211
    v_mfma_f32_16x16x32_bf16 v[60:63], v[152:155], v[172:175], v[60:63]
    v_mfma_f32_16x16x32_bf16 v[44:47], v[148:151], v[172:175], v[44:47]
    v_mfma_f32_16x16x32_bf16 v[28:31], v[144:147], v[172:175], v[28:31]
    s_waitcnt lgkmcnt(0)
    s_barrier
    v_mfma_f32_16x16x32_bf16 v[16:19], v[176:179], v[192:195], v[16:19]
    ds_read_b128 v[160:163], v12 offset:49152
    v_mul_f32 v208, v108, v108
    v_mfma_f32_16x16x32_bf16 v[32:35], v[180:183], v[192:195], v[32:35]
    ds_read_b64_tr_b16 v[144:145], v8 offset:32768
    v_mul_f32 v209, v109, v109
    v_mfma_f32_16x16x32_bf16 v[48:51], v[184:187], v[192:195], v[48:51]
    ds_read_b64_tr_b16 v[146:147], v8 offset:33792
    v_mul_f32 v210, v110, v110
    v_mfma_f32_16x16x32_bf16 v[64:67], v[188:191], v[192:195], v[64:67]
    ds_read_b128 v[164:167], v12 offset:51200
    v_mul_f32 v211, v111, v111
    v_mfma_f32_16x16x32_bf16 v[68:71], v[188:191], v[196:199], v[68:71]
    ds_read_b64_tr_b16 v[148:149], v9 offset:32768
    v_fma_f32 v208, v208, s42, v14
    v_mfma_f32_16x16x32_bf16 v[52:55], v[184:187], v[196:199], v[52:55]
    ds_read_b64_tr_b16 v[150:151], v9 offset:33792
    v_fma_f32 v209, v209, s42, v14
    v_mfma_f32_16x16x32_bf16 v[36:39], v[180:183], v[196:199], v[36:39]
    ds_read_b128 v[168:171], v12 offset:53248
    v_fma_f32 v210, v210, s42, v14
    v_mfma_f32_16x16x32_bf16 v[20:23], v[176:179], v[196:199], v[20:23]
    ds_read_b64_tr_b16 v[152:153], v10 offset:32768
    v_fma_f32 v211, v211, s42, v14
    v_mfma_f32_16x16x32_bf16 v[24:27], v[176:179], v[200:203], v[24:27]
    ds_read_b64_tr_b16 v[154:155], v10 offset:33792
    v_mul_f32 v208, v208, v108
    v_mfma_f32_16x16x32_bf16 v[40:43], v[180:183], v[200:203], v[40:43]
    ds_read_b128 v[172:175], v12 offset:55296
    v_mul_f32 v209, v209, v109
    v_mfma_f32_16x16x32_bf16 v[56:59], v[184:187], v[200:203], v[56:59]
    ds_read_b64_tr_b16 v[156:157], v11 offset:32768
    v_mul_f32 v210, v210, v110
    v_mfma_f32_16x16x32_bf16 v[72:75], v[188:191], v[200:203], v[72:75]
    ds_read_b64_tr_b16 v[158:159], v11 offset:33792
    v_mul_f32 v211, v211, v111
    v_mfma_f32_16x16x32_bf16 v[76:79], v[188:191], v[204:207], v[76:79]
    v_exp_f32 v208, v208
    v_mfma_f32_16x16x32_bf16 v[60:63], v[184:187], v[204:207], v[60:63]
    v_exp_f32 v209, v209
    v_mfma_f32_16x16x32_bf16 v[44:47], v[180:183], v[204:207], v[44:47]
    v_mfma_f32_16x16x32_bf16 v[28:31], v[176:179], v[204:207], v[28:31]
    s_waitcnt lgkmcnt(0)
    v_mfma_f32_16x16x32_bf16 v[16:19], v[144:147], v[160:163], v[16:19]
    ds_read_b128 v[192:195], v13 offset:49152
    v_exp_f32 v210, v210
    v_mfma_f32_16x16x32_bf16 v[32:35], v[148:151], v[160:163], v[32:35]
    ds_read_b64_tr_b16 v[176:177], v8 offset:40960
    v_exp_f32 v211, v211
    v_mfma_f32_16x16x32_bf16 v[48:51], v[152:155], v[160:163], v[48:51]
    ds_read_b64_tr_b16 v[178:179], v8 offset:41984
    v_add_f32 v208, 1.0, v208
    v_mfma_f32_16x16x32_bf16 v[64:67], v[156:159], v[160:163], v[64:67]
    ds_read_b128 v[196:199], v13 offset:51200
    v_add_f32 v209, 1.0, v209
    v_mfma_f32_16x16x32_bf16 v[68:71], v[156:159], v[164:167], v[68:71]
    ds_read_b64_tr_b16 v[180:181], v9 offset:40960
    v_add_f32 v210, 1.0, v210
    v_mfma_f32_16x16x32_bf16 v[52:55], v[152:155], v[164:167], v[52:55]
    ds_read_b64_tr_b16 v[182:183], v9 offset:41984
    v_add_f32 v211, 1.0, v211
    v_mfma_f32_16x16x32_bf16 v[36:39], v[148:151], v[164:167], v[36:39]
    ds_read_b128 v[200:203], v13 offset:53248
    v_rcp_f32 v208, v208
    v_mfma_f32_16x16x32_bf16 v[20:23], v[144:147], v[164:167], v[20:23]
    ds_read_b64_tr_b16 v[184:185], v10 offset:40960
    v_rcp_f32 v209, v209
    v_mfma_f32_16x16x32_bf16 v[24:27], v[144:147], v[168:171], v[24:27]
    ds_read_b64_tr_b16 v[186:187], v10 offset:41984
    v_rcp_f32 v210, v210
    v_mfma_f32_16x16x32_bf16 v[40:43], v[148:151], v[168:171], v[40:43]
    ds_read_b128 v[204:207], v13 offset:55296
    v_rcp_f32 v211, v211
    v_mfma_f32_16x16x32_bf16 v[56:59], v[152:155], v[168:171], v[56:59]
    ds_read_b64_tr_b16 v[188:189], v11 offset:40960
    v_mul_f32 v108, v108, v208
    v_mfma_f32_16x16x32_bf16 v[72:75], v[156:159], v[168:171], v[72:75]
    ds_read_b64_tr_b16 v[190:191], v11 offset:41984
    v_xor_b32 v8, s40, v8
    v_xor_b32 v9, s40, v9
    v_mfma_f32_16x16x32_bf16 v[76:79], v[156:159], v[172:175], v[76:79]
    v_xor_b32 v10, s40, v10
    v_xor_b32 v11, s40, v11
    v_mfma_f32_16x16x32_bf16 v[60:63], v[152:155], v[172:175], v[60:63]
    v_xor_b32 v12, s40, v12
    v_xor_b32 v13, s40, v13
    v_mfma_f32_16x16x32_bf16 v[44:47], v[148:151], v[172:175], v[44:47]
    v_mul_f32 v109, v109, v209
    v_mul_f32 v110, v110, v210
    v_mfma_f32_16x16x32_bf16 v[28:31], v[144:147], v[172:175], v[28:31]
    v_mul_f32 v111, v111, v211
    s_waitcnt lgkmcnt(0)
    s_barrier
    v_mfma_f32_16x16x32_bf16 v[16:19], v[176:179], v[192:195], v[16:19]
    ds_read_b128 v[160:163], v12 offset:16384
    v_mul_f32 v208, v112, v112
    v_mfma_f32_16x16x32_bf16 v[32:35], v[180:183], v[192:195], v[32:35]
    ds_read_b64_tr_b16 v[144:145], v8 offset:0
    v_mul_f32 v209, v113, v113
    v_mfma_f32_16x16x32_bf16 v[48:51], v[184:187], v[192:195], v[48:51]
    ds_read_b64_tr_b16 v[146:147], v8 offset:1024
    v_mul_f32 v210, v114, v114
    v_mfma_f32_16x16x32_bf16 v[64:67], v[188:191], v[192:195], v[64:67]
    ds_read_b128 v[164:167], v12 offset:18432
    v_mul_f32 v211, v115, v115
    v_mfma_f32_16x16x32_bf16 v[68:71], v[188:191], v[196:199], v[68:71]
    ds_read_b64_tr_b16 v[148:149], v9 offset:0
    v_fma_f32 v208, v208, s42, v14
    v_mfma_f32_16x16x32_bf16 v[52:55], v[184:187], v[196:199], v[52:55]
    ds_read_b64_tr_b16 v[150:151], v9 offset:1024
    v_fma_f32 v209, v209, s42, v14
    v_mfma_f32_16x16x32_bf16 v[36:39], v[180:183], v[196:199], v[36:39]
    ds_read_b128 v[168:171], v12 offset:20480
    v_fma_f32 v210, v210, s42, v14
    v_mfma_f32_16x16x32_bf16 v[20:23], v[176:179], v[196:199], v[20:23]
    ds_read_b64_tr_b16 v[152:153], v10 offset:0
    v_fma_f32 v211, v211, s42, v14
    v_mfma_f32_16x16x32_bf16 v[24:27], v[176:179], v[200:203], v[24:27]
    ds_read_b64_tr_b16 v[154:155], v10 offset:1024
    v_mul_f32 v208, v208, v112
    v_mfma_f32_16x16x32_bf16 v[40:43], v[180:183], v[200:203], v[40:43]
    ds_read_b128 v[172:175], v12 offset:22528
    v_mul_f32 v209, v209, v113
    v_mfma_f32_16x16x32_bf16 v[56:59], v[184:187], v[200:203], v[56:59]
    ds_read_b64_tr_b16 v[156:157], v11 offset:0
    v_mul_f32 v210, v210, v114
    v_mfma_f32_16x16x32_bf16 v[72:75], v[188:191], v[200:203], v[72:75]
    ds_read_b64_tr_b16 v[158:159], v11 offset:1024
    v_mul_f32 v211, v211, v115
    v_mfma_f32_16x16x32_bf16 v[76:79], v[188:191], v[204:207], v[76:79]
    v_exp_f32 v208, v208
    v_mfma_f32_16x16x32_bf16 v[60:63], v[184:187], v[204:207], v[60:63]
    v_exp_f32 v209, v209
    v_mfma_f32_16x16x32_bf16 v[44:47], v[180:183], v[204:207], v[44:47]
    v_mfma_f32_16x16x32_bf16 v[28:31], v[176:179], v[204:207], v[28:31]
    s_waitcnt lgkmcnt(0)
    v_mfma_f32_16x16x32_bf16 v[16:19], v[144:147], v[160:163], v[16:19]
    ds_read_b128 v[192:195], v13 offset:16384
    v_exp_f32 v210, v210
    v_mfma_f32_16x16x32_bf16 v[32:35], v[148:151], v[160:163], v[32:35]
    ds_read_b64_tr_b16 v[176:177], v8 offset:8192
    v_exp_f32 v211, v211
    v_mfma_f32_16x16x32_bf16 v[48:51], v[152:155], v[160:163], v[48:51]
    ds_read_b64_tr_b16 v[178:179], v8 offset:9216
    v_add_f32 v208, 1.0, v208
    v_mfma_f32_16x16x32_bf16 v[64:67], v[156:159], v[160:163], v[64:67]
    ds_read_b128 v[196:199], v13 offset:18432
    v_add_f32 v209, 1.0, v209
    v_mfma_f32_16x16x32_bf16 v[68:71], v[156:159], v[164:167], v[68:71]
    ds_read_b64_tr_b16 v[180:181], v9 offset:8192
    v_add_f32 v210, 1.0, v210
    v_mfma_f32_16x16x32_bf16 v[52:55], v[152:155], v[164:167], v[52:55]
    ds_read_b64_tr_b16 v[182:183], v9 offset:9216
    v_add_f32 v211, 1.0, v211
    v_mfma_f32_16x16x32_bf16 v[36:39], v[148:151], v[164:167], v[36:39]
    ds_read_b128 v[200:203], v13 offset:20480
    v_rcp_f32 v208, v208
    v_mfma_f32_16x16x32_bf16 v[20:23], v[144:147], v[164:167], v[20:23]
    ds_read_b64_tr_b16 v[184:185], v10 offset:8192
    v_rcp_f32 v209, v209
    v_mfma_f32_16x16x32_bf16 v[24:27], v[144:147], v[168:171], v[24:27]
    ds_read_b64_tr_b16 v[186:187], v10 offset:9216
    v_rcp_f32 v210, v210
    v_mfma_f32_16x16x32_bf16 v[40:43], v[148:151], v[168:171], v[40:43]
    ds_read_b128 v[204:207], v13 offset:22528
    v_rcp_f32 v211, v211
    v_mfma_f32_16x16x32_bf16 v[56:59], v[152:155], v[168:171], v[56:59]
    ds_read_b64_tr_b16 v[188:189], v11 offset:8192
    v_mul_f32 v112, v112, v208
    v_mfma_f32_16x16x32_bf16 v[72:75], v[156:159], v[168:171], v[72:75]
    ds_read_b64_tr_b16 v[190:191], v11 offset:9216
    v_mul_f32 v113, v113, v209
    v_mfma_f32_16x16x32_bf16 v[76:79], v[156:159], v[172:175], v[76:79]
    v_mul_f32 v114, v114, v210
    v_mul_f32 v115, v115, v211
    v_mfma_f32_16x16x32_bf16 v[60:63], v[152:155], v[172:175], v[60:63]
    v_mfma_f32_16x16x32_bf16 v[44:47], v[148:151], v[172:175], v[44:47]
    v_mfma_f32_16x16x32_bf16 v[28:31], v[144:147], v[172:175], v[28:31]
    s_waitcnt lgkmcnt(0)
    s_barrier
    v_mfma_f32_16x16x32_bf16 v[16:19], v[176:179], v[192:195], v[16:19]
    ds_read_b128 v[160:163], v12 offset:49152
    v_mul_f32 v208, v116, v116
    v_mfma_f32_16x16x32_bf16 v[32:35], v[180:183], v[192:195], v[32:35]
    ds_read_b64_tr_b16 v[144:145], v8 offset:32768
    v_mul_f32 v209, v117, v117
    v_mfma_f32_16x16x32_bf16 v[48:51], v[184:187], v[192:195], v[48:51]
    ds_read_b64_tr_b16 v[146:147], v8 offset:33792
    v_mul_f32 v210, v118, v118
    v_mfma_f32_16x16x32_bf16 v[64:67], v[188:191], v[192:195], v[64:67]
    ds_read_b128 v[164:167], v12 offset:51200
    v_mul_f32 v211, v119, v119
    v_mfma_f32_16x16x32_bf16 v[68:71], v[188:191], v[196:199], v[68:71]
    ds_read_b64_tr_b16 v[148:149], v9 offset:32768
    v_fma_f32 v208, v208, s42, v14
    v_mfma_f32_16x16x32_bf16 v[52:55], v[184:187], v[196:199], v[52:55]
    ds_read_b64_tr_b16 v[150:151], v9 offset:33792
    v_fma_f32 v209, v209, s42, v14
    v_mfma_f32_16x16x32_bf16 v[36:39], v[180:183], v[196:199], v[36:39]
    ds_read_b128 v[168:171], v12 offset:53248
    v_fma_f32 v210, v210, s42, v14
    v_mfma_f32_16x16x32_bf16 v[20:23], v[176:179], v[196:199], v[20:23]
    ds_read_b64_tr_b16 v[152:153], v10 offset:32768
    v_fma_f32 v211, v211, s42, v14
    v_mfma_f32_16x16x32_bf16 v[24:27], v[176:179], v[200:203], v[24:27]
    ds_read_b64_tr_b16 v[154:155], v10 offset:33792
    v_mul_f32 v208, v208, v116
    v_mfma_f32_16x16x32_bf16 v[40:43], v[180:183], v[200:203], v[40:43]
    ds_read_b128 v[172:175], v12 offset:55296
    v_mul_f32 v209, v209, v117
    v_mfma_f32_16x16x32_bf16 v[56:59], v[184:187], v[200:203], v[56:59]
    ds_read_b64_tr_b16 v[156:157], v11 offset:32768
    v_mul_f32 v210, v210, v118
    v_mfma_f32_16x16x32_bf16 v[72:75], v[188:191], v[200:203], v[72:75]
    ds_read_b64_tr_b16 v[158:159], v11 offset:33792
    v_mul_f32 v211, v211, v119
    v_mfma_f32_16x16x32_bf16 v[76:79], v[188:191], v[204:207], v[76:79]
    v_exp_f32 v208, v208
    v_mfma_f32_16x16x32_bf16 v[60:63], v[184:187], v[204:207], v[60:63]
    v_exp_f32 v209, v209
    v_mfma_f32_16x16x32_bf16 v[44:47], v[180:183], v[204:207], v[44:47]
    v_mfma_f32_16x16x32_bf16 v[28:31], v[176:179], v[204:207], v[28:31]
    s_waitcnt lgkmcnt(0)
    v_mfma_f32_16x16x32_bf16 v[16:19], v[144:147], v[160:163], v[16:19]
    ds_read_b128 v[192:195], v13 offset:49152
    v_exp_f32 v210, v210
    v_mfma_f32_16x16x32_bf16 v[32:35], v[148:151], v[160:163], v[32:35]
    ds_read_b64_tr_b16 v[176:177], v8 offset:40960
    v_exp_f32 v211, v211
    v_mfma_f32_16x16x32_bf16 v[48:51], v[152:155], v[160:163], v[48:51]
    ds_read_b64_tr_b16 v[178:179], v8 offset:41984
    v_add_f32 v208, 1.0, v208
    v_mfma_f32_16x16x32_bf16 v[64:67], v[156:159], v[160:163], v[64:67]
    ds_read_b128 v[196:199], v13 offset:51200
    v_add_f32 v209, 1.0, v209
    v_mfma_f32_16x16x32_bf16 v[68:71], v[156:159], v[164:167], v[68:71]
    ds_read_b64_tr_b16 v[180:181], v9 offset:40960
    v_add_f32 v210, 1.0, v210
    v_mfma_f32_16x16x32_bf16 v[52:55], v[152:155], v[164:167], v[52:55]
    ds_read_b64_tr_b16 v[182:183], v9 offset:41984
    v_add_f32 v211, 1.0, v211
    v_mfma_f32_16x16x32_bf16 v[36:39], v[148:151], v[164:167], v[36:39]
    ds_read_b128 v[200:203], v13 offset:53248
    v_rcp_f32 v208, v208
    v_mfma_f32_16x16x32_bf16 v[20:23], v[144:147], v[164:167], v[20:23]
    ds_read_b64_tr_b16 v[184:185], v10 offset:40960
    v_rcp_f32 v209, v209
    v_mfma_f32_16x16x32_bf16 v[24:27], v[144:147], v[168:171], v[24:27]
    ds_read_b64_tr_b16 v[186:187], v10 offset:41984
    v_rcp_f32 v210, v210
    v_mfma_f32_16x16x32_bf16 v[40:43], v[148:151], v[168:171], v[40:43]
    ds_read_b128 v[204:207], v13 offset:55296
    v_rcp_f32 v211, v211
    v_mfma_f32_16x16x32_bf16 v[56:59], v[152:155], v[168:171], v[56:59]
    ds_read_b64_tr_b16 v[188:189], v11 offset:40960
    v_mul_f32 v116, v116, v208
    v_mfma_f32_16x16x32_bf16 v[72:75], v[156:159], v[168:171], v[72:75]
    ds_read_b64_tr_b16 v[190:191], v11 offset:41984
    v_xor_b32 v8, s40, v8
    v_xor_b32 v9, s40, v9
    v_mfma_f32_16x16x32_bf16 v[76:79], v[156:159], v[172:175], v[76:79]
    v_xor_b32 v10, s40, v10
    v_xor_b32 v11, s40, v11
    v_mfma_f32_16x16x32_bf16 v[60:63], v[152:155], v[172:175], v[60:63]
    v_xor_b32 v12, s40, v12
    v_xor_b32 v13, s40, v13
    v_mfma_f32_16x16x32_bf16 v[44:47], v[148:151], v[172:175], v[44:47]
    v_mul_f32 v117, v117, v209
    v_mul_f32 v118, v118, v210
    v_mfma_f32_16x16x32_bf16 v[28:31], v[144:147], v[172:175], v[28:31]
    v_mul_f32 v119, v119, v211
    s_waitcnt lgkmcnt(0)
    s_barrier
    v_mfma_f32_16x16x32_bf16 v[16:19], v[176:179], v[192:195], v[16:19]
    ds_read_b128 v[160:163], v12 offset:16384
    v_mul_f32 v208, v120, v120
    v_mfma_f32_16x16x32_bf16 v[32:35], v[180:183], v[192:195], v[32:35]
    ds_read_b64_tr_b16 v[144:145], v8 offset:0
    v_mul_f32 v209, v121, v121
    v_mfma_f32_16x16x32_bf16 v[48:51], v[184:187], v[192:195], v[48:51]
    ds_read_b64_tr_b16 v[146:147], v8 offset:1024
    v_mul_f32 v210, v122, v122
    v_mfma_f32_16x16x32_bf16 v[64:67], v[188:191], v[192:195], v[64:67]
    ds_read_b128 v[164:167], v12 offset:18432
    v_mul_f32 v211, v123, v123
    v_mfma_f32_16x16x32_bf16 v[68:71], v[188:191], v[196:199], v[68:71]
    ds_read_b64_tr_b16 v[148:149], v9 offset:0
    v_fma_f32 v208, v208, s42, v14
    v_mfma_f32_16x16x32_bf16 v[52:55], v[184:187], v[196:199], v[52:55]
    ds_read_b64_tr_b16 v[150:151], v9 offset:1024
    v_fma_f32 v209, v209, s42, v14
    v_mfma_f32_16x16x32_bf16 v[36:39], v[180:183], v[196:199], v[36:39]
    ds_read_b128 v[168:171], v12 offset:20480
    v_fma_f32 v210, v210, s42, v14
    v_mfma_f32_16x16x32_bf16 v[20:23], v[176:179], v[196:199], v[20:23]
    ds_read_b64_tr_b16 v[152:153], v10 offset:0
    v_fma_f32 v211, v211, s42, v14
    v_mfma_f32_16x16x32_bf16 v[24:27], v[176:179], v[200:203], v[24:27]
    ds_read_b64_tr_b16 v[154:155], v10 offset:1024
    v_mul_f32 v208, v208, v120
    v_mfma_f32_16x16x32_bf16 v[40:43], v[180:183], v[200:203], v[40:43]
    ds_read_b128 v[172:175], v12 offset:22528
    v_mul_f32 v209, v209, v121
    v_mfma_f32_16x16x32_bf16 v[56:59], v[184:187], v[200:203], v[56:59]
    ds_read_b64_tr_b16 v[156:157], v11 offset:0
    v_mul_f32 v210, v210, v122
    v_mfma_f32_16x16x32_bf16 v[72:75], v[188:191], v[200:203], v[72:75]
    ds_read_b64_tr_b16 v[158:159], v11 offset:1024
    v_mul_f32 v211, v211, v123
    v_mfma_f32_16x16x32_bf16 v[76:79], v[188:191], v[204:207], v[76:79]
    v_exp_f32 v208, v208
    v_mfma_f32_16x16x32_bf16 v[60:63], v[184:187], v[204:207], v[60:63]
    v_exp_f32 v209, v209
    v_mfma_f32_16x16x32_bf16 v[44:47], v[180:183], v[204:207], v[44:47]
    v_mfma_f32_16x16x32_bf16 v[28:31], v[176:179], v[204:207], v[28:31]
    s_waitcnt lgkmcnt(0)
    v_mfma_f32_16x16x32_bf16 v[16:19], v[144:147], v[160:163], v[16:19]
    ds_read_b128 v[192:195], v13 offset:16384
    v_exp_f32 v210, v210
    v_mfma_f32_16x16x32_bf16 v[32:35], v[148:151], v[160:163], v[32:35]
    ds_read_b64_tr_b16 v[176:177], v8 offset:8192
    v_exp_f32 v211, v211
    v_mfma_f32_16x16x32_bf16 v[48:51], v[152:155], v[160:163], v[48:51]
    ds_read_b64_tr_b16 v[178:179], v8 offset:9216
    v_add_f32 v208, 1.0, v208
    v_mfma_f32_16x16x32_bf16 v[64:67], v[156:159], v[160:163], v[64:67]
    ds_read_b128 v[196:199], v13 offset:18432
    v_add_f32 v209, 1.0, v209
    v_mfma_f32_16x16x32_bf16 v[68:71], v[156:159], v[164:167], v[68:71]
    ds_read_b64_tr_b16 v[180:181], v9 offset:8192
    v_add_f32 v210, 1.0, v210
    v_mfma_f32_16x16x32_bf16 v[52:55], v[152:155], v[164:167], v[52:55]
    ds_read_b64_tr_b16 v[182:183], v9 offset:9216
    v_add_f32 v211, 1.0, v211
    v_mfma_f32_16x16x32_bf16 v[36:39], v[148:151], v[164:167], v[36:39]
    ds_read_b128 v[200:203], v13 offset:20480
    v_rcp_f32 v208, v208
    v_mfma_f32_16x16x32_bf16 v[20:23], v[144:147], v[164:167], v[20:23]
    ds_read_b64_tr_b16 v[184:185], v10 offset:8192
    v_rcp_f32 v209, v209
    v_mfma_f32_16x16x32_bf16 v[24:27], v[144:147], v[168:171], v[24:27]
    ds_read_b64_tr_b16 v[186:187], v10 offset:9216
    v_rcp_f32 v210, v210
    v_mfma_f32_16x16x32_bf16 v[40:43], v[148:151], v[168:171], v[40:43]
    ds_read_b128 v[204:207], v13 offset:22528
    v_rcp_f32 v211, v211
    v_mfma_f32_16x16x32_bf16 v[56:59], v[152:155], v[168:171], v[56:59]
    ds_read_b64_tr_b16 v[188:189], v11 offset:8192
    v_mul_f32 v120, v120, v208
    v_mfma_f32_16x16x32_bf16 v[72:75], v[156:159], v[168:171], v[72:75]
    ds_read_b64_tr_b16 v[190:191], v11 offset:9216
    v_mul_f32 v121, v121, v209
    v_mfma_f32_16x16x32_bf16 v[76:79], v[156:159], v[172:175], v[76:79]
    v_mul_f32 v122, v122, v210
    v_mul_f32 v123, v123, v211
    v_mfma_f32_16x16x32_bf16 v[60:63], v[152:155], v[172:175], v[60:63]
    v_mfma_f32_16x16x32_bf16 v[44:47], v[148:151], v[172:175], v[44:47]
    v_mfma_f32_16x16x32_bf16 v[28:31], v[144:147], v[172:175], v[28:31]
    s_waitcnt lgkmcnt(0)
    s_barrier
    v_mfma_f32_16x16x32_bf16 v[16:19], v[176:179], v[192:195], v[16:19]
    ds_read_b128 v[160:163], v12 offset:49152
    v_mul_f32 v208, v124, v124
    v_mfma_f32_16x16x32_bf16 v[32:35], v[180:183], v[192:195], v[32:35]
    ds_read_b64_tr_b16 v[144:145], v8 offset:32768
    v_mul_f32 v209, v125, v125
    v_mfma_f32_16x16x32_bf16 v[48:51], v[184:187], v[192:195], v[48:51]
    ds_read_b64_tr_b16 v[146:147], v8 offset:33792
    v_mul_f32 v210, v126, v126
    v_mfma_f32_16x16x32_bf16 v[64:67], v[188:191], v[192:195], v[64:67]
    ds_read_b128 v[164:167], v12 offset:51200
    v_mul_f32 v211, v127, v127
    v_mfma_f32_16x16x32_bf16 v[68:71], v[188:191], v[196:199], v[68:71]
    ds_read_b64_tr_b16 v[148:149], v9 offset:32768
    v_fma_f32 v208, v208, s42, v14
    v_mfma_f32_16x16x32_bf16 v[52:55], v[184:187], v[196:199], v[52:55]
    ds_read_b64_tr_b16 v[150:151], v9 offset:33792
    v_fma_f32 v209, v209, s42, v14
    v_mfma_f32_16x16x32_bf16 v[36:39], v[180:183], v[196:199], v[36:39]
    ds_read_b128 v[168:171], v12 offset:53248
    v_fma_f32 v210, v210, s42, v14
    v_mfma_f32_16x16x32_bf16 v[20:23], v[176:179], v[196:199], v[20:23]
    ds_read_b64_tr_b16 v[152:153], v10 offset:32768
    v_fma_f32 v211, v211, s42, v14
    v_mfma_f32_16x16x32_bf16 v[24:27], v[176:179], v[200:203], v[24:27]
    ds_read_b64_tr_b16 v[154:155], v10 offset:33792
    v_mul_f32 v208, v208, v124
    v_mfma_f32_16x16x32_bf16 v[40:43], v[180:183], v[200:203], v[40:43]
    ds_read_b128 v[172:175], v12 offset:55296
    v_mul_f32 v209, v209, v125
    v_mfma_f32_16x16x32_bf16 v[56:59], v[184:187], v[200:203], v[56:59]
    ds_read_b64_tr_b16 v[156:157], v11 offset:32768
    v_mul_f32 v210, v210, v126
    v_mfma_f32_16x16x32_bf16 v[72:75], v[188:191], v[200:203], v[72:75]
    ds_read_b64_tr_b16 v[158:159], v11 offset:33792
    v_mul_f32 v211, v211, v127
    v_mfma_f32_16x16x32_bf16 v[76:79], v[188:191], v[204:207], v[76:79]
    v_exp_f32 v208, v208
    v_mfma_f32_16x16x32_bf16 v[60:63], v[184:187], v[204:207], v[60:63]
    v_exp_f32 v209, v209
    v_mfma_f32_16x16x32_bf16 v[44:47], v[180:183], v[204:207], v[44:47]
    v_mfma_f32_16x16x32_bf16 v[28:31], v[176:179], v[204:207], v[28:31]
    s_waitcnt lgkmcnt(0)
    v_mfma_f32_16x16x32_bf16 v[16:19], v[144:147], v[160:163], v[16:19]
    ds_read_b128 v[192:195], v13 offset:49152
    v_exp_f32 v210, v210
    v_mfma_f32_16x16x32_bf16 v[32:35], v[148:151], v[160:163], v[32:35]
    ds_read_b64_tr_b16 v[176:177], v8 offset:40960
    v_exp_f32 v211, v211
    v_mfma_f32_16x16x32_bf16 v[48:51], v[152:155], v[160:163], v[48:51]
    ds_read_b64_tr_b16 v[178:179], v8 offset:41984
    v_add_f32 v208, 1.0, v208
    v_mfma_f32_16x16x32_bf16 v[64:67], v[156:159], v[160:163], v[64:67]
    ds_read_b128 v[196:199], v13 offset:51200
    v_add_f32 v209, 1.0, v209
    v_mfma_f32_16x16x32_bf16 v[68:71], v[156:159], v[164:167], v[68:71]
    ds_read_b64_tr_b16 v[180:181], v9 offset:40960
    v_add_f32 v210, 1.0, v210
    v_mfma_f32_16x16x32_bf16 v[52:55], v[152:155], v[164:167], v[52:55]
    ds_read_b64_tr_b16 v[182:183], v9 offset:41984
    v_add_f32 v211, 1.0, v211
    v_mfma_f32_16x16x32_bf16 v[36:39], v[148:151], v[164:167], v[36:39]
    ds_read_b128 v[200:203], v13 offset:53248
    v_rcp_f32 v208, v208
    v_mfma_f32_16x16x32_bf16 v[20:23], v[144:147], v[164:167], v[20:23]
    ds_read_b64_tr_b16 v[184:185], v10 offset:40960
    v_rcp_f32 v209, v209
    v_mfma_f32_16x16x32_bf16 v[24:27], v[144:147], v[168:171], v[24:27]
    ds_read_b64_tr_b16 v[186:187], v10 offset:41984
    v_rcp_f32 v210, v210
    v_mfma_f32_16x16x32_bf16 v[40:43], v[148:151], v[168:171], v[40:43]
    ds_read_b128 v[204:207], v13 offset:55296
    v_rcp_f32 v211, v211
    v_mfma_f32_16x16x32_bf16 v[56:59], v[152:155], v[168:171], v[56:59]
    ds_read_b64_tr_b16 v[188:189], v11 offset:40960
    v_mul_f32 v124, v124, v208
    v_mfma_f32_16x16x32_bf16 v[72:75], v[156:159], v[168:171], v[72:75]
    ds_read_b64_tr_b16 v[190:191], v11 offset:41984
    v_xor_b32 v8, s40, v8
    v_xor_b32 v9, s40, v9
    v_mfma_f32_16x16x32_bf16 v[76:79], v[156:159], v[172:175], v[76:79]
    v_xor_b32 v10, s40, v10
    v_xor_b32 v11, s40, v11
    v_mfma_f32_16x16x32_bf16 v[60:63], v[152:155], v[172:175], v[60:63]
    v_xor_b32 v12, s40, v12
    v_xor_b32 v13, s40, v13
    v_mfma_f32_16x16x32_bf16 v[44:47], v[148:151], v[172:175], v[44:47]
    v_mul_f32 v125, v125, v209
    v_mul_f32 v126, v126, v210
    v_mfma_f32_16x16x32_bf16 v[28:31], v[144:147], v[172:175], v[28:31]
    v_mul_f32 v127, v127, v211
    s_waitcnt lgkmcnt(0)
    s_barrier
    v_mfma_f32_16x16x32_bf16 v[16:19], v[176:179], v[192:195], v[16:19]
    ds_read_b128 v[160:163], v12 offset:16384
    v_mul_f32 v208, v128, v128
    v_mfma_f32_16x16x32_bf16 v[32:35], v[180:183], v[192:195], v[32:35]
    ds_read_b64_tr_b16 v[144:145], v8 offset:0
    v_mul_f32 v209, v129, v129
    v_mfma_f32_16x16x32_bf16 v[48:51], v[184:187], v[192:195], v[48:51]
    ds_read_b64_tr_b16 v[146:147], v8 offset:1024
    v_mul_f32 v210, v130, v130
    v_mfma_f32_16x16x32_bf16 v[64:67], v[188:191], v[192:195], v[64:67]
    ds_read_b128 v[164:167], v12 offset:18432
    v_mul_f32 v211, v131, v131
    v_mfma_f32_16x16x32_bf16 v[68:71], v[188:191], v[196:199], v[68:71]
    ds_read_b64_tr_b16 v[148:149], v9 offset:0
    v_fma_f32 v208, v208, s42, v14
    v_mfma_f32_16x16x32_bf16 v[52:55], v[184:187], v[196:199], v[52:55]
    ds_read_b64_tr_b16 v[150:151], v9 offset:1024
    v_fma_f32 v209, v209, s42, v14
    v_mfma_f32_16x16x32_bf16 v[36:39], v[180:183], v[196:199], v[36:39]
    ds_read_b128 v[168:171], v12 offset:20480
    v_fma_f32 v210, v210, s42, v14
    v_mfma_f32_16x16x32_bf16 v[20:23], v[176:179], v[196:199], v[20:23]
    ds_read_b64_tr_b16 v[152:153], v10 offset:0
    v_fma_f32 v211, v211, s42, v14
    v_mfma_f32_16x16x32_bf16 v[24:27], v[176:179], v[200:203], v[24:27]
    ds_read_b64_tr_b16 v[154:155], v10 offset:1024
    v_mul_f32 v208, v208, v128
    v_mfma_f32_16x16x32_bf16 v[40:43], v[180:183], v[200:203], v[40:43]
    ds_read_b128 v[172:175], v12 offset:22528
    v_mul_f32 v209, v209, v129
    v_mfma_f32_16x16x32_bf16 v[56:59], v[184:187], v[200:203], v[56:59]
    ds_read_b64_tr_b16 v[156:157], v11 offset:0
    v_mul_f32 v210, v210, v130
    v_mfma_f32_16x16x32_bf16 v[72:75], v[188:191], v[200:203], v[72:75]
    ds_read_b64_tr_b16 v[158:159], v11 offset:1024
    v_mul_f32 v211, v211, v131
    v_mfma_f32_16x16x32_bf16 v[76:79], v[188:191], v[204:207], v[76:79]
    v_exp_f32 v208, v208
    v_mfma_f32_16x16x32_bf16 v[60:63], v[184:187], v[204:207], v[60:63]
    v_exp_f32 v209, v209
    v_mfma_f32_16x16x32_bf16 v[44:47], v[180:183], v[204:207], v[44:47]
    v_mfma_f32_16x16x32_bf16 v[28:31], v[176:179], v[204:207], v[28:31]
    s_waitcnt lgkmcnt(0)
    v_mfma_f32_16x16x32_bf16 v[16:19], v[144:147], v[160:163], v[16:19]
    ds_read_b128 v[192:195], v13 offset:16384
    v_exp_f32 v210, v210
    v_mfma_f32_16x16x32_bf16 v[32:35], v[148:151], v[160:163], v[32:35]
    ds_read_b64_tr_b16 v[176:177], v8 offset:8192
    v_exp_f32 v211, v211
    v_mfma_f32_16x16x32_bf16 v[48:51], v[152:155], v[160:163], v[48:51]
    ds_read_b64_tr_b16 v[178:179], v8 offset:9216
    v_add_f32 v208, 1.0, v208
    v_mfma_f32_16x16x32_bf16 v[64:67], v[156:159], v[160:163], v[64:67]
    ds_read_b128 v[196:199], v13 offset:18432
    v_add_f32 v209, 1.0, v209
    v_mfma_f32_16x16x32_bf16 v[68:71], v[156:159], v[164:167], v[68:71]
    ds_read_b64_tr_b16 v[180:181], v9 offset:8192
    v_add_f32 v210, 1.0, v210
    v_mfma_f32_16x16x32_bf16 v[52:55], v[152:155], v[164:167], v[52:55]
    ds_read_b64_tr_b16 v[182:183], v9 offset:9216
    v_add_f32 v211, 1.0, v211
    v_mfma_f32_16x16x32_bf16 v[36:39], v[148:151], v[164:167], v[36:39]
    ds_read_b128 v[200:203], v13 offset:20480
    v_rcp_f32 v208, v208
    v_mfma_f32_16x16x32_bf16 v[20:23], v[144:147], v[164:167], v[20:23]
    ds_read_b64_tr_b16 v[184:185], v10 offset:8192
    v_rcp_f32 v209, v209
    v_mfma_f32_16x16x32_bf16 v[24:27], v[144:147], v[168:171], v[24:27]
    ds_read_b64_tr_b16 v[186:187], v10 offset:9216
    v_rcp_f32 v210, v210
    v_mfma_f32_16x16x32_bf16 v[40:43], v[148:151], v[168:171], v[40:43]
    ds_read_b128 v[204:207], v13 offset:22528
    v_rcp_f32 v211, v211
    v_mfma_f32_16x16x32_bf16 v[56:59], v[152:155], v[168:171], v[56:59]
    ds_read_b64_tr_b16 v[188:189], v11 offset:8192
    v_mul_f32 v128, v128, v208
    v_mfma_f32_16x16x32_bf16 v[72:75], v[156:159], v[168:171], v[72:75]
    ds_read_b64_tr_b16 v[190:191], v11 offset:9216
    v_mul_f32 v129, v129, v209
    v_mfma_f32_16x16x32_bf16 v[76:79], v[156:159], v[172:175], v[76:79]
    v_mul_f32 v130, v130, v210
    v_mul_f32 v131, v131, v211
    v_mfma_f32_16x16x32_bf16 v[60:63], v[152:155], v[172:175], v[60:63]
    v_mfma_f32_16x16x32_bf16 v[44:47], v[148:151], v[172:175], v[44:47]
    v_mfma_f32_16x16x32_bf16 v[28:31], v[144:147], v[172:175], v[28:31]
    s_waitcnt lgkmcnt(0)
    s_barrier
    v_mfma_f32_16x16x32_bf16 v[16:19], v[176:179], v[192:195], v[16:19]
    ds_read_b128 v[160:163], v12 offset:49152
    v_mul_f32 v208, v132, v132
    v_mfma_f32_16x16x32_bf16 v[32:35], v[180:183], v[192:195], v[32:35]
    ds_read_b64_tr_b16 v[144:145], v8 offset:32768
    v_mul_f32 v209, v133, v133
    v_mfma_f32_16x16x32_bf16 v[48:51], v[184:187], v[192:195], v[48:51]
    ds_read_b64_tr_b16 v[146:147], v8 offset:33792
    v_mul_f32 v210, v134, v134
    v_mfma_f32_16x16x32_bf16 v[64:67], v[188:191], v[192:195], v[64:67]
    ds_read_b128 v[164:167], v12 offset:51200
    v_mul_f32 v211, v135, v135
    v_mfma_f32_16x16x32_bf16 v[68:71], v[188:191], v[196:199], v[68:71]
    ds_read_b64_tr_b16 v[148:149], v9 offset:32768
    v_fma_f32 v208, v208, s42, v14
    v_mfma_f32_16x16x32_bf16 v[52:55], v[184:187], v[196:199], v[52:55]
    ds_read_b64_tr_b16 v[150:151], v9 offset:33792
    v_fma_f32 v209, v209, s42, v14
    v_mfma_f32_16x16x32_bf16 v[36:39], v[180:183], v[196:199], v[36:39]
    ds_read_b128 v[168:171], v12 offset:53248
    v_fma_f32 v210, v210, s42, v14
    v_mfma_f32_16x16x32_bf16 v[20:23], v[176:179], v[196:199], v[20:23]
    ds_read_b64_tr_b16 v[152:153], v10 offset:32768
    v_fma_f32 v211, v211, s42, v14
    v_mfma_f32_16x16x32_bf16 v[24:27], v[176:179], v[200:203], v[24:27]
    ds_read_b64_tr_b16 v[154:155], v10 offset:33792
L_pad_7:
    s_cmp_eq_u32 s99, 1
    s_cbranch_scc1 L_padret_7
    v_mul_f32 v208, v208, v132
    v_mfma_f32_16x16x32_bf16 v[40:43], v[180:183], v[200:203], v[40:43]
    ds_read_b128 v[172:175], v12 offset:55296
    v_mul_f32 v209, v209, v133
    v_mfma_f32_16x16x32_bf16 v[56:59], v[184:187], v[200:203], v[56:59]
    ds_read_b64_tr_b16 v[156:157], v11 offset:32768
    v_mul_f32 v210, v210, v134
    v_mfma_f32_16x16x32_bf16 v[72:75], v[188:191], v[200:203], v[72:75]
    ds_read_b64_tr_b16 v[158:159], v11 offset:33792
    v_mul_f32 v211, v211, v135
    v_mfma_f32_16x16x32_bf16 v[76:79], v[188:191], v[204:207], v[76:79]
    v_exp_f32 v208, v208
    v_mfma_f32_16x16x32_bf16 v[60:63], v[184:187], v[204:207], v[60:63]
    v_exp_f32 v209, v209
    v_mfma_f32_16x16x32_bf16 v[44:47], v[180:183], v[204:207], v[44:47]
    v_mfma_f32_16x16x32_bf16 v[28:31], v[176:179], v[204:207], v[28:31]
    s_waitcnt lgkmcnt(0)
    v_mfma_f32_16x16x32_bf16 v[16:19], v[144:147], v[160:163], v[16:19]
    ds_read_b128 v[192:195], v13 offset:49152
    v_exp_f32 v210, v210
    v_mfma_f32_16x16x32_bf16 v[32:35], v[148:151], v[160:163], v[32:35]
    ds_read_b64_tr_b16 v[176:177], v8 offset:40960
    v_exp_f32 v211, v211
    v_mfma_f32_16x16x32_bf16 v[48:51], v[152:155], v[160:163], v[48:51]
    ds_read_b64_tr_b16 v[178:179], v8 offset:41984
    v_add_f32 v208, 1.0, v208
    v_mfma_f32_16x16x32_bf16 v[64:67], v[156:159], v[160:163], v[64:67]
    ds_read_b128 v[196:199], v13 offset:51200
    v_add_f32 v209, 1.0, v209
    v_mfma_f32_16x16x32_bf16 v[68:71], v[156:159], v[164:167], v[68:71]
    ds_read_b64_tr_b16 v[180:181], v9 offset:40960
    v_add_f32 v210, 1.0, v210
    v_mfma_f32_16x16x32_bf16 v[52:55], v[152:155], v[164:167], v[52:55]
    ds_read_b64_tr_b16 v[182:183], v9 offset:41984
    v_add_f32 v211, 1.0, v211
    v_mfma_f32_16x16x32_bf16 v[36:39], v[148:151], v[164:167], v[36:39]
    ds_read_b128 v[200:203], v13 offset:53248
    v_rcp_f32 v208, v208
    v_mfma_f32_16x16x32_bf16 v[20:23], v[144:147], v[164:167], v[20:23]
    ds_read_b64_tr_b16 v[184:185], v10 offset:40960
    v_rcp_f32 v209, v209
    v_mfma_f32_16x16x32_bf16 v[24:27], v[144:147], v[168:171], v[24:27]
    ds_read_b64_tr_b16 v[186:187], v10 offset:41984
    v_rcp_f32 v210, v210
    v_mfma_f32_16x16x32_bf16 v[40:43], v[148:151], v[168:171], v[40:43]
    ds_read_b128 v[204:207], v13 offset:55296
    v_rcp_f32 v211, v211
    v_mfma_f32_16x16x32_bf16 v[56:59], v[152:155], v[168:171], v[56:59]
    ds_read_b64_tr_b16 v[188:189], v11 offset:40960
    v_mul_f32 v132, v132, v208
    v_mfma_f32_16x16x32_bf16 v[72:75], v[156:159], v[168:171], v[72:75]
    ds_read_b64_tr_b16 v[190:191], v11 offset:41984
    v_xor_b32 v8, s40, v8
    v_xor_b32 v9, s40, v9
    v_mfma_f32_16x16x32_bf16 v[76:79], v[156:159], v[172:175], v[76:79]
    v_xor_b32 v10, s40, v10
    v_xor_b32 v11, s40, v11
    v_mfma_f32_16x16x32_bf16 v[60:63], v[152:155], v[172:175], v[60:63]
    v_xor_b32 v12, s40, v12
    v_xor_b32 v13, s40, v13
    v_mfma_f32_16x16x32_bf16 v[44:47], v[148:151], v[172:175], v[44:47]
    v_mul_f32 v133, v133, v209
    v_mul_f32 v134, v134, v210
    v_mfma_f32_16x16x32_bf16 v[28:31], v[144:147], v[172:175], v[28:31]
    v_mul_f32 v135, v135, v211
    s_waitcnt lgkmcnt(0)
    s_barrier
    v_mfma_f32_16x16x32_bf16 v[16:19], v[176:179], v[192:195], v[16:19]
    ds_read_b128 v[160:163], v12 offset:16384
    v_mul_f32 v208, v136, v136
    v_mfma_f32_16x16x32_bf16 v[32:35], v[180:183], v[192:195], v[32:35]
    ds_read_b64_tr_b16 v[144:145], v8 offset:0
    v_mul_f32 v209, v137, v137
    v_mfma_f32_16x16x32_bf16 v[48:51], v[184:187], v[192:195], v[48:51]
    ds_read_b64_tr_b16 v[146:147], v8 offset:1024
    v_mul_f32 v210, v138, v138
    v_mfma_f32_16x16x32_bf16 v[64:67], v[188:191], v[192:195], v[64:67]
    ds_read_b128 v[164:167], v12 offset:18432
    v_mul_f32 v211, v139, v139
    v_mfma_f32_16x16x32_bf16 v[68:71], v[188:191], v[196:199], v[68:71]
    ds_read_b64_tr_b16 v[148:149], v9 offset:0
    v_fma_f32 v208, v208, s42, v14
    v_mfma_f32_16x16x32_bf16 v[52:55], v[184:187], v[196:199], v[52:55]
    ds_read_b64_tr_b16 v[150:151], v9 offset:1024
    v_fma_f32 v209, v209, s42, v14
    v_mfma_f32_16x16x32_bf16 v[36:39], v[180:183], v[196:199], v[36:39]
    ds_read_b128 v[168:171], v12 offset:20480
    v_fma_f32 v210, v210, s42, v14
    v_mfma_f32_16x16x32_bf16 v[20:23], v[176:179], v[196:199], v[20:23]
    ds_read_b64_tr_b16 v[152:153], v10 offset:0
    v_fma_f32 v211, v211, s42, v14
    v_mfma_f32_16x16x32_bf16 v[24:27], v[176:179], v[200:203], v[24:27]
    ds_read_b64_tr_b16 v[154:155], v10 offset:1024
    v_mul_f32 v208, v208, v136
    v_mfma_f32_16x16x32_bf16 v[40:43], v[180:183], v[200:203], v[40:43]
    ds_read_b128 v[172:175], v12 offset:22528
    v_mul_f32 v209, v209, v137
    v_mfma_f32_16x16x32_bf16 v[56:59], v[184:187], v[200:203], v[56:59]
    ds_read_b64_tr_b16 v[156:157], v11 offset:0
    v_mul_f32 v210, v210, v138
    v_mfma_f32_16x16x32_bf16 v[72:75], v[188:191], v[200:203], v[72:75]
    ds_read_b64_tr_b16 v[158:159], v11 offset:1024
    v_mul_f32 v211, v211, v139
    v_mfma_f32_16x16x32_bf16 v[76:79], v[188:191], v[204:207], v[76:79]
    v_exp_f32 v208, v208
    v_mfma_f32_16x16x32_bf16 v[60:63], v[184:187], v[204:207], v[60:63]
    v_exp_f32 v209, v209
    v_mfma_f32_16x16x32_bf16 v[44:47], v[180:183], v[204:207], v[44:47]
    v_mfma_f32_16x16x32_bf16 v[28:31], v[176:179], v[204:207], v[28:31]
    s_waitcnt lgkmcnt(0)
    v_mfma_f32_16x16x32_bf16 v[16:19], v[144:147], v[160:163], v[16:19]
    ds_read_b128 v[192:195], v13 offset:16384
    v_exp_f32 v210, v210
    v_mfma_f32_16x16x32_bf16 v[32:35], v[148:151], v[160:163], v[32:35]
    ds_read_b64_tr_b16 v[176:177], v8 offset:8192
    v_exp_f32 v211, v211
    v_mfma_f32_16x16x32_bf16 v[48:51], v[152:155], v[160:163], v[48:51]
    ds_read_b64_tr_b16 v[178:179], v8 offset:9216
    v_add_f32 v208, 1.0, v208
    v_mfma_f32_16x16x32_bf16 v[64:67], v[156:159], v[160:163], v[64:67]
    ds_read_b128 v[196:199], v13 offset:18432
    v_add_f32 v209, 1.0, v209
    v_mfma_f32_16x16x32_bf16 v[68:71], v[156:159], v[164:167], v[68:71]
    ds_read_b64_tr_b16 v[180:181], v9 offset:8192
    v_add_f32 v210, 1.0, v210
    v_mfma_f32_16x16x32_bf16 v[52:55], v[152:155], v[164:167], v[52:55]
    ds_read_b64_tr_b16 v[182:183], v9 offset:9216
    v_add_f32 v211, 1.0, v211
    v_mfma_f32_16x16x32_bf16 v[36:39], v[148:151], v[164:167], v[36:39]
    ds_read_b128 v[200:203], v13 offset:20480
    v_rcp_f32 v208, v208
    v_mfma_f32_16x16x32_bf16 v[20:23], v[144:147], v[164:167], v[20:23]
    ds_read_b64_tr_b16 v[184:185], v10 offset:8192
    v_rcp_f32 v209, v209
    v_mfma_f32_16x16x32_bf16 v[24:27], v[144:147], v[168:171], v[24:27]
    ds_read_b64_tr_b16 v[186:187], v10 offset:9216
    v_rcp_f32 v210, v210
    v_mfma_f32_16x16x32_bf16 v[40:43], v[148:151], v[168:171], v[40:43]
    ds_read_b128 v[204:207], v13 offset:22528
    v_rcp_f32 v211, v211
    v_mfma_f32_16x16x32_bf16 v[56:59], v[152:155], v[168:171], v[56:59]
    ds_read_b64_tr_b16 v[188:189], v11 offset:8192
    v_mul_f32 v136, v136, v208
    v_mfma_f32_16x16x32_bf16 v[72:75], v[156:159], v[168:171], v[72:75]
    ds_read_b64_tr_b16 v[190:191], v11 offset:9216
    v_mul_f32 v137, v137, v209
    v_mfma_f32_16x16x32_bf16 v[76:79], v[156:159], v[172:175], v[76:79]
    v_mul_f32 v138, v138, v210
    v_mul_f32 v139, v139, v211
    v_mfma_f32_16x16x32_bf16 v[60:63], v[152:155], v[172:175], v[60:63]
    v_mfma_f32_16x16x32_bf16 v[44:47], v[148:151], v[172:175], v[44:47]
    v_mfma_f32_16x16x32_bf16 v[28:31], v[144:147], v[172:175], v[28:31]
    s_waitcnt lgkmcnt(0)
    s_barrier
    v_mfma_f32_16x16x32_bf16 v[16:19], v[176:179], v[192:195], v[16:19]
    ds_read_b128 v[160:163], v12 offset:49152
    v_mul_f32 v208, v140, v140
    v_mfma_f32_16x16x32_bf16 v[32:35], v[180:183], v[192:195], v[32:35]
    ds_read_b64_tr_b16 v[144:145], v8 offset:32768
    v_mul_f32 v209, v141, v141
    v_mfma_f32_16x16x32_bf16 v[48:51], v[184:187], v[192:195], v[48:51]
    ds_read_b64_tr_b16 v[146:147], v8 offset:33792
    v_mul_f32 v210, v142, v142
    v_mfma_f32_16x16x32_bf16 v[64:67], v[188:191], v[192:195], v[64:67]
    ds_read_b128 v[164:167], v12 offset:51200
    v_mul_f32 v211, v143, v143
    v_mfma_f32_16x16x32_bf16 v[68:71], v[188:191], v[196:199], v[68:71]
    ds_read_b64_tr_b16 v[148:149], v9 offset:32768
    v_fma_f32 v208, v208, s42, v14
    v_mfma_f32_16x16x32_bf16 v[52:55], v[184:187], v[196:199], v[52:55]
    ds_read_b64_tr_b16 v[150:151], v9 offset:33792
    v_fma_f32 v209, v209, s42, v14
    v_mfma_f32_16x16x32_bf16 v[36:39], v[180:183], v[196:199], v[36:39]
    ds_read_b128 v[168:171], v12 offset:53248
    v_fma_f32 v210, v210, s42, v14
    v_mfma_f32_16x16x32_bf16 v[20:23], v[176:179], v[196:199], v[20:23]
    ds_read_b64_tr_b16 v[152:153], v10 offset:32768
    v_fma_f32 v211, v211, s42, v14
    v_mfma_f32_16x16x32_bf16 v[24:27], v[176:179], v[200:203], v[24:27]
    ds_read_b64_tr_b16 v[154:155], v10 offset:33792
    v_mul_f32 v208, v208, v140
    v_mfma_f32_16x16x32_bf16 v[40:43], v[180:183], v[200:203], v[40:43]
    ds_read_b128 v[172:175], v12 offset:55296
    v_mul_f32 v209, v209, v141
    v_mfma_f32_16x16x32_bf16 v[56:59], v[184:187], v[200:203], v[56:59]
    ds_read_b64_tr_b16 v[156:157], v11 offset:32768
    v_mul_f32 v210, v210, v142
    v_mfma_f32_16x16x32_bf16 v[72:75], v[188:191], v[200:203], v[72:75]
    ds_read_b64_tr_b16 v[158:159], v11 offset:33792
    v_mul_f32 v211, v211, v143
    v_mfma_f32_16x16x32_bf16 v[76:79], v[188:191], v[204:207], v[76:79]
    v_exp_f32 v208, v208
    v_mfma_f32_16x16x32_bf16 v[60:63], v[184:187], v[204:207], v[60:63]
    v_exp_f32 v209, v209
    v_mfma_f32_16x16x32_bf16 v[44:47], v[180:183], v[204:207], v[44:47]
    v_mfma_f32_16x16x32_bf16 v[28:31], v[176:179], v[204:207], v[28:31]
    s_waitcnt lgkmcnt(0)
    v_mfma_f32_16x16x32_bf16 v[16:19], v[144:147], v[160:163], v[16:19]
    ds_read_b128 v[192:195], v13 offset:49152
    v_exp_f32 v210, v210
    v_mfma_f32_16x16x32_bf16 v[32:35], v[148:151], v[160:163], v[32:35]
    ds_read_b64_tr_b16 v[176:177], v8 offset:40960
    v_exp_f32 v211, v211
    v_mfma_f32_16x16x32_bf16 v[48:51], v[152:155], v[160:163], v[48:51]
    ds_read_b64_tr_b16 v[178:179], v8 offset:41984
    v_add_f32 v208, 1.0, v208
    v_mfma_f32_16x16x32_bf16 v[64:67], v[156:159], v[160:163], v[64:67]
    ds_read_b128 v[196:199], v13 offset:51200
    v_add_f32 v209, 1.0, v209
    v_mfma_f32_16x16x32_bf16 v[68:71], v[156:159], v[164:167], v[68:71]
    ds_read_b64_tr_b16 v[180:181], v9 offset:40960
    v_add_f32 v210, 1.0, v210
    v_mfma_f32_16x16x32_bf16 v[52:55], v[152:155], v[164:167], v[52:55]
    ds_read_b64_tr_b16 v[182:183], v9 offset:41984
    v_add_f32 v211, 1.0, v211
    v_mfma_f32_16x16x32_bf16 v[36:39], v[148:151], v[164:167], v[36:39]
    ds_read_b128 v[200:203], v13 offset:53248
    v_rcp_f32 v208, v208
    v_mfma_f32_16x16x32_bf16 v[20:23], v[144:147], v[164:167], v[20:23]
    ds_read_b64_tr_b16 v[184:185], v10 offset:40960
    v_rcp_f32 v209, v209
    v_mfma_f32_16x16x32_bf16 v[24:27], v[144:147], v[168:171], v[24:27]
    ds_read_b64_tr_b16 v[186:187], v10 offset:41984
    v_rcp_f32 v210, v210
    v_mfma_f32_16x16x32_bf16 v[40:43], v[148:151], v[168:171], v[40:43]
    ds_read_b128 v[204:207], v13 offset:55296
    v_rcp_f32 v211, v211
    v_mfma_f32_16x16x32_bf16 v[56:59], v[152:155], v[168:171], v[56:59]
    ds_read_b64_tr_b16 v[188:189], v11 offset:40960
    v_mul_f32 v140, v140, v208
    v_mfma_f32_16x16x32_bf16 v[72:75], v[156:159], v[168:171], v[72:75]
    ds_read_b64_tr_b16 v[190:191], v11 offset:41984
    v_xor_b32 v8, s40, v8
    v_xor_b32 v9, s40, v9
    v_mfma_f32_16x16x32_bf16 v[76:79], v[156:159], v[172:175], v[76:79]
    v_xor_b32 v10, s40, v10
    v_xor_b32 v11, s40, v11
    v_mfma_f32_16x16x32_bf16 v[60:63], v[152:155], v[172:175], v[60:63]
    v_xor_b32 v12, s40, v12
    v_xor_b32 v13, s40, v13
    v_mfma_f32_16x16x32_bf16 v[44:47], v[148:151], v[172:175], v[44:47]
    v_mul_f32 v141, v141, v209
    v_mul_f32 v142, v142, v210
    v_mfma_f32_16x16x32_bf16 v[28:31], v[144:147], v[172:175], v[28:31]
    v_mul_f32 v143, v143, v211
    s_waitcnt lgkmcnt(0)
    s_mov_b32 s39, 5
L_g2loop:
    s_barrier
    v_mfma_f32_16x16x32_bf16 v[16:19], v[176:179], v[192:195], v[16:19]
    ds_read_b128 v[160:163], v12 offset:16384
    ds_read_b64_tr_b16 v[144:145], v8 offset:0
    v_mfma_f32_16x16x32_bf16 v[32:35], v[180:183], v[192:195], v[32:35]
    ds_read_b64_tr_b16 v[146:147], v8 offset:1024
    ds_read_b128 v[164:167], v12 offset:18432
    v_mfma_f32_16x16x32_bf16 v[48:51], v[184:187], v[192:195], v[48:51]
    ds_read_b64_tr_b16 v[148:149], v9 offset:0
    ds_read_b64_tr_b16 v[150:151], v9 offset:1024
    v_mfma_f32_16x16x32_bf16 v[64:67], v[188:191], v[192:195], v[64:67]
    ds_read_b128 v[168:171], v12 offset:20480
    ds_read_b64_tr_b16 v[152:153], v10 offset:0
    v_mfma_f32_16x16x32_bf16 v[68:71], v[188:191], v[196:199], v[68:71]
    ds_read_b64_tr_b16 v[154:155], v10 offset:1024
    ds_read_b128 v[172:175], v12 offset:22528
    v_mfma_f32_16x16x32_bf16 v[52:55], v[184:187], v[196:199], v[52:55]
    ds_read_b64_tr_b16 v[156:157], v11 offset:0
    ds_read_b64_tr_b16 v[158:159], v11 offset:1024
    v_mfma_f32_16x16x32_bf16 v[36:39], v[180:183], v[196:199], v[36:39]
    v_mfma_f32_16x16x32_bf16 v[20:23], v[176:179], v[196:199], v[20:23]
    v_mfma_f32_16x16x32_bf16 v[24:27], v[176:179], v[200:203], v[24:27]
    v_mfma_f32_16x16x32_bf16 v[40:43], v[180:183], v[200:203], v[40:43]
    v_mfma_f32_16x16x32_bf16 v[56:59], v[184:187], v[200:203], v[56:59]
    v_mfma_f32_16x16x32_bf16 v[72:75], v[188:191], v[200:203], v[72:75]
    v_mfma_f32_16x16x32_bf16 v[76:79], v[188:191], v[204:207], v[76:79]
    v_mfma_f32_16x16x32_bf16 v[60:63], v[184:187], v[204:207], v[60:63]
    v_mfma_f32_16x16x32_bf16 v[44:47], v[180:183], v[204:207], v[44:47]
    v_mfma_f32_16x16x32_bf16 v[28:31], v[176:179], v[204:207], v[28:31]
    s_waitcnt lgkmcnt(0)
    v_mfma_f32_16x16x32_bf16 v[16:19], v[144:147], v[160:163], v[16:19]
    ds_read_b128 v[192:195], v13 offset:16384
    ds_read_b64_tr_b16 v[176:177], v8 offset:8192
    v_mfma_f32_16x16x32_bf16 v[32:35], v[148:151], v[160:163], v[32:35]
    ds_read_b64_tr_b16 v[178:179], v8 offset:9216
    ds_read_b128 v[196:199], v13 offset:18432
    v_mfma_f32_16x16x32_bf16 v[48:51], v[152:155], v[160:163], v[48:51]
    ds_read_b64_tr_b16 v[180:181], v9 offset:8192
    ds_read_b64_tr_b16 v[182:183], v9 offset:9216
    v_mfma_f32_16x16x32_bf16 v[64:67], v[156:159], v[160:163], v[64:67]
    ds_read_b128 v[200:203], v13 offset:20480
    ds_read_b64_tr_b16 v[184:185], v10 offset:8192
    v_mfma_f32_16x16x32_bf16 v[68:71], v[156:159], v[164:167], v[68:71]
    ds_read_b64_tr_b16 v[186:187], v10 offset:9216
    ds_read_b128 v[204:207], v13 offset:22528
    v_mfma_f32_16x16x32_bf16 v[52:55], v[152:155], v[164:167], v[52:55]
    ds_read_b64_tr_b16 v[188:189], v11 offset:8192
    ds_read_b64_tr_b16 v[190:191], v11 offset:9216
    v_mfma_f32_16x16x32_bf16 v[36:39], v[148:151], v[164:167], v[36:39]
    v_mfma_f32_16x16x32_bf16 v[20:23], v[144:147], v[164:167], v[20:23]
    v_mfma_f32_16x16x32_bf16 v[24:27], v[144:147], v[168:171], v[24:27]
    v_mfma_f32_16x16x32_bf16 v[40:43], v[148:151], v[168:171], v[40:43]
    v_mfma_f32_16x16x32_bf16 v[56:59], v[152:155], v[168:171], v[56:59]
    v_mfma_f32_16x16x32_bf16 v[72:75], v[156:159], v[168:171], v[72:75]
    v_mfma_f32_16x16x32_bf16 v[76:79], v[156:159], v[172:175], v[76:79]
    v_mfma_f32_16x16x32_bf16 v[60:63], v[152:155], v[172:175], v[60:63]
    v_mfma_f32_16x16x32_bf16 v[44:47], v[148:151], v[172:175], v[44:47]
    v_mfma_f32_16x16x32_bf16 v[28:31], v[144:147], v[172:175], v[28:31]
    s_waitcnt lgkmcnt(0)
    s_barrier
    v_mfma_f32_16x16x32_bf16 v[16:19], v[176:179], v[192:195], v[16:19]
    ds_read_b128 v[160:163], v12 offset:49152
    ds_read_b64_tr_b16 v[144:145], v8 offset:32768
    v_mfma_f32_16x16x32_bf16 v[32:35], v[180:183], v[192:195], v[32:35]
    ds_read_b64_tr_b16 v[146:147], v8 offset:33792
    ds_read_b128 v[164:167], v12 offset:51200
    v_mfma_f32_16x16x32_bf16 v[48:51], v[184:187], v[192:195], v[48:51]
    ds_read_b64_tr_b16 v[148:149], v9 offset:32768
    ds_read_b64_tr_b16 v[150:151], v9 offset:33792
    v_mfma_f32_16x16x32_bf16 v[64:67], v[188:191], v[192:195], v[64:67]
    ds_read_b128 v[168:171], v12 offset:53248
    ds_read_b64_tr_b16 v[152:153], v10 offset:32768
    v_mfma_f32_16x16x32_bf16 v[68:71], v[188:191], v[196:199], v[68:71]
    ds_read_b64_tr_b16 v[154:155], v10 offset:33792
    ds_read_b128 v[172:175], v12 offset:55296
    v_mfma_f32_16x16x32_bf16 v[52:55], v[184:187], v[196:199], v[52:55]
    ds_read_b64_tr_b16 v[156:157], v11 offset:32768
    ds_read_b64_tr_b16 v[158:159], v11 offset:33792
    v_mfma_f32_16x16x32_bf16 v[36:39], v[180:183], v[196:199], v[36:39]
    v_mfma_f32_16x16x32_bf16 v[20:23], v[176:179], v[196:199], v[20:23]
    v_mfma_f32_16x16x32_bf16 v[24:27], v[176:179], v[200:203], v[24:27]
    v_mfma_f32_16x16x32_bf16 v[40:43], v[180:183], v[200:203], v[40:43]
    v_mfma_f32_16x16x32_bf16 v[56:59], v[184:187], v[200:203], v[56:59]
    v_mfma_f32_16x16x32_bf16 v[72:75], v[188:191], v[200:203], v[72:75]
    v_mfma_f32_16x16x32_bf16 v[76:79], v[188:191], v[204:207], v[76:79]
    v_mfma_f32_16x16x32_bf16 v[60:63], v[184:187], v[204:207], v[60:63]
    v_mfma_f32_16x16x32_bf16 v[44:47], v[180:183], v[204:207], v[44:47]
    v_mfma_f32_16x16x32_bf16 v[28:31], v[176:179], v[204:207], v[28:31]
    s_waitcnt lgkmcnt(0)
    v_mfma_f32_16x16x32_bf16 v[16:19], v[144:147], v[160:163], v[16:19]
    ds_read_b128 v[192:195], v13 offset:49152
    ds_read_b64_tr_b16 v[176:177], v8 offset:40960
    v_mfma_f32_16x16x32_bf16 v[32:35], v[148:151], v[160:163], v[32:35]
    ds_read_b64_tr_b16 v[178:179], v8 offset:41984
    ds_read_b128 v[196:199], v13 offset:51200
    v_mfma_f32_16x16x32_bf16 v[48:51], v[152:155], v[160:163], v[48:51]
    ds_read_b64_tr_b16 v[180:181], v9 offset:40960
    ds_read_b64_tr_b16 v[182:183], v9 offset:41984
    v_mfma_f32_16x16x32_bf16 v[64:67], v[156:159], v[160:163], v[64:67]
    ds_read_b128 v[200:203], v13 offset:53248
    ds_read_b64_tr_b16 v[184:185], v10 offset:40960
    v_mfma_f32_16x16x32_bf16 v[68:71], v[156:159], v[164:167], v[68:71]
    ds_read_b64_tr_b16 v[186:187], v10 offset:41984
    ds_read_b128 v[204:207], v13 offset:55296
    v_mfma_f32_16x16x32_bf16 v[52:55], v[152:155], v[164:167], v[52:55]
    ds_read_b64_tr_b16 v[188:189], v11 offset:40960
    ds_read_b64_tr_b16 v[190:191], v11 offset:41984
    v_xor_b32 v8, s40, v8
    v_mfma_f32_16x16x32_bf16 v[36:39], v[148:151], v[164:167], v[36:39]
    v_xor_b32 v9, s40, v9
    v_xor_b32 v10, s40, v10
    v_mfma_f32_16x16x32_bf16 v[20:23], v[144:147], v[164:167], v[20:23]
    v_xor_b32 v11, s40, v11
    v_xor_b32 v12, s40, v12
    v_mfma_f32_16x16x32_bf16 v[24:27], v[144:147], v[168:171], v[24:27]
    v_xor_b32 v13, s40, v13
    v_mfma_f32_16x16x32_bf16 v[40:43], v[148:151], v[168:171], v[40:43]
    v_mfma_f32_16x16x32_bf16 v[56:59], v[152:155], v[168:171], v[56:59]
    v_mfma_f32_16x16x32_bf16 v[72:75], v[156:159], v[168:171], v[72:75]
    v_mfma_f32_16x16x32_bf16 v[76:79], v[156:159], v[172:175], v[76:79]
    v_mfma_f32_16x16x32_bf16 v[60:63], v[152:155], v[172:175], v[60:63]
    v_mfma_f32_16x16x32_bf16 v[44:47], v[148:151], v[172:175], v[44:47]
    v_mfma_f32_16x16x32_bf16 v[28:31], v[144:147], v[172:175], v[28:31]
    s_waitcnt lgkmcnt(0)
    s_barrier
    v_mfma_f32_16x16x32_bf16 v[16:19], v[176:179], v[192:195], v[16:19]
    ds_read_b128 v[160:163], v12 offset:16384
    ds_read_b64_tr_b16 v[144:145], v8 offset:0
    v_mfma_f32_16x16x32_bf16 v[32:35], v[180:183], v[192:195], v[32:35]
    ds_read_b64_tr_b16 v[146:147], v8 offset:1024
    ds_read_b128 v[164:167], v12 offset:18432
    v_mfma_f32_16x16x32_bf16 v[48:51], v[184:187], v[192:195], v[48:51]
    ds_read_b64_tr_b16 v[148:149], v9 offset:0
    ds_read_b64_tr_b16 v[150:151], v9 offset:1024
    v_mfma_f32_16x16x32_bf16 v[64:67], v[188:191], v[192:195], v[64:67]
    ds_read_b128 v[168:171], v12 offset:20480
    ds_read_b64_tr_b16 v[152:153], v10 offset:0
    v_mfma_f32_16x16x32_bf16 v[68:71], v[188:191], v[196:199], v[68:71]
    ds_read_b64_tr_b16 v[154:155], v10 offset:1024
    ds_read_b128 v[172:175], v12 offset:22528
    v_mfma_f32_16x16x32_bf16 v[52:55], v[184:187], v[196:199], v[52:55]
    ds_read_b64_tr_b16 v[156:157], v11 offset:0
    ds_read_b64_tr_b16 v[158:159], v11 offset:1024
    v_mfma_f32_16x16x32_bf16 v[36:39], v[180:183], v[196:199], v[36:39]
    v_mfma_f32_16x16x32_bf16 v[20:23], v[176:179], v[196:199], v[20:23]
    v_mfma_f32_16x16x32_bf16 v[24:27], v[176:179], v[200:203], v[24:27]
    v_mfma_f32_16x16x32_bf16 v[40:43], v[180:183], v[200:203], v[40:43]
    v_mfma_f32_16x16x32_bf16 v[56:59], v[184:187], v[200:203], v[56:59]
    v_mfma_f32_16x16x32_bf16 v[72:75], v[188:191], v[200:203], v[72:75]
    v_mfma_f32_16x16x32_bf16 v[76:79], v[188:191], v[204:207], v[76:79]
    v_mfma_f32_16x16x32_bf16 v[60:63], v[184:187], v[204:207], v[60:63]
    v_mfma_f32_16x16x32_bf16 v[44:47], v[180:183], v[204:207], v[44:47]
    v_mfma_f32_16x16x32_bf16 v[28:31], v[176:179], v[204:207], v[28:31]
    s_waitcnt lgkmcnt(0)
    v_mfma_f32_16x16x32_bf16 v[16:19], v[144:147], v[160:163], v[16:19]
    ds_read_b128 v[192:195], v13 offset:16384
    ds_read_b64_tr_b16 v[176:177], v8 offset:8192
    v_mfma_f32_16x16x32_bf16 v[32:35], v[148:151], v[160:163], v[32:35]
    ds_read_b64_tr_b16 v[178:179], v8 offset:9216
    ds_read_b128 v[196:199], v13 offset:18432
    v_mfma_f32_16x16x32_bf16 v[48:51], v[152:155], v[160:163], v[48:51]
    ds_read_b64_tr_b16 v[180:181], v9 offset:8192
    ds_read_b64_tr_b16 v[182:183], v9 offset:9216
    v_mfma_f32_16x16x32_bf16 v[64:67], v[156:159], v[160:163], v[64:67]
    ds_read_b128 v[200:203], v13 offset:20480
    ds_read_b64_tr_b16 v[184:185], v10 offset:8192
    v_mfma_f32_16x16x32_bf16 v[68:71], v[156:159], v[164:167], v[68:71]
    ds_read_b64_tr_b16 v[186:187], v10 offset:9216
    ds_read_b128 v[204:207], v13 offset:22528
    v_mfma_f32_16x16x32_bf16 v[52:55], v[152:155], v[164:167], v[52:55]
    ds_read_b64_tr_b16 v[188:189], v11 offset:8192
    ds_read_b64_tr_b16 v[190:191], v11 offset:9216
    v_mfma_f32_16x16x32_bf16 v[36:39], v[148:151], v[164:167], v[36:39]
    v_mfma_f32_16x16x32_bf16 v[20:23], v[144:147], v[164:167], v[20:23]
    v_mfma_f32_16x16x32_bf16 v[24:27], v[144:147], v[168:171], v[24:27]
    v_mfma_f32_16x16x32_bf16 v[40:43], v[148:151], v[168:171], v[40:43]
    v_mfma_f32_16x16x32_bf16 v[56:59], v[152:155], v[168:171], v[56:59]
    v_mfma_f32_16x16x32_bf16 v[72:75], v[156:159], v[168:171], v[72:75]
    v_mfma_f32_16x16x32_bf16 v[76:79], v[156:159], v[172:175], v[76:79]
    v_mfma_f32_16x16x32_bf16 v[60:63], v[152:155], v[172:175], v[60:63]
    v_mfma_f32_16x16x32_bf16 v[44:47], v[148:151], v[172:175], v[44:47]
    v_mfma_f32_16x16x32_bf16 v[28:31], v[144:147], v[172:175], v[28:31]
    s_waitcnt lgkmcnt(0)
    s_barrier
    v_mfma_f32_16x16x32_bf16 v[16:19], v[176:179], v[192:195], v[16:19]
    ds_read_b128 v[160:163], v12 offset:49152
    ds_read_b64_tr_b16 v[144:145], v8 offset:32768
    v_mfma_f32_16x16x32_bf16 v[32:35], v[180:183], v[192:195], v[32:35]
    ds_read_b64_tr_b16 v[146:147], v8 offset:33792
    ds_read_b128 v[164:167], v12 offset:51200
    v_mfma_f32_16x16x32_bf16 v[48:51], v[184:187], v[192:195], v[48:51]
    ds_read_b64_tr_b16 v[148:149], v9 offset:32768
    ds_read_b64_tr_b16 v[150:151], v9 offset:33792
    v_mfma_f32_16x16x32_bf16 v[64:67], v[188:191], v[192:195], v[64:67]
    ds_read_b128 v[168:171], v12 offset:53248
    ds_read_b64_tr_b16 v[152:153], v10 offset:32768
    v_mfma_f32_16x16x32_bf16 v[68:71], v[188:191], v[196:199], v[68:71]
    ds_read_b64_tr_b16 v[154:155], v10 offset:33792
    ds_read_b128 v[172:175], v12 offset:55296
    v_mfma_f32_16x16x32_bf16 v[52:55], v[184:187], v[196:199], v[52:55]
    ds_read_b64_tr_b16 v[156:157], v11 offset:32768
    ds_read_b64_tr_b16 v[158:159], v11 offset:33792
    v_mfma_f32_16x16x32_bf16 v[36:39], v[180:183], v[196:199], v[36:39]
    v_mfma_f32_16x16x32_bf16 v[20:23], v[176:179], v[196:199], v[20:23]
    v_mfma_f32_16x16x32_bf16 v[24:27], v[176:179], v[200:203], v[24:27]
    v_mfma_f32_16x16x32_bf16 v[40:43], v[180:183], v[200:203], v[40:43]
    v_mfma_f32_16x16x32_bf16 v[56:59], v[184:187], v[200:203], v[56:59]
    v_mfma_f32_16x16x32_bf16 v[72:75], v[188:191], v[200:203], v[72:75]
    v_mfma_f32_16x16x32_bf16 v[76:79], v[188:191], v[204:207], v[76:79]
    v_mfma_f32_16x16x32_bf16 v[60:63], v[184:187], v[204:207], v[60:63]
    v_mfma_f32_16x16x32_bf16 v[44:47], v[180:183], v[204:207], v[44:47]
    v_mfma_f32_16x16x32_bf16 v[28:31], v[176:179], v[204:207], v[28:31]
    s_waitcnt lgkmcnt(0)
    v_mfma_f32_16x16x32_bf16 v[16:19], v[144:147], v[160:163], v[16:19]
    ds_read_b128 v[192:195], v13 offset:49152
    ds_read_b64_tr_b16 v[176:177], v8 offset:40960
    v_mfma_f32_16x16x32_bf16 v[32:35], v[148:151], v[160:163], v[32:35]
    ds_read_b64_tr_b16 v[178:179], v8 offset:41984
    ds_read_b128 v[196:199], v13 offset:51200
    v_mfma_f32_16x16x32_bf16 v[48:51], v[152:155], v[160:163], v[48:51]
    ds_read_b64_tr_b16 v[180:181], v9 offset:40960
    ds_read_b64_tr_b16 v[182:183], v9 offset:41984
    v_mfma_f32_16x16x32_bf16 v[64:67], v[156:159], v[160:163], v[64:67]
    ds_read_b128 v[200:203], v13 offset:53248
    ds_read_b64_tr_b16 v[184:185], v10 offset:40960
    v_mfma_f32_16x16x32_bf16 v[68:71], v[156:159], v[164:167], v[68:71]
    ds_read_b64_tr_b16 v[186:187], v10 offset:41984
    ds_read_b128 v[204:207], v13 offset:55296
    v_mfma_f32_16x16x32_bf16 v[52:55], v[152:155], v[164:167], v[52:55]
    ds_read_b64_tr_b16 v[188:189], v11 offset:40960
    ds_read_b64_tr_b16 v[190:191], v11 offset:41984
    v_xor_b32 v8, s40, v8
    v_mfma_f32_16x16x32_bf16 v[36:39], v[148:151], v[164:167], v[36:39]
    v_xor_b32 v9, s40, v9
    v_xor_b32 v10, s40, v10
    v_mfma_f32_16x16x32_bf16 v[20:23], v[144:147], v[164:167], v[20:23]
    v_xor_b32 v11, s40, v11
    v_xor_b32 v12, s40, v12
    v_mfma_f32_16x16x32_bf16 v[24:27], v[144:147], v[168:171], v[24:27]
    v_xor_b32 v13, s40, v13
    v_mfma_f32_16x16x32_bf16 v[40:43], v[148:151], v[168:171], v[40:43]
    v_mfma_f32_16x16x32_bf16 v[56:59], v[152:155], v[168:171], v[56:59]
    v_mfma_f32_16x16x32_bf16 v[72:75], v[156:159], v[168:171], v[72:75]
    v_mfma_f32_16x16x32_bf16 v[76:79], v[156:159], v[172:175], v[76:79]
    v_mfma_f32_16x16x32_bf16 v[60:63], v[152:155], v[172:175], v[60:63]
    v_mfma_f32_16x16x32_bf16 v[44:47], v[148:151], v[172:175], v[44:47]
    v_mfma_f32_16x16x32_bf16 v[28:31], v[144:147], v[172:175], v[28:31]
    s_sub_u32 s39, s39, 1
    s_cmp_lg_u32 s39, 0
    s_waitcnt lgkmcnt(0)
    s_cbranch_scc1 L_g2loop
    s_add_u32 s37, s34, 34603008
    v_mfma_f32_16x16x32_bf16 v[16:19], v[176:179], v[192:195], v[16:19]
    v_mfma_f32_16x16x32_bf16 v[32:35], v[180:183], v[192:195], v[32:35]
    v_mfma_f32_16x16x32_bf16 v[48:51], v[184:187], v[192:195], v[48:51]
    v_mfma_f32_16x16x32_bf16 v[64:67], v[188:191], v[192:195], v[64:67]
    v_mfma_f32_16x16x32_bf16 v[20:23], v[176:179], v[196:199], v[20:23]
    v_mfma_f32_16x16x32_bf16 v[36:39], v[180:183], v[196:199], v[36:39]
    v_mfma_f32_16x16x32_bf16 v[52:55], v[184:187], v[196:199], v[52:55]
    v_mfma_f32_16x16x32_bf16 v[68:71], v[188:191], v[196:199], v[68:71]
    v_mfma_f32_16x16x32_bf16 v[24:27], v[176:179], v[200:203], v[24:27]
    v_mul_f32 v16, v16, v80
    v_mul_f32 v17, v17, v81
    v_mfma_f32_16x16x32_bf16 v[40:43], v[180:183], v[200:203], v[40:43]
    v_mul_f32 v18, v18, v82
    v_mul_f32 v19, v19, v83
    v_mfma_f32_16x16x32_bf16 v[56:59], v[184:187], v[200:203], v[56:59]
    v_mul_f32 v32, v32, v96
    v_mul_f32 v33, v33, v97
    v_mfma_f32_16x16x32_bf16 v[72:75], v[188:191], v[200:203], v[72:75]
    v_mul_f32 v34, v34, v98
    v_mul_f32 v35, v35, v99
    v_mfma_f32_16x16x32_bf16 v[28:31], v[176:179], v[204:207], v[28:31]
    v_mul_f32 v48, v48, v112
    v_mul_f32 v49, v49, v113
    v_mfma_f32_16x16x32_bf16 v[44:47], v[180:183], v[204:207], v[44:47]
    v_mul_f32 v50, v50, v114
    v_mul_f32 v51, v51, v115
    v_mfma_f32_16x16x32_bf16 v[60:63], v[184:187], v[204:207], v[60:63]
    v_mul_f32 v64, v64, v128
    v_mul_f32 v65, v65, v129
    v_mfma_f32_16x16x32_bf16 v[76:79], v[188:191], v[204:207], v[76:79]
    v_mul_f32 v66, v66, v130
    v_mul_f32 v67, v67, v131
    v_cvt_pk_bf16_f32 v232, v16, v17
    v_cvt_pk_bf16_f32 v233, v18, v19
    v_cvt_pk_bf16_f32 v234, v32, v33
    v_cvt_pk_bf16_f32 v235, v34, v35
    v_cvt_pk_bf16_f32 v236, v48, v49
    v_cvt_pk_bf16_f32 v237, v50, v51
    v_cvt_pk_bf16_f32 v238, v64, v65
    v_cvt_pk_bf16_f32 v239, v66, v67
    v_mov_b32_dpp v208, v232 row_ror:8 row_mask:0xf bank_mask:0xf
    v_mov_b32_dpp v209, v233 row_ror:8 row_mask:0xf bank_mask:0xf
    v_mov_b32_dpp v210, v234 row_ror:8 row_mask:0xf bank_mask:0xf
    v_mov_b32_dpp v211, v235 row_ror:8 row_mask:0xf bank_mask:0xf
    v_mov_b32_dpp v232, v236 row_ror:8 row_mask:0xf bank_mask:0xc
    v_mov_b32_dpp v233, v237 row_ror:8 row_mask:0xf bank_mask:0xc
    v_mov_b32_dpp v234, v238 row_ror:8 row_mask:0xf bank_mask:0xc
    v_mov_b32_dpp v235, v239 row_ror:8 row_mask:0xf bank_mask:0xc
    buffer_store_dwordx4 v[232:235], v1, s[8:11], s37 offen sc1
    s_add_u32 s37, s37, 32768
    v_mov_b32_dpp v236, v208 quad_perm:[0,1,2,3] row_mask:0xf bank_mask:0x3
    v_mov_b32_dpp v237, v209 quad_perm:[0,1,2,3] row_mask:0xf bank_mask:0x3
    v_mov_b32_dpp v238, v210 quad_perm:[0,1,2,3] row_mask:0xf bank_mask:0x3
    v_mov_b32_dpp v239, v211 quad_perm:[0,1,2,3] row_mask:0xf bank_mask:0x3
    buffer_store_dwordx4 v[236:239], v1, s[8:11], s37 offen sc1
    s_add_u32 s37, s37, 32768
    v_pk_mul_f32 v[20:21], v[20:21], v[84:85]
    v_pk_mul_f32 v[22:23], v[22:23], v[86:87]
    v_cvt_pk_bf16_f32 v240, v20, v21
    v_cvt_pk_bf16_f32 v241, v22, v23
    v_pk_mul_f32 v[36:37], v[36:37], v[100:101]
    v_pk_mul_f32 v[38:39], v[38:39], v[102:103]
    v_cvt_pk_bf16_f32 v242, v36, v37
    v_cvt_pk_bf16_f32 v243, v38, v39
    v_pk_mul_f32 v[52:53], v[52:53], v[116:117]
    v_pk_mul_f32 v[54:55], v[54:55], v[118:119]
    v_cvt_pk_bf16_f32 v244, v52, v53
    v_cvt_pk_bf16_f32 v245, v54, v55
    v_pk_mul_f32 v[68:69], v[68:69], v[132:133]
    v_pk_mul_f32 v[70:71], v[70:71], v[134:135]
    v_cvt_pk_bf16_f32 v246, v68, v69
    v_cvt_pk_bf16_f32 v247, v70, v71
    v_mov_b32_dpp v208, v240 row_ror:8 row_mask:0xf bank_mask:0xf
    v_mov_b32_dpp v209, v241 row_ror:8 row_mask:0xf bank_mask:0xf
    v_mov_b32_dpp v210, v242 row_ror:8 row_mask:0xf bank_mask:0xf
    v_mov_b32_dpp v211, v243 row_ror:8 row_mask:0xf bank_mask:0xf
    v_mov_b32_dpp v240, v244 row_ror:8 row_mask:0xf bank_mask:0xc
    v_mov_b32_dpp v241, v245 row_ror:8 row_mask:0xf bank_mask:0xc
L_pad_8:
    s_cmp_eq_u32 s99, 1
    s_cbranch_scc1 L_padret_8
    v_mov_b32_dpp v242, v246 row_ror:8 row_mask:0xf bank_mask:0xc
    v_mov_b32_dpp v243, v247 row_ror:8 row_mask:0xf bank_mask:0xc
    buffer_store_dwordx4 v[240:243], v1, s[8:11], s37 offen sc1
    s_add_u32 s37, s37, 32768
    v_mov_b32_dpp v244, v208 quad_perm:[0,1,2,3] row_mask:0xf bank_mask:0x3
    v_mov_b32_dpp v245, v209 quad_perm:[0,1,2,3] row_mask:0xf bank_mask:0x3
    v_mov_b32_dpp v246, v210 quad_perm:[0,1,2,3] row_mask:0xf bank_mask:0x3
    v_mov_b32_dpp v247, v211 quad_perm:[0,1,2,3] row_mask:0xf bank_mask:0x3
    buffer_store_dwordx4 v[244:247], v1, s[8:11], s37 offen sc1
    s_add_u32 s37, s37, 32768
    v_pk_mul_f32 v[24:25], v[24:25], v[88:89]
    v_pk_mul_f32 v[26:27], v[26:27], v[90:91]
    v_cvt_pk_bf16_f32 v232, v24, v25
    v_cvt_pk_bf16_f32 v233, v26, v27
    v_pk_mul_f32 v[40:41], v[40:41], v[104:105]
    v_pk_mul_f32 v[42:43], v[42:43], v[106:107]
    v_cvt_pk_bf16_f32 v234, v40, v41
    v_cvt_pk_bf16_f32 v235, v42, v43
    v_pk_mul_f32 v[56:57], v[56:57], v[120:121]
    v_pk_mul_f32 v[58:59], v[58:59], v[122:123]
    v_cvt_pk_bf16_f32 v236, v56, v57
    v_cvt_pk_bf16_f32 v237, v58, v59
    v_pk_mul_f32 v[72:73], v[72:73], v[136:137]
    v_pk_mul_f32 v[74:75], v[74:75], v[138:139]
    v_cvt_pk_bf16_f32 v238, v72, v73
    v_cvt_pk_bf16_f32 v239, v74, v75
    v_mov_b32_dpp v208, v232 row_ror:8 row_mask:0xf bank_mask:0xf
    v_mov_b32_dpp v209, v233 row_ror:8 row_mask:0xf bank_mask:0xf
    v_mov_b32_dpp v210, v234 row_ror:8 row_mask:0xf bank_mask:0xf
    v_mov_b32_dpp v211, v235 row_ror:8 row_mask:0xf bank_mask:0xf
    v_mov_b32_dpp v232, v236 row_ror:8 row_mask:0xf bank_mask:0xc
    v_mov_b32_dpp v233, v237 row_ror:8 row_mask:0xf bank_mask:0xc
    v_mov_b32_dpp v234, v238 row_ror:8 row_mask:0xf bank_mask:0xc
    v_mov_b32_dpp v235, v239 row_ror:8 row_mask:0xf bank_mask:0xc
    buffer_store_dwordx4 v[232:235], v1, s[8:11], s37 offen sc1
    s_add_u32 s37, s37, 32768
    v_mov_b32_dpp v236, v208 quad_perm:[0,1,2,3] row_mask:0xf bank_mask:0x3
    v_mov_b32_dpp v237, v209 quad_perm:[0,1,2,3] row_mask:0xf bank_mask:0x3
    v_mov_b32_dpp v238, v210 quad_perm:[0,1,2,3] row_mask:0xf bank_mask:0x3
    v_mov_b32_dpp v239, v211 quad_perm:[0,1,2,3] row_mask:0xf bank_mask:0x3
    buffer_store_dwordx4 v[236:239], v1, s[8:11], s37 offen sc1
    s_add_u32 s37, s37, 32768
    v_pk_mul_f32 v[28:29], v[28:29], v[92:93]
    v_pk_mul_f32 v[30:31], v[30:31], v[94:95]
    v_cvt_pk_bf16_f32 v240, v28, v29
    v_cvt_pk_bf16_f32 v241, v30, v31
    v_pk_mul_f32 v[44:45], v[44:45], v[108:109]
    v_pk_mul_f32 v[46:47], v[46:47], v[110:111]
    v_cvt_pk_bf16_f32 v242, v44, v45
    v_cvt_pk_bf16_f32 v243, v46, v47
    v_pk_mul_f32 v[60:61], v[60:61], v[124:125]
    v_pk_mul_f32 v[62:63], v[62:63], v[126:127]
    v_cvt_pk_bf16_f32 v244, v60, v61
    v_cvt_pk_bf16_f32 v245, v62, v63
    v_pk_mul_f32 v[76:77], v[76:77], v[140:141]
    v_pk_mul_f32 v[78:79], v[78:79], v[142:143]
    v_cvt_pk_bf16_f32 v246, v76, v77
    v_cvt_pk_bf16_f32 v247, v78, v79
    v_mov_b32_dpp v208, v240 row_ror:8 row_mask:0xf bank_mask:0xf
    v_mov_b32_dpp v209, v241 row_ror:8 row_mask:0xf bank_mask:0xf
    v_mov_b32_dpp v210, v242 row_ror:8 row_mask:0xf bank_mask:0xf
    v_mov_b32_dpp v211, v243 row_ror:8 row_mask:0xf bank_mask:0xf
    v_mov_b32_dpp v240, v244 row_ror:8 row_mask:0xf bank_mask:0xc
    v_mov_b32_dpp v241, v245 row_ror:8 row_mask:0xf bank_mask:0xc
    v_mov_b32_dpp v242, v246 row_ror:8 row_mask:0xf bank_mask:0xc
    v_mov_b32_dpp v243, v247 row_ror:8 row_mask:0xf bank_mask:0xc
    buffer_store_dwordx4 v[240:243], v1, s[8:11], s37 offen sc1
    s_add_u32 s37, s37, 32768
    v_mov_b32_dpp v244, v208 quad_perm:[0,1,2,3] row_mask:0xf bank_mask:0x3
    v_mov_b32_dpp v245, v209 quad_perm:[0,1,2,3] row_mask:0xf bank_mask:0x3
    v_mov_b32_dpp v246, v210 quad_perm:[0,1,2,3] row_mask:0xf bank_mask:0x3
    v_mov_b32_dpp v247, v211 quad_perm:[0,1,2,3] row_mask:0xf bank_mask:0x3
    buffer_store_dwordx4 v[244:247], v1, s[8:11], s37 offen sc1
    s_add_u32 s37, s37, 32768
    s_waitcnt vmcnt(0)
    s_barrier
L_A3:
    s_and_b32 s35, s3, 1
    s_lshr_b32 s36, s3, 1
    v_bfe_u32 v5, v2, 2, 2
    v_and_b32 v6, 3, v2
    v_lshl_add_u32 v7, v4, 2, v5
    v_lshlrev_b32 v7, 8, v7
    v_lshl_add_u32 v7, v6, 3, v7
    v_and_b32 v6, 1, v4
    v_xor_b32 v6, s35, v6
    v_lshl_add_u32 v7, v6, 7, v7
    v_xor_b32 v6, 0, v5
    v_lshl_add_u32 v8, v6, 5, v7
    v_xor_b32 v6, 1, v5
    v_lshl_add_u32 v9, v6, 5, v7
    v_xor_b32 v6, 2, v5
    v_lshl_add_u32 v10, v6, 5, v7
    v_xor_b32 v6, 3, v5
    v_lshl_add_u32 v11, v6, 5, v7
    s_mul_i32 s37, s36, 4096
    v_lshrrev_b32 v5, 1, v3
    v_xor_b32 v5, v5, v4
    v_lshlrev_b32 v5, 4, v5
    v_lshl_add_u32 v5, v3, 7, v5
    v_add_u32 v12, s37, v5
    v_add_u32 v12, 131072, v12
    v_xor_b32 v13, 64, v12
    s_mov_b32 s40, 0x10000
    s_mov_b32 s20, s90
    s_and_b32 s21, s91, 0xffff
    s_mov_b32 s22, 4194304
    s_mov_b32 s23, 0x00020000
    s_lshl_b32 s41, s56, 6
    s_lshl_b32 s42, s36, 5
    s_add_u32 s41, s41, s42
    v_add_u32 v6, s41, v3
    v_lshlrev_b32 v1, 11, v6
    v_lshl_add_u32 v1, v4, 4, v1
    v_and_b32 v15, 7, v2
    v_add_u32 v15, s41, v15
    v_mul_u32_u24 v15, 2048, v15
    v_lshl_add_u32 v15, v4, 4, v15
    v_bfe_u32 v6, v2, 3, 1
    v_lshl_add_u32 v15, v6, 6, v15
    s_lshl_b32 s37, s57, 8
    s_lshl_b32 s41, s35, 7
    s_add_u32 s37, s37, s41
    v_lshlrev_b32 v14, 5, v4
    s_lshl_b32 s41, s37, 1
    s_add_u32 s41, s41, 20480
    s_barrier
    s_barrier
    ds_read_b128 v[64:67], v12 offset:0
    ds_read_b64_tr_b16 v[48:49], v8 offset:0
    ds_read_b64_tr_b16 v[50:51], v8 offset:4096
    ds_read_b128 v[68:71], v12 offset:2048
    ds_read_b64_tr_b16 v[52:53], v9 offset:0
    ds_read_b64_tr_b16 v[54:55], v9 offset:4096
    ds_read_b64_tr_b16 v[56:57], v10 offset:0
    ds_read_b64_tr_b16 v[58:59], v10 offset:4096
    ds_read_b64_tr_b16 v[60:61], v11 offset:0
    ds_read_b64_tr_b16 v[62:63], v11 offset:4096
    ds_read_b128 v[88:91], v13 offset:0
    ds_read_b64_tr_b16 v[72:73], v8 offset:8192
    ds_read_b64_tr_b16 v[74:75], v8 offset:12288
    ds_read_b128 v[92:95], v13 offset:2048
    ds_read_b64_tr_b16 v[76:77], v9 offset:8192
    ds_read_b64_tr_b16 v[78:79], v9 offset:12288
    ds_read_b64_tr_b16 v[80:81], v10 offset:8192
    ds_read_b64_tr_b16 v[82:83], v10 offset:12288
    ds_read_b64_tr_b16 v[84:85], v11 offset:8192
    ds_read_b64_tr_b16 v[86:87], v11 offset:12288
    s_waitcnt lgkmcnt(0)
    s_barrier
    v_mfma_f32_16x16x32_bf16 v[16:19], v[48:51], v[64:67], 0
    ds_read_b128 v[112:115], v12 offset:8192
    ds_read_b64_tr_b16 v[96:97], v8 offset:16384
    v_mfma_f32_16x16x32_bf16 v[24:27], v[52:55], v[64:67], 0
    ds_read_b64_tr_b16 v[98:99], v8 offset:20480
    ds_read_b128 v[116:119], v12 offset:10240
    v_mfma_f32_16x16x32_bf16 v[32:35], v[56:59], v[64:67], 0
    ds_read_b64_tr_b16 v[100:101], v9 offset:16384
    ds_read_b64_tr_b16 v[102:103], v9 offset:20480
    v_mfma_f32_16x16x32_bf16 v[40:43], v[60:63], v[64:67], 0
    ds_read_b64_tr_b16 v[104:105], v10 offset:16384
    ds_read_b64_tr_b16 v[106:107], v10 offset:20480
    v_mfma_f32_16x16x32_bf16 v[44:47], v[60:63], v[68:71], 0
    ds_read_b64_tr_b16 v[108:109], v11 offset:16384
    ds_read_b64_tr_b16 v[110:111], v11 offset:20480
    v_mfma_f32_16x16x32_bf16 v[36:39], v[56:59], v[68:71], 0
    ds_read_b128 v[136:139], v13 offset:8192
    ds_read_b64_tr_b16 v[120:121], v8 offset:24576
    v_mfma_f32_16x16x32_bf16 v[28:31], v[52:55], v[68:71], 0
    ds_read_b64_tr_b16 v[122:123], v8 offset:28672
    ds_read_b128 v[140:143], v13 offset:10240
    v_mfma_f32_16x16x32_bf16 v[20:23], v[48:51], v[68:71], 0
    ds_read_b64_tr_b16 v[124:125], v9 offset:24576
    ds_read_b64_tr_b16 v[126:127], v9 offset:28672
    v_mfma_f32_16x16x32_bf16 v[16:19], v[72:75], v[88:91], v[16:19]
    ds_read_b64_tr_b16 v[128:129], v10 offset:24576
    ds_read_b64_tr_b16 v[130:131], v10 offset:28672
    v_mfma_f32_16x16x32_bf16 v[24:27], v[76:79], v[88:91], v[24:27]
    ds_read_b64_tr_b16 v[132:133], v11 offset:24576
    ds_read_b64_tr_b16 v[134:135], v11 offset:28672
    v_mfma_f32_16x16x32_bf16 v[32:35], v[80:83], v[88:91], v[32:35]
    v_mfma_f32_16x16x32_bf16 v[40:43], v[84:87], v[88:91], v[40:43]
    v_mfma_f32_16x16x32_bf16 v[44:47], v[84:87], v[92:95], v[44:47]
    v_mfma_f32_16x16x32_bf16 v[36:39], v[80:83], v[92:95], v[36:39]
    v_mfma_f32_16x16x32_bf16 v[28:31], v[76:79], v[92:95], v[28:31]
    v_mfma_f32_16x16x32_bf16 v[20:23], v[72:75], v[92:95], v[20:23]
    s_waitcnt lgkmcnt(0)
    s_mov_b32 s39, 3
L_g3loop:
    s_barrier
    v_mfma_f32_16x16x32_bf16 v[16:19], v[96:99], v[112:115], v[16:19]
    ds_read_b128 v[64:67], v12 offset:16384
    ds_read_b64_tr_b16 v[48:49], v8 offset:32768
    v_mfma_f32_16x16x32_bf16 v[24:27], v[100:103], v[112:115], v[24:27]
    ds_read_b64_tr_b16 v[50:51], v8 offset:36864
    ds_read_b128 v[68:71], v12 offset:18432
    v_mfma_f32_16x16x32_bf16 v[32:35], v[104:107], v[112:115], v[32:35]
    ds_read_b64_tr_b16 v[52:53], v9 offset:32768
    ds_read_b64_tr_b16 v[54:55], v9 offset:36864
    v_mfma_f32_16x16x32_bf16 v[40:43], v[108:111], v[112:115], v[40:43]
    ds_read_b64_tr_b16 v[56:57], v10 offset:32768
    ds_read_b64_tr_b16 v[58:59], v10 offset:36864
    v_mfma_f32_16x16x32_bf16 v[44:47], v[108:111], v[116:119], v[44:47]
    ds_read_b64_tr_b16 v[60:61], v11 offset:32768
    ds_read_b64_tr_b16 v[62:63], v11 offset:36864
    v_mfma_f32_16x16x32_bf16 v[36:39], v[104:107], v[116:119], v[36:39]
    ds_read_b128 v[88:91], v13 offset:16384
    ds_read_b64_tr_b16 v[72:73], v8 offset:40960
    v_mfma_f32_16x16x32_bf16 v[28:31], v[100:103], v[116:119], v[28:31]
    ds_read_b64_tr_b16 v[74:75], v8 offset:45056
    ds_read_b128 v[92:95], v13 offset:18432
    v_mfma_f32_16x16x32_bf16 v[20:23], v[96:99], v[116:119], v[20:23]
    ds_read_b64_tr_b16 v[76:77], v9 offset:40960
    ds_read_b64_tr_b16 v[78:79], v9 offset:45056
    v_mfma_f32_16x16x32_bf16 v[16:19], v[120:123], v[136:139], v[16:19]
    ds_read_b64_tr_b16 v[80:81], v10 offset:40960
    ds_read_b64_tr_b16 v[82:83], v10 offset:45056
    v_mfma_f32_16x16x32_bf16 v[24:27], v[124:127], v[136:139], v[24:27]
    ds_read_b64_tr_b16 v[84:85], v11 offset:40960
    ds_read_b64_tr_b16 v[86:87], v11 offset:45056
    v_mfma_f32_16x16x32_bf16 v[32:35], v[128:131], v[136:139], v[32:35]
    v_mfma_f32_16x16x32_bf16 v[40:43], v[132:135], v[136:139], v[40:43]
    v_mfma_f32_16x16x32_bf16 v[44:47], v[132:135], v[140:143], v[44:47]
    v_mfma_f32_16x16x32_bf16 v[36:39], v[128:131], v[140:143], v[36:39]
    v_mfma_f32_16x16x32_bf16 v[28:31], v[124:127], v[140:143], v[28:31]
    v_mfma_f32_16x16x32_bf16 v[20:23], v[120:123], v[140:143], v[20:23]
    s_waitcnt lgkmcnt(0)
    s_barrier
    v_mfma_f32_16x16x32_bf16 v[16:19], v[48:51], v[64:67], v[16:19]
    ds_read_b128 v[112:115], v12 offset:24576
    ds_read_b64_tr_b16 v[96:97], v8 offset:49152
    v_mfma_f32_16x16x32_bf16 v[24:27], v[52:55], v[64:67], v[24:27]
    ds_read_b64_tr_b16 v[98:99], v8 offset:53248
    ds_read_b128 v[116:119], v12 offset:26624
    v_mfma_f32_16x16x32_bf16 v[32:35], v[56:59], v[64:67], v[32:35]
    ds_read_b64_tr_b16 v[100:101], v9 offset:49152
    ds_read_b64_tr_b16 v[102:103], v9 offset:53248
    v_mfma_f32_16x16x32_bf16 v[40:43], v[60:63], v[64:67], v[40:43]
    ds_read_b64_tr_b16 v[104:105], v10 offset:49152
    ds_read_b64_tr_b16 v[106:107], v10 offset:53248
    v_mfma_f32_16x16x32_bf16 v[44:47], v[60:63], v[68:71], v[44:47]
    ds_read_b64_tr_b16 v[108:109], v11 offset:49152
    ds_read_b64_tr_b16 v[110:111], v11 offset:53248
    v_mfma_f32_16x16x32_bf16 v[36:39], v[56:59], v[68:71], v[36:39]
    ds_read_b128 v[136:139], v13 offset:24576
    ds_read_b64_tr_b16 v[120:121], v8 offset:57344
    v_mfma_f32_16x16x32_bf16 v[28:31], v[52:55], v[68:71], v[28:31]
    ds_read_b64_tr_b16 v[122:123], v8 offset:61440
    ds_read_b128 v[140:143], v13 offset:26624
    v_mfma_f32_16x16x32_bf16 v[20:23], v[48:51], v[68:71], v[20:23]
    ds_read_b64_tr_b16 v[124:125], v9 offset:57344
    ds_read_b64_tr_b16 v[126:127], v9 offset:61440
    v_mfma_f32_16x16x32_bf16 v[16:19], v[72:75], v[88:91], v[16:19]
    ds_read_b64_tr_b16 v[128:129], v10 offset:57344
    ds_read_b64_tr_b16 v[130:131], v10 offset:61440
    v_mfma_f32_16x16x32_bf16 v[24:27], v[76:79], v[88:91], v[24:27]
    ds_read_b64_tr_b16 v[132:133], v11 offset:57344
    ds_read_b64_tr_b16 v[134:135], v11 offset:61440
    v_xor_b32 v8, s40, v8
    v_mfma_f32_16x16x32_bf16 v[32:35], v[80:83], v[88:91], v[32:35]
    v_xor_b32 v9, s40, v9
    v_xor_b32 v10, s40, v10
    v_mfma_f32_16x16x32_bf16 v[40:43], v[84:87], v[88:91], v[40:43]
    v_xor_b32 v11, s40, v11
    v_mfma_f32_16x16x32_bf16 v[44:47], v[84:87], v[92:95], v[44:47]
    v_mfma_f32_16x16x32_bf16 v[36:39], v[80:83], v[92:95], v[36:39]
    v_mfma_f32_16x16x32_bf16 v[28:31], v[76:79], v[92:95], v[28:31]
    v_mfma_f32_16x16x32_bf16 v[20:23], v[72:75], v[92:95], v[20:23]
    s_waitcnt lgkmcnt(0)
    s_barrier
    v_mfma_f32_16x16x32_bf16 v[16:19], v[96:99], v[112:115], v[16:19]
    ds_read_b128 v[64:67], v12 offset:0
    ds_read_b64_tr_b16 v[48:49], v8 offset:0
    v_mfma_f32_16x16x32_bf16 v[24:27], v[100:103], v[112:115], v[24:27]
    ds_read_b64_tr_b16 v[50:51], v8 offset:4096
    ds_read_b128 v[68:71], v12 offset:2048
    v_mfma_f32_16x16x32_bf16 v[32:35], v[104:107], v[112:115], v[32:35]
    ds_read_b64_tr_b16 v[52:53], v9 offset:0
    ds_read_b64_tr_b16 v[54:55], v9 offset:4096
    v_mfma_f32_16x16x32_bf16 v[40:43], v[108:111], v[112:115], v[40:43]
    ds_read_b64_tr_b16 v[56:57], v10 offset:0
    ds_read_b64_tr_b16 v[58:59], v10 offset:4096
    v_mfma_f32_16x16x32_bf16 v[44:47], v[108:111], v[116:119], v[44:47]
    ds_read_b64_tr_b16 v[60:61], v11 offset:0
    ds_read_b64_tr_b16 v[62:63], v11 offset:4096
    v_mfma_f32_16x16x32_bf16 v[36:39], v[104:107], v[116:119], v[36:39]
    ds_read_b128 v[88:91], v13 offset:0
    ds_read_b64_tr_b16 v[72:73], v8 offset:8192
    v_mfma_f32_16x16x32_bf16 v[28:31], v[100:103], v[116:119], v[28:31]
    ds_read_b64_tr_b16 v[74:75], v8 offset:12288
    ds_read_b128 v[92:95], v13 offset:2048
    v_mfma_f32_16x16x32_bf16 v[20:23], v[96:99], v[116:119], v[20:23]
    ds_read_b64_tr_b16 v[76:77], v9 offset:8192
    ds_read_b64_tr_b16 v[78:79], v9 offset:12288
    v_mfma_f32_16x16x32_bf16 v[16:19], v[120:123], v[136:139], v[16:19]
    ds_read_b64_tr_b16 v[80:81], v10 offset:8192
    ds_read_b64_tr_b16 v[82:83], v10 offset:12288
    v_mfma_f32_16x16x32_bf16 v[24:27], v[124:127], v[136:139], v[24:27]
    ds_read_b64_tr_b16 v[84:85], v11 offset:8192
    ds_read_b64_tr_b16 v[86:87], v11 offset:12288
    v_mfma_f32_16x16x32_bf16 v[32:35], v[128:131], v[136:139], v[32:35]
    v_mfma_f32_16x16x32_bf16 v[40:43], v[132:135], v[136:139], v[40:43]
    v_mfma_f32_16x16x32_bf16 v[44:47], v[132:135], v[140:143], v[44:47]
    v_mfma_f32_16x16x32_bf16 v[36:39], v[128:131], v[140:143], v[36:39]
    v_mfma_f32_16x16x32_bf16 v[28:31], v[124:127], v[140:143], v[28:31]
    v_mfma_f32_16x16x32_bf16 v[20:23], v[120:123], v[140:143], v[20:23]
    s_waitcnt lgkmcnt(0)
    s_barrier
    v_mfma_f32_16x16x32_bf16 v[16:19], v[48:51], v[64:67], v[16:19]
    ds_read_b128 v[112:115], v12 offset:8192
    ds_read_b64_tr_b16 v[96:97], v8 offset:16384
    v_mfma_f32_16x16x32_bf16 v[24:27], v[52:55], v[64:67], v[24:27]
    ds_read_b64_tr_b16 v[98:99], v8 offset:20480
    ds_read_b128 v[116:119], v12 offset:10240
    v_mfma_f32_16x16x32_bf16 v[32:35], v[56:59], v[64:67], v[32:35]
    ds_read_b64_tr_b16 v[100:101], v9 offset:16384
    ds_read_b64_tr_b16 v[102:103], v9 offset:20480
    v_mfma_f32_16x16x32_bf16 v[40:43], v[60:63], v[64:67], v[40:43]
    ds_read_b64_tr_b16 v[104:105], v10 offset:16384
    ds_read_b64_tr_b16 v[106:107], v10 offset:20480
    v_mfma_f32_16x16x32_bf16 v[44:47], v[60:63], v[68:71], v[44:47]
    ds_read_b64_tr_b16 v[108:109], v11 offset:16384
    ds_read_b64_tr_b16 v[110:111], v11 offset:20480
    v_mfma_f32_16x16x32_bf16 v[36:39], v[56:59], v[68:71], v[36:39]
    ds_read_b128 v[136:139], v13 offset:8192
    ds_read_b64_tr_b16 v[120:121], v8 offset:24576
    v_mfma_f32_16x16x32_bf16 v[28:31], v[52:55], v[68:71], v[28:31]
    ds_read_b64_tr_b16 v[122:123], v8 offset:28672
    ds_read_b128 v[140:143], v13 offset:10240
    v_mfma_f32_16x16x32_bf16 v[20:23], v[48:51], v[68:71], v[20:23]
    ds_read_b64_tr_b16 v[124:125], v9 offset:24576
    ds_read_b64_tr_b16 v[126:127], v9 offset:28672
    v_mfma_f32_16x16x32_bf16 v[16:19], v[72:75], v[88:91], v[16:19]
    ds_read_b64_tr_b16 v[128:129], v10 offset:24576
    ds_read_b64_tr_b16 v[130:131], v10 offset:28672
    v_mfma_f32_16x16x32_bf16 v[24:27], v[76:79], v[88:91], v[24:27]
    ds_read_b64_tr_b16 v[132:133], v11 offset:24576
    ds_read_b64_tr_b16 v[134:135], v11 offset:28672
    v_mfma_f32_16x16x32_bf16 v[32:35], v[80:83], v[88:91], v[32:35]
    v_mfma_f32_16x16x32_bf16 v[40:43], v[84:87], v[88:91], v[40:43]
    v_mfma_f32_16x16x32_bf16 v[44:47], v[84:87], v[92:95], v[44:47]
    v_mfma_f32_16x16x32_bf16 v[36:39], v[80:83], v[92:95], v[36:39]
    v_mfma_f32_16x16x32_bf16 v[28:31], v[76:79], v[92:95], v[28:31]
    v_mfma_f32_16x16x32_bf16 v[20:23], v[72:75], v[92:95], v[20:23]
    s_waitcnt lgkmcnt(0)
    s_barrier
    v_mfma_f32_16x16x32_bf16 v[16:19], v[96:99], v[112:115], v[16:19]
    ds_read_b128 v[64:67], v12 offset:16384
    ds_read_b64_tr_b16 v[48:49], v8 offset:32768
    v_mfma_f32_16x16x32_bf16 v[24:27], v[100:103], v[112:115], v[24:27]
    ds_read_b64_tr_b16 v[50:51], v8 offset:36864
    ds_read_b128 v[68:71], v12 offset:18432
    v_mfma_f32_16x16x32_bf16 v[32:35], v[104:107], v[112:115], v[32:35]
    ds_read_b64_tr_b16 v[52:53], v9 offset:32768
    ds_read_b64_tr_b16 v[54:55], v9 offset:36864
    v_mfma_f32_16x16x32_bf16 v[40:43], v[108:111], v[112:115], v[40:43]
    ds_read_b64_tr_b16 v[56:57], v10 offset:32768
    ds_read_b64_tr_b16 v[58:59], v10 offset:36864
    v_mfma_f32_16x16x32_bf16 v[44:47], v[108:111], v[116:119], v[44:47]
    ds_read_b64_tr_b16 v[60:61], v11 offset:32768
    ds_read_b64_tr_b16 v[62:63], v11 offset:36864
    v_mfma_f32_16x16x32_bf16 v[36:39], v[104:107], v[116:119], v[36:39]
    ds_read_b128 v[88:91], v13 offset:16384
    ds_read_b64_tr_b16 v[72:73], v8 offset:40960
    v_mfma_f32_16x16x32_bf16 v[28:31], v[100:103], v[116:119], v[28:31]
    ds_read_b64_tr_b16 v[74:75], v8 offset:45056
    ds_read_b128 v[92:95], v13 offset:18432
    v_mfma_f32_16x16x32_bf16 v[20:23], v[96:99], v[116:119], v[20:23]
    ds_read_b64_tr_b16 v[76:77], v9 offset:40960
    ds_read_b64_tr_b16 v[78:79], v9 offset:45056
    v_mfma_f32_16x16x32_bf16 v[16:19], v[120:123], v[136:139], v[16:19]
    ds_read_b64_tr_b16 v[80:81], v10 offset:40960
    ds_read_b64_tr_b16 v[82:83], v10 offset:45056
    v_mfma_f32_16x16x32_bf16 v[24:27], v[124:127], v[136:139], v[24:27]
    ds_read_b64_tr_b16 v[84:85], v11 offset:40960
    ds_read_b64_tr_b16 v[86:87], v11 offset:45056
    v_mfma_f32_16x16x32_bf16 v[32:35], v[128:131], v[136:139], v[32:35]
    v_mfma_f32_16x16x32_bf16 v[40:43], v[132:135], v[136:139], v[40:43]
    v_mfma_f32_16x16x32_bf16 v[44:47], v[132:135], v[140:143], v[44:47]
    v_mfma_f32_16x16x32_bf16 v[36:39], v[128:131], v[140:143], v[36:39]
    v_mfma_f32_16x16x32_bf16 v[28:31], v[124:127], v[140:143], v[28:31]
    v_mfma_f32_16x16x32_bf16 v[20:23], v[120:123], v[140:143], v[20:23]
    s_waitcnt lgkmcnt(0)
    s_barrier
    v_mfma_f32_16x16x32_bf16 v[16:19], v[48:51], v[64:67], v[16:19]
    ds_read_b128 v[112:115], v12 offset:24576
    ds_read_b64_tr_b16 v[96:97], v8 offset:49152
    v_mfma_f32_16x16x32_bf16 v[24:27], v[52:55], v[64:67], v[24:27]
    ds_read_b64_tr_b16 v[98:99], v8 offset:53248
    ds_read_b128 v[116:119], v12 offset:26624
    v_mfma_f32_16x16x32_bf16 v[32:35], v[56:59], v[64:67], v[32:35]
    ds_read_b64_tr_b16 v[100:101], v9 offset:49152
    ds_read_b64_tr_b16 v[102:103], v9 offset:53248
    v_mfma_f32_16x16x32_bf16 v[40:43], v[60:63], v[64:67], v[40:43]
    ds_read_b64_tr_b16 v[104:105], v10 offset:49152
    ds_read_b64_tr_b16 v[106:107], v10 offset:53248
    v_mfma_f32_16x16x32_bf16 v[44:47], v[60:63], v[68:71], v[44:47]
    ds_read_b64_tr_b16 v[108:109], v11 offset:49152
    ds_read_b64_tr_b16 v[110:111], v11 offset:53248
    v_mfma_f32_16x16x32_bf16 v[36:39], v[56:59], v[68:71], v[36:39]
    ds_read_b128 v[136:139], v13 offset:24576
    ds_read_b64_tr_b16 v[120:121], v8 offset:57344
    v_mfma_f32_16x16x32_bf16 v[28:31], v[52:55], v[68:71], v[28:31]
    ds_read_b64_tr_b16 v[122:123], v8 offset:61440
    ds_read_b128 v[140:143], v13 offset:26624
    v_mfma_f32_16x16x32_bf16 v[20:23], v[48:51], v[68:71], v[20:23]
    ds_read_b64_tr_b16 v[124:125], v9 offset:57344
    ds_read_b64_tr_b16 v[126:127], v9 offset:61440
    v_mfma_f32_16x16x32_bf16 v[16:19], v[72:75], v[88:91], v[16:19]
    ds_read_b64_tr_b16 v[128:129], v10 offset:57344
    ds_read_b64_tr_b16 v[130:131], v10 offset:61440
    v_mfma_f32_16x16x32_bf16 v[24:27], v[76:79], v[88:91], v[24:27]
    ds_read_b64_tr_b16 v[132:133], v11 offset:57344
    ds_read_b64_tr_b16 v[134:135], v11 offset:61440
    v_xor_b32 v8, s40, v8
    v_mfma_f32_16x16x32_bf16 v[32:35], v[80:83], v[88:91], v[32:35]
    v_xor_b32 v9, s40, v9
    v_xor_b32 v10, s40, v10
    v_mfma_f32_16x16x32_bf16 v[40:43], v[84:87], v[88:91], v[40:43]
    v_xor_b32 v11, s40, v11
    v_mfma_f32_16x16x32_bf16 v[44:47], v[84:87], v[92:95], v[44:47]
    v_mfma_f32_16x16x32_bf16 v[36:39], v[80:83], v[92:95], v[36:39]
    v_mfma_f32_16x16x32_bf16 v[28:31], v[76:79], v[92:95], v[28:31]
    v_mfma_f32_16x16x32_bf16 v[20:23], v[72:75], v[92:95], v[20:23]
    s_waitcnt lgkmcnt(0)
    s_barrier
    v_mfma_f32_16x16x32_bf16 v[16:19], v[96:99], v[112:115], v[16:19]
    ds_read_b128 v[64:67], v12 offset:0
    ds_read_b64_tr_b16 v[48:49], v8 offset:0
    v_mfma_f32_16x16x32_bf16 v[24:27], v[100:103], v[112:115], v[24:27]
    ds_read_b64_tr_b16 v[50:51], v8 offset:4096
    ds_read_b128 v[68:71], v12 offset:2048
    v_mfma_f32_16x16x32_bf16 v[32:35], v[104:107], v[112:115], v[32:35]
    ds_read_b64_tr_b16 v[52:53], v9 offset:0
    ds_read_b64_tr_b16 v[54:55], v9 offset:4096
    v_mfma_f32_16x16x32_bf16 v[40:43], v[108:111], v[112:115], v[40:43]
    ds_read_b64_tr_b16 v[56:57], v10 offset:0
    ds_read_b64_tr_b16 v[58:59], v10 offset:4096
    v_mfma_f32_16x16x32_bf16 v[44:47], v[108:111], v[116:119], v[44:47]
    ds_read_b64_tr_b16 v[60:61], v11 offset:0
    ds_read_b64_tr_b16 v[62:63], v11 offset:4096
    v_mfma_f32_16x16x32_bf16 v[36:39], v[104:107], v[116:119], v[36:39]
    ds_read_b128 v[88:91], v13 offset:0
    ds_read_b64_tr_b16 v[72:73], v8 offset:8192
    v_mfma_f32_16x16x32_bf16 v[28:31], v[100:103], v[116:119], v[28:31]
    ds_read_b64_tr_b16 v[74:75], v8 offset:12288
    ds_read_b128 v[92:95], v13 offset:2048
    v_mfma_f32_16x16x32_bf16 v[20:23], v[96:99], v[116:119], v[20:23]
    ds_read_b64_tr_b16 v[76:77], v9 offset:8192
    ds_read_b64_tr_b16 v[78:79], v9 offset:12288
    v_mfma_f32_16x16x32_bf16 v[16:19], v[120:123], v[136:139], v[16:19]
    ds_read_b64_tr_b16 v[80:81], v10 offset:8192
    ds_read_b64_tr_b16 v[82:83], v10 offset:12288
    v_mfma_f32_16x16x32_bf16 v[24:27], v[124:127], v[136:139], v[24:27]
    ds_read_b64_tr_b16 v[84:85], v11 offset:8192
    ds_read_b64_tr_b16 v[86:87], v11 offset:12288
    v_mfma_f32_16x16x32_bf16 v[32:35], v[128:131], v[136:139], v[32:35]
    v_mfma_f32_16x16x32_bf16 v[40:43], v[132:135], v[136:139], v[40:43]
    v_mfma_f32_16x16x32_bf16 v[44:47], v[132:135], v[140:143], v[44:47]
    v_mfma_f32_16x16x32_bf16 v[36:39], v[128:131], v[140:143], v[36:39]
    v_mfma_f32_16x16x32_bf16 v[28:31], v[124:127], v[140:143], v[28:31]
    v_mfma_f32_16x16x32_bf16 v[20:23], v[120:123], v[140:143], v[20:23]
    s_waitcnt lgkmcnt(0)
    s_barrier
    v_mfma_f32_16x16x32_bf16 v[16:19], v[48:51], v[64:67], v[16:19]
    ds_read_b128 v[112:115], v12 offset:8192
    ds_read_b64_tr_b16 v[96:97], v8 offset:16384
    v_mfma_f32_16x16x32_bf16 v[24:27], v[52:55], v[64:67], v[24:27]
    ds_read_b64_tr_b16 v[98:99], v8 offset:20480
    ds_read_b128 v[116:119], v12 offset:10240
    v_mfma_f32_16x16x32_bf16 v[32:35], v[56:59], v[64:67], v[32:35]
    ds_read_b64_tr_b16 v[100:101], v9 offset:16384
    ds_read_b64_tr_b16 v[102:103], v9 offset:20480
    v_mfma_f32_16x16x32_bf16 v[40:43], v[60:63], v[64:67], v[40:43]
    ds_read_b64_tr_b16 v[104:105], v10 offset:16384
    ds_read_b64_tr_b16 v[106:107], v10 offset:20480
    v_mfma_f32_16x16x32_bf16 v[44:47], v[60:63], v[68:71], v[44:47]
    ds_read_b64_tr_b16 v[108:109], v11 offset:16384
    ds_read_b64_tr_b16 v[110:111], v11 offset:20480
    v_mfma_f32_16x16x32_bf16 v[36:39], v[56:59], v[68:71], v[36:39]
    ds_read_b128 v[136:139], v13 offset:8192
    ds_read_b64_tr_b16 v[120:121], v8 offset:24576
    v_mfma_f32_16x16x32_bf16 v[28:31], v[52:55], v[68:71], v[28:31]
    ds_read_b64_tr_b16 v[122:123], v8 offset:28672
    ds_read_b128 v[140:143], v13 offset:10240
    v_mfma_f32_16x16x32_bf16 v[20:23], v[48:51], v[68:71], v[20:23]
    ds_read_b64_tr_b16 v[124:125], v9 offset:24576
    ds_read_b64_tr_b16 v[126:127], v9 offset:28672
    v_mfma_f32_16x16x32_bf16 v[16:19], v[72:75], v[88:91], v[16:19]
    ds_read_b64_tr_b16 v[128:129], v10 offset:24576
    ds_read_b64_tr_b16 v[130:131], v10 offset:28672
    v_mfma_f32_16x16x32_bf16 v[24:27], v[76:79], v[88:91], v[24:27]
    ds_read_b64_tr_b16 v[132:133], v11 offset:24576
    ds_read_b64_tr_b16 v[134:135], v11 offset:28672
    v_mfma_f32_16x16x32_bf16 v[32:35], v[80:83], v[88:91], v[32:35]
    v_mfma_f32_16x16x32_bf16 v[40:43], v[84:87], v[88:91], v[40:43]
    v_mfma_f32_16x16x32_bf16 v[44:47], v[84:87], v[92:95], v[44:47]
    v_mfma_f32_16x16x32_bf16 v[36:39], v[80:83], v[92:95], v[36:39]
    v_mfma_f32_16x16x32_bf16 v[28:31], v[76:79], v[92:95], v[28:31]
    v_mfma_f32_16x16x32_bf16 v[20:23], v[72:75], v[92:95], v[20:23]
    s_sub_u32 s39, s39, 1
    s_cmp_lg_u32 s39, 0
    s_waitcnt lgkmcnt(0)
    s_cbranch_scc1 L_g3loop
    s_barrier
    buffer_load_dwordx4 v[160:163], v14, s[8:11], s41 offen offset:0 sc1
    buffer_load_dwordx4 v[164:167], v14, s[8:11], s41 offen offset:16 sc1
    buffer_load_dwordx4 v[168:171], v14, s[8:11], s41 offen offset:128 sc1
    buffer_load_dwordx4 v[172:175], v14, s[8:11], s41 offen offset:144 sc1
    s_add_u32 s41, s41, 24576
    buffer_load_dwordx4 v[208:211], v14, s[8:11], s41 offen offset:0 sc1
    buffer_load_dwordx4 v[212:215], v14, s[8:11], s41 offen offset:16 sc1
    buffer_load_dwordx4 v[216:219], v14, s[8:11], s41 offen offset:128 sc1
    buffer_load_dwordx4 v[220:223], v14, s[8:11], s41 offen offset:144 sc1
    s_add_u32 s41, s37, 13631488
    buffer_load_dwordx4 v[144:147], v1, s[8:11], s41 offen offset:0 sc1
    buffer_load_dwordx4 v[148:151], v1, s[8:11], s41 offen offset:64 sc1
    s_add_u32 s41, s37, 13664256
    buffer_load_dwordx4 v[152:155], v1, s[8:11], s41 offen offset:0 sc1
    buffer_load_dwordx4 v[156:159], v1, s[8:11], s41 offen offset:64 sc1
    v_mfma_f32_16x16x32_bf16 v[16:19], v[96:99], v[112:115], v[16:19]
    ds_read_b128 v[64:67], v12 offset:16384
    ds_read_b64_tr_b16 v[48:49], v8 offset:32768
    v_mfma_f32_16x16x32_bf16 v[24:27], v[100:103], v[112:115], v[24:27]
    ds_read_b64_tr_b16 v[50:51], v8 offset:36864
    ds_read_b128 v[68:71], v12 offset:18432
    v_mfma_f32_16x16x32_bf16 v[32:35], v[104:107], v[112:115], v[32:35]
    ds_read_b64_tr_b16 v[52:53], v9 offset:32768
    ds_read_b64_tr_b16 v[54:55], v9 offset:36864
    v_mfma_f32_16x16x32_bf16 v[40:43], v[108:111], v[112:115], v[40:43]
    ds_read_b64_tr_b16 v[56:57], v10 offset:32768
    ds_read_b64_tr_b16 v[58:59], v10 offset:36864
    v_mfma_f32_16x16x32_bf16 v[44:47], v[108:111], v[116:119], v[44:47]
    ds_read_b64_tr_b16 v[60:61], v11 offset:32768
    ds_read_b64_tr_b16 v[62:63], v11 offset:36864
    v_mfma_f32_16x16x32_bf16 v[36:39], v[104:107], v[116:119], v[36:39]
    ds_read_b128 v[88:91], v13 offset:16384
    ds_read_b64_tr_b16 v[72:73], v8 offset:40960
    v_mfma_f32_16x16x32_bf16 v[28:31], v[100:103], v[116:119], v[28:31]
    ds_read_b64_tr_b16 v[74:75], v8 offset:45056
    ds_read_b128 v[92:95], v13 offset:18432
    v_mfma_f32_16x16x32_bf16 v[20:23], v[96:99], v[116:119], v[20:23]
    ds_read_b64_tr_b16 v[76:77], v9 offset:40960
    ds_read_b64_tr_b16 v[78:79], v9 offset:45056
    v_mfma_f32_16x16x32_bf16 v[16:19], v[120:123], v[136:139], v[16:19]
L_pad_9:
    s_cmp_eq_u32 s99, 1
    s_cbranch_scc1 L_padret_9
    ds_read_b64_tr_b16 v[80:81], v10 offset:40960
    ds_read_b64_tr_b16 v[82:83], v10 offset:45056
    v_mfma_f32_16x16x32_bf16 v[24:27], v[124:127], v[136:139], v[24:27]
    ds_read_b64_tr_b16 v[84:85], v11 offset:40960
    ds_read_b64_tr_b16 v[86:87], v11 offset:45056
    v_mfma_f32_16x16x32_bf16 v[32:35], v[128:131], v[136:139], v[32:35]
    v_mfma_f32_16x16x32_bf16 v[40:43], v[132:135], v[136:139], v[40:43]
    v_mfma_f32_16x16x32_bf16 v[44:47], v[132:135], v[140:143], v[44:47]
    v_mfma_f32_16x16x32_bf16 v[36:39], v[128:131], v[140:143], v[36:39]
    v_mfma_f32_16x16x32_bf16 v[28:31], v[124:127], v[140:143], v[28:31]
    v_mfma_f32_16x16x32_bf16 v[20:23], v[120:123], v[140:143], v[20:23]
    s_waitcnt lgkmcnt(0)
    s_barrier
    v_mfma_f32_16x16x32_bf16 v[16:19], v[48:51], v[64:67], v[16:19]
    ds_read_b128 v[112:115], v12 offset:24576
    ds_read_b64_tr_b16 v[96:97], v8 offset:49152
    v_mfma_f32_16x16x32_bf16 v[24:27], v[52:55], v[64:67], v[24:27]
    ds_read_b64_tr_b16 v[98:99], v8 offset:53248
    ds_read_b128 v[116:119], v12 offset:26624
    v_mfma_f32_16x16x32_bf16 v[32:35], v[56:59], v[64:67], v[32:35]
    ds_read_b64_tr_b16 v[100:101], v9 offset:49152
    ds_read_b64_tr_b16 v[102:103], v9 offset:53248
    v_mfma_f32_16x16x32_bf16 v[40:43], v[60:63], v[64:67], v[40:43]
    ds_read_b64_tr_b16 v[104:105], v10 offset:49152
    ds_read_b64_tr_b16 v[106:107], v10 offset:53248
    v_mfma_f32_16x16x32_bf16 v[44:47], v[60:63], v[68:71], v[44:47]
    ds_read_b64_tr_b16 v[108:109], v11 offset:49152
    ds_read_b64_tr_b16 v[110:111], v11 offset:53248
    v_mfma_f32_16x16x32_bf16 v[36:39], v[56:59], v[68:71], v[36:39]
    ds_read_b128 v[136:139], v13 offset:24576
    ds_read_b64_tr_b16 v[120:121], v8 offset:57344
    v_mfma_f32_16x16x32_bf16 v[28:31], v[52:55], v[68:71], v[28:31]
    ds_read_b64_tr_b16 v[122:123], v8 offset:61440
    ds_read_b128 v[140:143], v13 offset:26624
    v_mfma_f32_16x16x32_bf16 v[20:23], v[48:51], v[68:71], v[20:23]
    ds_read_b64_tr_b16 v[124:125], v9 offset:57344
    ds_read_b64_tr_b16 v[126:127], v9 offset:61440
    v_mfma_f32_16x16x32_bf16 v[16:19], v[72:75], v[88:91], v[16:19]
    ds_read_b64_tr_b16 v[128:129], v10 offset:57344
    ds_read_b64_tr_b16 v[130:131], v10 offset:61440
    v_mfma_f32_16x16x32_bf16 v[24:27], v[76:79], v[88:91], v[24:27]
    ds_read_b64_tr_b16 v[132:133], v11 offset:57344
    ds_read_b64_tr_b16 v[134:135], v11 offset:61440
    v_xor_b32 v8, s40, v8
    v_mfma_f32_16x16x32_bf16 v[32:35], v[80:83], v[88:91], v[32:35]
    v_xor_b32 v9, s40, v9
    v_xor_b32 v10, s40, v10
    v_mfma_f32_16x16x32_bf16 v[40:43], v[84:87], v[88:91], v[40:43]
    v_xor_b32 v11, s40, v11
    v_mfma_f32_16x16x32_bf16 v[44:47], v[84:87], v[92:95], v[44:47]
    v_mfma_f32_16x16x32_bf16 v[36:39], v[80:83], v[92:95], v[36:39]
    v_mfma_f32_16x16x32_bf16 v[28:31], v[76:79], v[92:95], v[28:31]
    v_mfma_f32_16x16x32_bf16 v[20:23], v[72:75], v[92:95], v[20:23]
    s_waitcnt lgkmcnt(0)
    v_mfma_f32_16x16x32_bf16 v[16:19], v[96:99], v[112:115], v[16:19]
    v_mfma_f32_16x16x32_bf16 v[24:27], v[100:103], v[112:115], v[24:27]
    v_mfma_f32_16x16x32_bf16 v[32:35], v[104:107], v[112:115], v[32:35]
    v_mfma_f32_16x16x32_bf16 v[40:43], v[108:111], v[112:115], v[40:43]
    v_mfma_f32_16x16x32_bf16 v[44:47], v[108:111], v[116:119], v[44:47]
    v_mfma_f32_16x16x32_bf16 v[36:39], v[104:107], v[116:119], v[36:39]
    v_mfma_f32_16x16x32_bf16 v[28:31], v[100:103], v[116:119], v[28:31]
    v_mfma_f32_16x16x32_bf16 v[20:23], v[96:99], v[116:119], v[20:23]
    v_mfma_f32_16x16x32_bf16 v[16:19], v[120:123], v[136:139], v[16:19]
    v_mfma_f32_16x16x32_bf16 v[24:27], v[124:127], v[136:139], v[24:27]
    v_mfma_f32_16x16x32_bf16 v[32:35], v[128:131], v[136:139], v[32:35]
    v_mfma_f32_16x16x32_bf16 v[40:43], v[132:135], v[136:139], v[40:43]
    v_mfma_f32_16x16x32_bf16 v[44:47], v[132:135], v[140:143], v[44:47]
    v_mfma_f32_16x16x32_bf16 v[36:39], v[128:131], v[140:143], v[36:39]
    v_mfma_f32_16x16x32_bf16 v[28:31], v[124:127], v[140:143], v[28:31]
    v_mfma_f32_16x16x32_bf16 v[20:23], v[120:123], v[140:143], v[20:23]
    s_waitcnt vmcnt(4)
    v_add_f32 v160, v160, v208
    v_add_f32 v161, v161, v209
    v_add_f32 v162, v162, v210
    v_add_f32 v163, v163, v211
    v_add_f32 v164, v164, v212
    v_add_f32 v165, v165, v213
    v_add_f32 v166, v166, v214
    v_add_f32 v167, v167, v215
    v_add_f32 v168, v168, v216
    v_add_f32 v169, v169, v217
    v_add_f32 v170, v170, v218
    v_add_f32 v171, v171, v219
    v_add_f32 v172, v172, v220
    v_add_f32 v173, v173, v221
    v_add_f32 v174, v174, v222
    v_add_f32 v175, v175, v223
    v_permlane32_swap_b32 v16, v24
    v_permlane32_swap_b32 v17, v25
    v_permlane32_swap_b32 v18, v26
    v_permlane32_swap_b32 v19, v27
    v_permlane16_swap_b32 v16, v24
    v_permlane16_swap_b32 v17, v25
    v_permlane16_swap_b32 v18, v26
    v_permlane16_swap_b32 v19, v27
    s_waitcnt vmcnt(3)
    v_lshlrev_b32 v176, 16, v144
    v_and_b32 v177, 0xffff0000, v144
    v_lshlrev_b32 v178, 16, v145
    v_and_b32 v179, 0xffff0000, v145
    v_pk_fma_f32 v[16:17], v[16:17], v[160:161], v[176:177]
    v_pk_fma_f32 v[18:19], v[18:19], v[162:163], v[178:179]
    v_cvt_pk_bf16_f32 v184, v16, v17
    v_cvt_pk_bf16_f32 v185, v18, v19
    v_lshlrev_b32 v176, 16, v146
    v_and_b32 v177, 0xffff0000, v146
    v_lshlrev_b32 v178, 16, v147
    v_and_b32 v179, 0xffff0000, v147
    v_pk_fma_f32 v[24:25], v[24:25], v[164:165], v[176:177]
    v_pk_fma_f32 v[26:27], v[26:27], v[166:167], v[178:179]
    v_cvt_pk_bf16_f32 v186, v24, v25
    v_cvt_pk_bf16_f32 v187, v26, v27
    v_permlane32_swap_b32 v32, v40
    v_permlane32_swap_b32 v33, v41
    v_permlane32_swap_b32 v34, v42
    v_permlane32_swap_b32 v35, v43
    v_permlane16_swap_b32 v32, v40
    v_permlane16_swap_b32 v33, v41
    v_permlane16_swap_b32 v34, v42
    v_permlane16_swap_b32 v35, v43
    s_waitcnt vmcnt(2)
    v_lshlrev_b32 v176, 16, v148
    v_and_b32 v177, 0xffff0000, v148
    v_lshlrev_b32 v178, 16, v149
    v_and_b32 v179, 0xffff0000, v149
    v_pk_fma_f32 v[32:33], v[32:33], v[168:169], v[176:177]
    v_pk_fma_f32 v[34:35], v[34:35], v[170:171], v[178:179]
    v_cvt_pk_bf16_f32 v188, v32, v33
    v_cvt_pk_bf16_f32 v189, v34, v35
    v_lshlrev_b32 v176, 16, v150
    v_and_b32 v177, 0xffff0000, v150
    v_lshlrev_b32 v178, 16, v151
    v_and_b32 v179, 0xffff0000, v151
    v_pk_fma_f32 v[40:41], v[40:41], v[172:173], v[176:177]
    v_pk_fma_f32 v[42:43], v[42:43], v[174:175], v[178:179]
    v_cvt_pk_bf16_f32 v190, v40, v41
    v_cvt_pk_bf16_f32 v191, v42, v43
    v_mov_b32_dpp v180, v184 row_ror:8 row_mask:0xf bank_mask:0xf
    v_mov_b32_dpp v181, v185 row_ror:8 row_mask:0xf bank_mask:0xf
    v_mov_b32_dpp v182, v186 row_ror:8 row_mask:0xf bank_mask:0xf
    v_mov_b32_dpp v183, v187 row_ror:8 row_mask:0xf bank_mask:0xf
    v_mov_b32_dpp v184, v188 row_ror:8 row_mask:0xf bank_mask:0xc
    v_mov_b32_dpp v185, v189 row_ror:8 row_mask:0xf bank_mask:0xc
    v_mov_b32_dpp v186, v190 row_ror:8 row_mask:0xf bank_mask:0xc
    v_mov_b32_dpp v187, v191 row_ror:8 row_mask:0xf bank_mask:0xc
    buffer_store_dwordx4 v[184:187], v15, s[20:23], s37 offen sc1
    s_add_u32 s37, s37, 16384
    v_mov_b32_dpp v188, v180 quad_perm:[0,1,2,3] row_mask:0xf bank_mask:0x3
    v_mov_b32_dpp v189, v181 quad_perm:[0,1,2,3] row_mask:0xf bank_mask:0x3
    v_mov_b32_dpp v190, v182 quad_perm:[0,1,2,3] row_mask:0xf bank_mask:0x3
    v_mov_b32_dpp v191, v183 quad_perm:[0,1,2,3] row_mask:0xf bank_mask:0x3
    buffer_store_dwordx4 v[188:191], v15, s[20:23], s37 offen sc1
    s_add_u32 s37, s37, 16384
    v_permlane32_swap_b32 v20, v28
    v_permlane32_swap_b32 v21, v29
    v_permlane32_swap_b32 v22, v30
    v_permlane32_swap_b32 v23, v31
    v_permlane16_swap_b32 v20, v28
    v_permlane16_swap_b32 v21, v29
    v_permlane16_swap_b32 v22, v30
    v_permlane16_swap_b32 v23, v31
    s_waitcnt vmcnt(3)
    v_lshlrev_b32 v176, 16, v152
    v_and_b32 v177, 0xffff0000, v152
    v_lshlrev_b32 v178, 16, v153
    v_and_b32 v179, 0xffff0000, v153
    v_pk_fma_f32 v[20:21], v[20:21], v[160:161], v[176:177]
    v_pk_fma_f32 v[22:23], v[22:23], v[162:163], v[178:179]
    v_cvt_pk_bf16_f32 v192, v20, v21
    v_cvt_pk_bf16_f32 v193, v22, v23
    v_lshlrev_b32 v176, 16, v154
    v_and_b32 v177, 0xffff0000, v154
    v_lshlrev_b32 v178, 16, v155
    v_and_b32 v179, 0xffff0000, v155
    v_pk_fma_f32 v[28:29], v[28:29], v[164:165], v[176:177]
    v_pk_fma_f32 v[30:31], v[30:31], v[166:167], v[178:179]
    v_cvt_pk_bf16_f32 v194, v28, v29
    v_cvt_pk_bf16_f32 v195, v30, v31
    v_permlane32_swap_b32 v36, v44
    v_permlane32_swap_b32 v37, v45
    v_permlane32_swap_b32 v38, v46
    v_permlane32_swap_b32 v39, v47
    v_permlane16_swap_b32 v36, v44
    v_permlane16_swap_b32 v37, v45
    v_permlane16_swap_b32 v38, v46
    v_permlane16_swap_b32 v39, v47
    s_waitcnt vmcnt(2)
    v_lshlrev_b32 v176, 16, v156
    v_and_b32 v177, 0xffff0000, v156
    v_lshlrev_b32 v178, 16, v157
    v_and_b32 v179, 0xffff0000, v157
    v_pk_fma_f32 v[36:37], v[36:37], v[168:169], v[176:177]
    v_pk_fma_f32 v[38:39], v[38:39], v[170:171], v[178:179]
    v_cvt_pk_bf16_f32 v196, v36, v37
    v_cvt_pk_bf16_f32 v197, v38, v39
    v_lshlrev_b32 v176, 16, v158
    v_and_b32 v177, 0xffff0000, v158
    v_lshlrev_b32 v178, 16, v159
    v_and_b32 v179, 0xffff0000, v159
    v_pk_fma_f32 v[44:45], v[44:45], v[172:173], v[176:177]
    v_pk_fma_f32 v[46:47], v[46:47], v[174:175], v[178:179]
    v_cvt_pk_bf16_f32 v198, v44, v45
    v_cvt_pk_bf16_f32 v199, v46, v47
    v_mov_b32_dpp v180, v192 row_ror:8 row_mask:0xf bank_mask:0xf
    v_mov_b32_dpp v181, v193 row_ror:8 row_mask:0xf bank_mask:0xf
    v_mov_b32_dpp v182, v194 row_ror:8 row_mask:0xf bank_mask:0xf
    v_mov_b32_dpp v183, v195 row_ror:8 row_mask:0xf bank_mask:0xf
    v_mov_b32_dpp v192, v196 row_ror:8 row_mask:0xf bank_mask:0xc
    v_mov_b32_dpp v193, v197 row_ror:8 row_mask:0xf bank_mask:0xc
    v_mov_b32_dpp v194, v198 row_ror:8 row_mask:0xf bank_mask:0xc
    v_mov_b32_dpp v195, v199 row_ror:8 row_mask:0xf bank_mask:0xc
    buffer_store_dwordx4 v[192:195], v15, s[20:23], s37 offen sc1
    s_add_u32 s37, s37, 16384
    v_mov_b32_dpp v196, v180 quad_perm:[0,1,2,3] row_mask:0xf bank_mask:0x3
    v_mov_b32_dpp v197, v181 quad_perm:[0,1,2,3] row_mask:0xf bank_mask:0x3
    v_mov_b32_dpp v198, v182 quad_perm:[0,1,2,3] row_mask:0xf bank_mask:0x3
    v_mov_b32_dpp v199, v183 quad_perm:[0,1,2,3] row_mask:0xf bank_mask:0x3
    buffer_store_dwordx4 v[196:199], v15, s[20:23], s37 offen sc1
    s_add_u32 s37, s37, 16384
    s_branch L_end
L_B:
    s_load_dword s6, s[94:95], 49152
    s_cmp_lg_u32 s3, 6
    s_cbranch_scc1 L_skip_4
    s_getpc_b64 s[24:25]
L_pc_5:
    s_sub_u32 s24, s24, L_pc_5-adaLN_cond__ssm_conv_h3__mixer_gmlp__prompt_kernel
    s_subb_u32 s25, s25, 0
    s_and_b32 s25, s25, 0xffff
    s_mov_b32 s26, L_done-adaLN_cond__ssm_conv_h3__mixer_gmlp__prompt_kernel
    s_mov_b32 s27, 0x00020000
    v_mul_u32_u24 v248, 4096, v2
    s_lshl_b32 s35, s5, 7
    buffer_load_dword v249, v248, s[24:27], s35 offen
L_skip_4:
    s_cmp_lg_u32 s3, 5
    s_cbranch_scc1 L_skip_6
    s_cmp_ge_u32 s5, 28
    s_cbranch_scc1 L_skip_6
    s_mul_i32 s37, s58, 14
    s_add_u32 s37, s37, s59
    s_lshl_b32 s37, s37, 10
    s_add_u32 s37, s37, 65536
    v_lshlrev_b32 v1, 4, v2
    v_mov_b32 v16, -1
    v_mov_b32 v17, -1
    v_mov_b32 v18, -1
    v_mov_b32 v19, -1
    buffer_store_dwordx4 v[16:19], v1, s[8:11], s37 offen sc1
L_skip_6:
    s_mul_i32 s33, s4, 20
    s_add_u32 s33, s33, s5
    s_sub_u32 s40, s3, 4
    s_lshr_b32 s35, s33, 1
    s_and_b32 s47, s33, 1
    s_lshl_b32 s34, s47, 2
    s_add_u32 s34, s34, s40
    s_mov_b32 s16, s88
    s_and_b32 s17, s89, 0xffff
    s_mov_b32 s18, 12582912
    s_mov_b32 s19, 0x00020000
    s_mov_b32 s20, s86
    s_and_b32 s21, s87, 0xffff
    s_mov_b32 s22, 2048
    s_mov_b32 s23, 0x00020000
    s_lshl_b32 s36, s34, 8
    v_lshl_add_u32 v29, v2, 2, s36
    buffer_load_dword v28, v29, s[20:23], 0 offen
    s_mul_i32 s36, s34, 1572864
    s_lshl_b32 s37, s35, 7
    s_add_u32 s46, s36, s37
    v_lshrrev_b32 v20, 3, v2
    v_mul_u32_u24 v20, 12288, v20
    v_and_b32 v21, 7, v2
    v_and_b32 v22, 1, v4
    v_lshlrev_b32 v22, 1, v22
    v_xor_b32 v21, v21, v22
    v_lshl_add_u32 v20, v21, 4, v20
    v_xor_b32 v21, 64, v20
    s_lshl_b32 s41, s40, 8
    s_add_u32 s41, s41, 154624
    s_lshl_b32 s40, s40, 14
    s_add_u32 s40, s40, 70656
    s_mov_b32 s45, s35
    s_mov_b32 s99, 1
    s_cmp_lg_u32 s3, 4
    s_cbranch_scc1 L_skip_8
    s_branch L_pad_0
L_padret_0:
    s_branch L_hopped_7
L_skip_8:
    s_cmp_lg_u32 s3, 5
    s_cbranch_scc1 L_skip_9
    s_branch L_pad_1
L_padret_1:
    s_branch L_hopped_7
L_skip_9:
    s_cmp_lg_u32 s3, 6
    s_cbranch_scc1 L_skip_10
    s_branch L_hopped_7
L_skip_10:
    s_cmp_lg_u32 s3, 7
    s_cbranch_scc1 L_skip_11
    s_branch L_hopped_7
L_skip_11:
L_hopped_7:
    s_mov_b32 s99, 0
    s_waitcnt lgkmcnt(0)
    s_add_u32 s6, s6, 1
    s_waitcnt vmcnt(1)
    s_barrier
    s_sub_u32 s30, s3, 4
    s_and_b32 s49, s3, 1
    v_lshlrev_b32 v6, 1, v4
    v_xor_b32 v6, v6, v3
    s_lshl_b32 s35, s49, 5
    v_add_u32 v16, s35, v4
    s_mov_b32 s36, 7168
    v_mul_lo_u32 v5, v16, s36
    s_lshl_b32 s36, s59, 8
    s_add_u32 s36, s36, 0
    v_add_u32 v5, s36, v5
    v_xor_b32 v7, 0, v6
    v_lshl_add_u32 v7, v7, 4, v5
    v_add_u32 v120, 0, v7
    v_xor_b32 v7, 0, v6
    v_lshl_add_u32 v7, v7, 4, v5
    v_add_u32 v121, 28672, v7
    v_xor_b32 v7, 8, v6
    v_lshl_add_u32 v7, v7, 4, v5
    v_add_u32 v122, 57344, v7
    v_xor_b32 v7, 8, v6
    v_lshl_add_u32 v7, v7, 4, v5
    v_add_u32 v123, 86016, v7
    v_xor_b32 v7, 0, v6
    v_lshl_add_u32 v7, v7, 4, v5
    v_add_u32 v124, 114688, v7
    v_xor_b32 v7, 0, v6
    v_lshl_add_u32 v7, v7, 4, v5
    v_add_u32 v125, 143360, v7
    v_xor_b32 v7, 8, v6
    v_lshl_add_u32 v7, v7, 4, v5
    v_add_u32 v126, 172032, v7
    v_xor_b32 v7, 8, v6
    v_lshl_add_u32 v7, v7, 4, v5
    v_add_u32 v127, 200704, v7
    s_mov_b32 s36, 2048
    v_mul_lo_u32 v5, v16, s36
    s_lshl_b32 s36, s57, 8
    s_add_u32 s36, s36, 0
    v_add_u32 v5, s36, v5
    v_xor_b32 v7, 0, v6
    v_lshl_add_u32 v7, v7, 4, v5
    v_add_u32 v152, 0, v7
    v_xor_b32 v7, 8, v6
    v_lshl_add_u32 v7, v7, 4, v5
    v_add_u32 v153, 8192, v7
    v_xor_b32 v7, 0, v6
    v_lshl_add_u32 v7, v7, 4, v5
    v_add_u32 v154, 16384, v7
    v_xor_b32 v7, 8, v6
    v_lshl_add_u32 v7, v7, 4, v5
    v_add_u32 v155, 24576, v7
    v_xor_b32 v7, 0, v6
    v_lshl_add_u32 v7, v7, 4, v5
    v_add_u32 v156, 32768, v7
    v_xor_b32 v7, 8, v6
    v_lshl_add_u32 v7, v7, 4, v5
    v_add_u32 v157, 40960, v7
    v_xor_b32 v7, 0, v6
    v_lshl_add_u32 v7, v7, 4, v5
    v_add_u32 v158, 49152, v7
    v_xor_b32 v7, 8, v6
    v_lshl_add_u32 v7, v7, 4, v5
    v_add_u32 v159, 57344, v7
    v_lshlrev_b32 v5, 12, v16
    v_add_u32 v5, 26214400, v5
    s_lshl_b32 s36, s59, 1
    v_xor_b32 v7, 0, v6
    v_lshrrev_b32 v17, 3, v7
    v_add_u32 v17, s36, v17
    v_add_u32 v18, 4, v17
    v_mul_u32_u24 v18, 37, v18
    v_lshrrev_b32 v18, 8, v18
    v_add_u32 v17, v17, v18
    v_and_b32 v7, 7, v7
    v_lshl_add_u32 v7, v7, 4, v5
    v_lshl_add_u32 v7, v17, 7, v7
    v_add_u32 v136, 0, v7
    v_add_u32 v137, 16384, v7
    v_add_u32 v140, 65536, v7
    v_add_u32 v141, 81920, v7
    v_xor_b32 v7, 8, v6
    v_lshrrev_b32 v17, 3, v7
    v_add_u32 v17, s36, v17
    v_add_u32 v18, 4, v17
    v_mul_u32_u24 v18, 37, v18
    v_lshrrev_b32 v18, 8, v18
    v_add_u32 v17, v17, v18
    v_and_b32 v7, 7, v7
    v_lshl_add_u32 v7, v7, 4, v5
    v_lshl_add_u32 v7, v17, 7, v7
    v_add_u32 v138, 32768, v7
    v_add_u32 v139, 49152, v7
    v_add_u32 v142, 98304, v7
    v_add_u32 v143, 114688, v7
    v_and_b32 v6, 7, v2
    v_xor_b32 v6, v6, v4
    v_lshrrev_b32 v16, 3, v2
    s_mul_i32 s35, s58, 128
    s_mul_i32 s36, s49, 64
    s_add_u32 s35, s35, s36
    v_add_u32 v5, s35, v16
    s_mov_b32 s36, 4096
    v_mul_lo_u32 v5, v5, s36
    v_add_u32 v5, 17825792, v5
    v_xor_b32 v7, 0, v6
    v_lshl_add_u32 v7, v7, 4, v5
    v_add_u32 v128, 0, v7
    v_xor_b32 v7, 4, v6
    v_lshl_add_u32 v7, v7, 4, v5
    v_add_u32 v129, 32768, v7
    v_xor_b32 v7, 0, v6
    v_lshl_add_u32 v7, v7, 4, v5
    v_add_u32 v130, 65536, v7
    v_xor_b32 v7, 4, v6
    v_lshl_add_u32 v7, v7, 4, v5
    v_add_u32 v131, 98304, v7
    v_xor_b32 v7, 0, v6
    v_lshl_add_u32 v7, v7, 4, v5
    v_add_u32 v132, 131072, v7
    v_xor_b32 v7, 4, v6
    v_lshl_add_u32 v7, v7, 4, v5
    v_add_u32 v133, 163840, v7
    v_xor_b32 v7, 0, v6
    v_lshl_add_u32 v7, v7, 4, v5
    v_add_u32 v134, 196608, v7
    v_xor_b32 v7, 4, v6
    v_lshl_add_u32 v7, v7, 4, v5
    v_add_u32 v135, 229376, v7
    s_mul_i32 s35, s58, 128
    s_mul_i32 s36, s49, 64
    s_add_u32 s35, s35, s36
    v_add_u32 v5, s35, v16
    s_mov_b32 s36, 4096
    v_mul_lo_u32 v5, v5, s36
    v_add_u32 v5, 0, v5
    v_xor_b32 v7, 0, v6
    v_lshl_add_u32 v7, v7, 4, v5
    v_add_u32 v144, 0, v7
    v_xor_b32 v7, 4, v6
    v_lshl_add_u32 v7, v7, 4, v5
    v_add_u32 v145, 32768, v7
    v_xor_b32 v7, 0, v6
    v_lshl_add_u32 v7, v7, 4, v5
    v_add_u32 v146, 65536, v7
    v_xor_b32 v7, 4, v6
    v_lshl_add_u32 v7, v7, 4, v5
    v_add_u32 v147, 98304, v7
    v_xor_b32 v7, 0, v6
    v_lshl_add_u32 v7, v7, 4, v5
    v_add_u32 v148, 131072, v7
    v_xor_b32 v7, 4, v6
    v_lshl_add_u32 v7, v7, 4, v5
    v_add_u32 v149, 163840, v7
    v_xor_b32 v7, 0, v6
    v_lshl_add_u32 v7, v7, 4, v5
    v_add_u32 v150, 196608, v7
    v_xor_b32 v7, 4, v6
    v_lshl_add_u32 v7, v7, 4, v5
    v_add_u32 v151, 229376, v7
    s_mul_i32 s35, s56, 64
    s_mul_i32 s36, s49, 32
    s_add_u32 s35, s35, s36
    v_add_u32 v5, s35, v16
    s_mov_b32 s36, 4096
    v_mul_lo_u32 v5, v5, s36
    v_add_u32 v5, 34603008, v5
    v_xor_b32 v7, 0, v6
    v_lshl_add_u32 v7, v7, 4, v5
    v_add_u32 v160, 0, v7
    v_xor_b32 v7, 4, v6
    v_lshl_add_u32 v7, v7, 4, v5
    v_add_u32 v161, 32768, v7
    v_xor_b32 v7, 0, v6
    v_lshl_add_u32 v7, v7, 4, v5
    v_add_u32 v162, 65536, v7
    v_xor_b32 v7, 4, v6
    v_lshl_add_u32 v7, v7, 4, v5
    v_add_u32 v163, 98304, v7
    s_waitcnt vmcnt(0)
    v_lshlrev_b32 v22, 16, v28
    v_and_b32 v23, 0xffff0000, v28
    v_mul_f32 v24, 0xbfb8aa3b, v22
    v_mul_f32 v25, 0xbfb8aa3b, v23
    v_exp_f32 v24, v24
    v_exp_f32 v25, v25
    v_add_f32 v24, 1.0, v24
    v_add_f32 v25, 1.0, v25
    v_rcp_f32 v24, v24
    v_rcp_f32 v25, v25
    v_mul_f32 v22, v22, v24
    v_mul_f32 v23, v23, v25
    v_cvt_pk_bf16_f32 v22, v22, v23
    v_lshl_add_u32 v23, v2, 2, s41
    ds_write_b32 v23, v22
    v_lshl_add_u32 v23, v4, 4, s41
    s_waitcnt lgkmcnt(0)
    ds_read_b128 v[208:211], v23 offset:0
    ds_read_b128 v[212:215], v23 offset:64
    ds_read_b128 v[216:219], v23 offset:128
    ds_read_b128 v[220:223], v23 offset:192
    v_bfe_u32 v24, v2, 2, 2
    v_and_b32 v25, 3, v2
    v_lshl_add_u32 v26, v4, 3, v24
    v_lshlrev_b32 v26, 7, v26
    v_lshl_add_u32 v26, v25, 3, v26
    v_add_u32 v26, s40, v26
    v_lshrrev_b32 v24, 1, v24
    v_and_b32 v25, 1, v4
    v_lshl_or_b32 v24, v25, 1, v24
    v_xor_b32 v25, 0, v24
    v_lshl_add_u32 v224, v25, 5, v26
    v_xor_b32 v25, 1, v24
    v_lshl_add_u32 v225, v25, 5, v26
    v_xor_b32 v25, 2, v24
    v_lshl_add_u32 v226, v25, 5, v26
    v_xor_b32 v25, 3, v24
    v_lshl_add_u32 v227, v25, 5, v26
    s_waitcnt lgkmcnt(0)
    s_barrier
    s_cmp_lg_u32 s3, 7
    s_cbranch_scc1 L_skip_12
    s_lshl_b32 s60, s7, 7
    s_add_u32 s60, s60, 327680
    v_mov_b32 v250, s6
    v_mov_b32 v251, 0
    s_mov_b64 exec, 1
    buffer_store_dword v250, v251, s[8:11], s60 offen sc1
    s_mov_b64 exec, -1
L_skip_12:
    s_mov_b32 s12, s72
    s_and_b32 s13, s73, 0xffff
    s_mov_b32 s14, 4194304
    s_mov_b32 s15, 0x00020000
    s_sub_u32 s30, s3, 4
    s_lshl_b32 s33, s7, 2
    s_add_u32 s33, s33, s30
    s_mul_i32 s34, s30, 17664
    s_lshl_b32 s36, s33, 12
    v_lshlrev_b32 v5, 4, v2
    v_mov_b32 v6, s36
    buffer_load_dword v8, v6, s[12:15], 0 offen
    s_add_u32 m0, s34, 9280
    s_add_u32 s37, s36, 0
    buffer_load_dwordx4 v5, s[12:15], s37 offen nt lds
    s_add_u32 m0, s34, 13504
    s_add_u32 s37, s36, 4
    buffer_load_dwordx4 v5, s[12:15], s37 offen nt lds
    s_add_u32 m0, s34, 10304
    s_add_u32 s37, s36, 1024
    buffer_load_dwordx4 v5, s[12:15], s37 offen nt lds
    s_add_u32 m0, s34, 14528
    s_add_u32 s37, s36, 1028
    buffer_load_dwordx4 v5, s[12:15], s37 offen nt lds
    s_add_u32 m0, s34, 11328
    s_add_u32 s37, s36, 2048
    buffer_load_dwordx4 v5, s[12:15], s37 offen nt lds
    s_add_u32 m0, s34, 15552
    s_add_u32 s37, s36, 2052
    buffer_load_dwordx4 v5, s[12:15], s37 offen nt lds
    s_add_u32 m0, s34, 12352
    s_add_u32 s37, s36, 3072
    buffer_load_dwordx4 v5, s[12:15], s37 offen nt lds
    s_add_u32 m0, s34, 16576
    s_add_u32 s37, s36, 3076
    buffer_load_dwordx4 v5, s[12:15], s37 offen nt lds
    v_and_b32 v10, 31, v2
    v_min_u32 v10, 27, v10
    v_lshlrev_b32 v10, 4, v10
    v_lshrrev_b32 v11, 5, v2
    v_mul_u32_u24 v11, 4576, v11
    v_add3_u32 v10, v10, v11, s34
    v_mov_b32 v12, 0
    v_mov_b32 v13, 0
    v_mov_b32 v14, 0
    v_mov_b32 v15, 0
    ds_write_b128 v10, v[12:15] offset:4096
    v_mov_b32 v10, 156416
    ds_write_b64 v10, v[12:13]
    v_and_b32 v10, 1, v4
    v_mul_u32_u24 v10, 4224, v10
    v_lshl_add_u32 v10, v3, 2, v10
    v_add_u32 v10, s34, v10
    v_and_b32 v11, 31, v2
    s_cmp_lg_u32 s3, 7
    s_cbranch_scc1 L_skip_13
    s_andn2_b32 s37, s7, 15
    s_lshl_b32 s60, s37, 7
    s_add_u32 s60, s60, 327680
    v_min_u32 v250, 15, v2
    v_lshlrev_b32 v250, 7, v250
    s_mov_b32 s61, 0
L_poll_14:
    buffer_load_dword v251, v250, s[8:11], s60 offen sc1
    s_add_u32 s61, s61, 1
    s_cmp_gt_u32 s61, 30000
    s_cbranch_scc1 L_go_15
    s_waitcnt vmcnt(0)
    v_xor_b32 v251, s6, v251
    v_cmp_ne_u32 vcc, 0, v251
    s_cbranch_vccnz L_poll_14
L_go_15:
    s_waitcnt vmcnt(0)
L_skip_13:
    v_cmp_eq_u32 vcc, 31, v11
    s_waitcnt vmcnt(0)
    s_nop 0
    v_cndmask_b32 v8, 0, v8, vcc
    ds_write_b32 v10, v8 offset:9216
    s_waitcnt lgkmcnt(0)
    s_barrier
    s_barrier
    s_cmp_ge_u32 s5, 20
    s_cbranch_scc1 L_gp_16
    s_cmp_lt_u32 s3, 4
    s_cbranch_scc1 L_gp_16
    s_cmp_ge_u32 s3, 8
    s_cbranch_scc1 L_gp_16
    s_add_u32 m0, s40, 0
    s_nop 0
    buffer_load_dwordx4 v20, s[16:19], s46 offen nt lds
    s_add_u32 s46, s46, 98304
    s_add_u32 m0, s40, 1024
    s_nop 0
    buffer_load_dwordx4 v21, s[16:19], s46 offen nt lds
    s_add_u32 s46, s46, 98304
    s_add_u32 m0, s40, 2048
    s_nop 0
    buffer_load_dwordx4 v20, s[16:19], s46 offen nt lds
    s_add_u32 s46, s46, 98304
    s_add_u32 m0, s40, 3072
    s_nop 0
    buffer_load_dwordx4 v21, s[16:19], s46 offen nt lds
    s_add_u32 s46, s46, 98304
    s_add_u32 m0, s40, 4096
    s_nop 0
    buffer_load_dwordx4 v20, s[16:19], s46 offen nt lds
    s_add_u32 s46, s46, 98304
    s_add_u32 m0, s40, 5120
    s_nop 0
    buffer_load_dwordx4 v21, s[16:19], s46 offen nt lds
    s_add_u32 s46, s46, 98304
    s_add_u32 m0, s40, 6144
    s_nop 0
    buffer_load_dwordx4 v20, s[16:19], s46 offen nt lds
    s_add_u32 s46, s46, 98304
    s_add_u32 m0, s40, 7168
    s_nop 0
    buffer_load_dwordx4 v21, s[16:19], s46 offen nt lds
    s_add_u32 s46, s46, 98304
    s_add_u32 m0, s40, 8192
    s_nop 0
    buffer_load_dwordx4 v20, s[16:19], s46 offen nt lds
    s_add_u32 s46, s46, 98304
    s_add_u32 m0, s40, 9216
    s_nop 0
    buffer_load_dwordx4 v21, s[16:19], s46 offen nt lds
    s_add_u32 s46, s46, 98304
    s_add_u32 m0, s40, 10240
    s_nop 0
    buffer_load_dwordx4 v20, s[16:19], s46 offen nt lds
    s_add_u32 s46, s46, 98304
    s_add_u32 m0, s40, 11264
    s_nop 0
    buffer_load_dwordx4 v21, s[16:19], s46 offen nt lds
    s_add_u32 s46, s46, 98304
    s_add_u32 m0, s40, 12288
    s_nop 0
    buffer_load_dwordx4 v20, s[16:19], s46 offen nt lds
    s_add_u32 s46, s46, 98304
    s_add_u32 m0, s40, 13312
    s_nop 0
L_pad_10:
    s_cmp_eq_u32 s99, 1
    s_cbranch_scc1 L_padret_10
    buffer_load_dwordx4 v21, s[16:19], s46 offen nt lds
    s_add_u32 s46, s46, 98304
    s_add_u32 m0, s40, 14336
    s_nop 0
    buffer_load_dwordx4 v20, s[16:19], s46 offen nt lds
    s_add_u32 s46, s46, 98304
    s_add_u32 m0, s40, 15360
    s_nop 0
    buffer_load_dwordx4 v21, s[16:19], s46 offen nt lds
    s_add_u32 s46, s46, 98304
L_gp_16:
    s_mov_b32 s24, s64
    s_and_b32 s25, s65, 0xffff
    s_mov_b32 s26, 4194304
    s_mov_b32 s27, 0x00020000
    v_and_b32 v6, 255, v0
    v_lshlrev_b32 v1, 3, v6
    s_lshl_b32 s32, s7, 14
    s_add_u32 s38, s32, 0
    buffer_load_dwordx2 v[164:165], v1, s[24:27], s38 offen offset:0 nt
    buffer_load_dwordx2 v[166:167], v1, s[24:27], s38 offen offset:2048 nt
    s_add_u32 s38, s32, 4096
    buffer_load_dwordx2 v[168:169], v1, s[24:27], s38 offen offset:0 nt
    buffer_load_dwordx2 v[170:171], v1, s[24:27], s38 offen offset:2048 nt
    s_add_u32 s38, s32, 8192
    buffer_load_dwordx2 v[172:173], v1, s[24:27], s38 offen offset:0 nt
    buffer_load_dwordx2 v[174:175], v1, s[24:27], s38 offen offset:2048 nt
    s_add_u32 s38, s32, 12288
    buffer_load_dwordx2 v[176:177], v1, s[24:27], s38 offen offset:0 nt
    buffer_load_dwordx2 v[178:179], v1, s[24:27], s38 offen offset:2048 nt
    s_mov_b32 s12, s78
    s_and_b32 s13, s79, 0xffff
    s_mov_b32 s14, 7340032
    s_mov_b32 s15, 0x00020000
    s_sub_u32 s30, s3, 4
    s_mul_i32 s33, s2, 28672
    s_mul_i32 s39, s30, 7168
    s_add_u32 s33, s33, s39
    s_add_u32 s33, s33, 3584
    v_min_u32 v7, 27, v2
    v_lshlrev_b32 v7, 7, v7
    buffer_load_dword v204, v7, s[12:15], s33 offen
    v_lshlrev_b32 v200, 4, v6
    v_bfe_u32 v201, v6, 2, 2
    v_lshlrev_b32 v6, 6, v6
    v_add_u32 v6, 16384, v6
    v_xor_b32 v7, 0, v201
    v_lshl_add_u32 v116, v7, 4, v6
    v_xor_b32 v7, 1, v201
    v_lshl_add_u32 v117, v7, 4, v6
    v_xor_b32 v7, 2, v201
    v_lshl_add_u32 v118, v7, 4, v6
    v_xor_b32 v7, 3, v201
    v_lshl_add_u32 v119, v7, 4, v6
    s_lshl_b32 s37, s30, 2
    s_add_u32 s37, s37, 155648
    v_and_b32 v202, 1, v4
    v_lshrrev_b32 v203, 1, v4
    v_lshl_or_b32 v202, v202, 1, v203
    v_lshl_add_u32 v202, v202, 5, s37
    v_and_b32 v203, 7, v2
    v_lshlrev_b32 v203, 5, v203
    v_add_u32 v203, 155648, v203
    v_xor_b32 v201, v2, v4
    v_lshlrev_b32 v201, 5, v201
    s_mov_b32 s99, 1
    s_cmp_lg_u32 s3, 4
    s_cbranch_scc1 L_skip_19
    s_branch L_pad_10
L_padret_10:
    s_branch L_pad_11
L_padret_11:
    s_branch L_hopped_18
L_skip_19:
    s_cmp_lg_u32 s3, 5
    s_cbranch_scc1 L_skip_20
    s_branch L_pad_12
L_padret_12:
    s_branch L_pad_13
L_padret_13:
    s_branch L_hopped_18
L_skip_20:
    s_cmp_lg_u32 s3, 6
    s_cbranch_scc1 L_skip_21
    s_branch L_pad_14
L_padret_14:
    s_branch L_pad_15
L_padret_15:
    s_branch L_hopped_18
L_skip_21:
    s_cmp_lg_u32 s3, 7
    s_cbranch_scc1 L_skip_22
    s_branch L_hopped_18
L_skip_22:
L_hopped_18:
    s_mov_b32 s99, 0
    s_cmp_ge_u32 s5, 20
    s_cbranch_scc1 L_nogemv_23
    s_waitcnt vmcnt(9)
    ds_read_b64_tr_b16 v[64:65], v224 offset:0
    ds_read_b64_tr_b16 v[66:67], v224 offset:512
    ds_read_b64_tr_b16 v[68:69], v225 offset:0
    ds_read_b64_tr_b16 v[70:71], v225 offset:512
    ds_read_b64_tr_b16 v[72:73], v226 offset:0
    ds_read_b64_tr_b16 v[74:75], v226 offset:512
    ds_read_b64_tr_b16 v[76:77], v227 offset:0
    ds_read_b64_tr_b16 v[78:79], v227 offset:512
    s_waitcnt lgkmcnt(4)
    ds_read_b64_tr_b16 v[80:81], v224 offset:4096
    ds_read_b64_tr_b16 v[82:83], v224 offset:4608
    ds_read_b64_tr_b16 v[84:85], v225 offset:4096
    ds_read_b64_tr_b16 v[86:87], v225 offset:4608
    ds_read_b64_tr_b16 v[88:89], v226 offset:4096
    ds_read_b64_tr_b16 v[90:91], v226 offset:4608
    ds_read_b64_tr_b16 v[92:93], v227 offset:4096
    ds_read_b64_tr_b16 v[94:95], v227 offset:4608
    s_waitcnt lgkmcnt(0)
    v_mfma_f32_16x16x32_bf16 v[228:231], v[208:211], v[64:67], 0
    v_mfma_f32_16x16x32_bf16 v[232:235], v[208:211], v[68:71], 0
    v_mfma_f32_16x16x32_bf16 v[236:239], v[208:211], v[72:75], 0
    v_mfma_f32_16x16x32_bf16 v[240:243], v[208:211], v[76:79], 0
    v_mfma_f32_16x16x32_bf16 v[228:231], v[212:215], v[80:83], v[228:231]
    v_mfma_f32_16x16x32_bf16 v[232:235], v[212:215], v[84:87], v[232:235]
    v_mfma_f32_16x16x32_bf16 v[236:239], v[212:215], v[88:91], v[236:239]
    v_mfma_f32_16x16x32_bf16 v[240:243], v[212:215], v[92:95], v[240:243]
    ds_read_b64_tr_b16 v[64:65], v224 offset:8192
    ds_read_b64_tr_b16 v[66:67], v224 offset:8704
    ds_read_b64_tr_b16 v[68:69], v225 offset:8192
    ds_read_b64_tr_b16 v[70:71], v225 offset:8704
    ds_read_b64_tr_b16 v[72:73], v226 offset:8192
    ds_read_b64_tr_b16 v[74:75], v226 offset:8704
    ds_read_b64_tr_b16 v[76:77], v227 offset:8192
    ds_read_b64_tr_b16 v[78:79], v227 offset:8704
    s_waitcnt lgkmcnt(4)
    ds_read_b64_tr_b16 v[80:81], v224 offset:12288
    ds_read_b64_tr_b16 v[82:83], v224 offset:12800
    ds_read_b64_tr_b16 v[84:85], v225 offset:12288
    ds_read_b64_tr_b16 v[86:87], v225 offset:12800
    ds_read_b64_tr_b16 v[88:89], v226 offset:12288
    ds_read_b64_tr_b16 v[90:91], v226 offset:12800
    ds_read_b64_tr_b16 v[92:93], v227 offset:12288
    ds_read_b64_tr_b16 v[94:95], v227 offset:12800
    s_waitcnt lgkmcnt(0)
    v_mfma_f32_16x16x32_bf16 v[228:231], v[216:219], v[64:67], v[228:231]
    v_mfma_f32_16x16x32_bf16 v[232:235], v[216:219], v[68:71], v[232:235]
    v_mfma_f32_16x16x32_bf16 v[236:239], v[216:219], v[72:75], v[236:239]
    v_mfma_f32_16x16x32_bf16 v[240:243], v[216:219], v[76:79], v[240:243]
    v_mfma_f32_16x16x32_bf16 v[228:231], v[220:223], v[80:83], v[228:231]
    v_mfma_f32_16x16x32_bf16 v[232:235], v[220:223], v[84:87], v[232:235]
    v_mfma_f32_16x16x32_bf16 v[236:239], v[220:223], v[88:91], v[236:239]
    v_mfma_f32_16x16x32_bf16 v[240:243], v[220:223], v[92:95], v[240:243]
    v_cmp_eq_u32 vcc, 1, v4
    s_nop 4
    v_cndmask_b32 v228, v228, v232, vcc
    v_cmp_eq_u32 vcc, 2, v4
    s_nop 1
    v_cndmask_b32 v228, v228, v236, vcc
    v_cmp_eq_u32 vcc, 3, v4
    s_nop 1
    v_cndmask_b32 v228, v228, v240, vcc
    v_lshl_add_u32 v23, v2, 2, s41
    ds_write_b32 v23, v228
    s_waitcnt lgkmcnt(0)
    v_mov_b32 v7, 156420
    v_mov_b32 v6, 1
    s_mov_b64 exec, 1
    ds_add_u32 v7, v6
    s_mov_b64 exec, -1
    s_mov_b32 s39, 0
L_spin_24:
    ds_read_b32 v6, v7
    s_add_u32 s39, s39, 1
    s_cmp_gt_u32 s39, 200000
    s_cbranch_scc1 L_spun_25
    s_waitcnt lgkmcnt(0)
    v_cmp_ne_u32 vcc, 4, v6
    s_cbranch_vccnz L_spin_24
L_spun_25:
    s_cmp_lg_u32 s3, 4
    s_cbranch_scc1 L_nogemv_23
    v_lshl_add_u32 v23, v2, 2, s41
    ds_read_b32 v24, v23 offset:0
    ds_read_b32 v25, v23 offset:256
    ds_read_b32 v26, v23 offset:512
    ds_read_b32 v27, v23 offset:768
    s_mul_i32 s37, s47, 24576
    s_lshl_b32 s38, s45, 8
    s_add_u32 s37, s37, s38
    v_lshlrev_b32 v23, 2, v2
    s_waitcnt lgkmcnt(0)
    v_add_f32 v24, v24, v25
    v_add_f32 v26, v26, v27
    v_add_f32 v24, v24, v26
    buffer_store_dword v24, v23, s[8:11], s37 offen sc1
L_nogemv_23:
    s_mov_b32 s16, s80
    s_and_b32 s17, s81, 0xffff
    s_mov_b32 s18, 8388608
    s_mov_b32 s19, 0x00020000
    s_mov_b32 s24, s78
    s_and_b32 s25, s79, 0xffff
    s_mov_b32 s26, 7340032
    s_mov_b32 s27, 0x00020000
    s_mov_b32 s20, s84
    s_and_b32 s21, s85, 0xffff
    s_mov_b32 s22, 3670016
    s_mov_b32 s23, 0x00020000
    s_waitcnt vmcnt(0)
    s_barrier
    s_cmp_lg_u32 s3, 7
    s_cbranch_scc1 L_skip_26
    s_lshl_b32 s60, s2, 7
    s_add_u32 s60, s60, 360448
    v_mov_b32 v250, s6
    v_mov_b32 v251, 0
    s_mov_b64 exec, 1
    buffer_store_dword v250, v251, s[8:11], s60 offen sc1
    s_mov_b64 exec, -1
L_skip_26:
    s_cmp_ge_u32 s3, 6
    s_cbranch_scc1 L_nopre_27
    s_cmp_ge_u32 s5, 28
    s_cbranch_scc1 L_nopre_27
    s_mul_i32 s50, s30, 8192
    s_mov_b32 s51, 3584
    s_add_u32 m0, s50, 0
    s_nop 0
    buffer_load_dwordx4 v120, s[12:15], s51 offen  lds
    s_add_u32 m0, s50, 1024
    s_nop 0
    buffer_load_dwordx4 v121, s[12:15], s51 offen  lds
    s_add_u32 m0, s50, 2048
    s_nop 0
    buffer_load_dwordx4 v122, s[12:15], s51 offen  lds
    s_add_u32 m0, s50, 3072
    s_nop 0
    buffer_load_dwordx4 v123, s[12:15], s51 offen  lds
    s_add_u32 m0, s50, 4096
    s_nop 0
    buffer_load_dwordx4 v124, s[12:15], s51 offen  lds
    s_add_u32 m0, s50, 5120
    s_nop 0
    buffer_load_dwordx4 v125, s[12:15], s51 offen  lds
    s_add_u32 m0, s50, 6144
    s_nop 0
    buffer_load_dwordx4 v126, s[12:15], s51 offen  lds
    s_add_u32 m0, s50, 7168
    s_nop 0
    buffer_load_dwordx4 v127, s[12:15], s51 offen  lds
    s_mul_i32 s50, s30, 8192
    s_mov_b32 s51, 462336
    s_add_u32 m0, s50, 32768
    s_nop 0
    buffer_load_dwordx4 v120, s[12:15], s51 offen  lds
    s_add_u32 m0, s50, 33792
    s_nop 0
    buffer_load_dwordx4 v121, s[12:15], s51 offen  lds
    s_add_u32 m0, s50, 34816
    s_nop 0
    buffer_load_dwordx4 v122, s[12:15], s51 offen  lds
    s_add_u32 m0, s50, 35840
    s_nop 0
    buffer_load_dwordx4 v123, s[12:15], s51 offen  lds
    s_add_u32 m0, s50, 36864
    s_nop 0
    buffer_load_dwordx4 v124, s[12:15], s51 offen  lds
    s_add_u32 m0, s50, 37888
    s_nop 0
    buffer_load_dwordx4 v125, s[12:15], s51 offen  lds
    s_add_u32 m0, s50, 38912
    s_nop 0
    buffer_load_dwordx4 v126, s[12:15], s51 offen  lds
    s_add_u32 m0, s50, 39936
    s_nop 0
    buffer_load_dwordx4 v127, s[12:15], s51 offen  lds
    s_mul_i32 s50, s30, 8192
    s_mov_b32 s51, 921088
    s_add_u32 m0, s50, 65536
    s_nop 0
    buffer_load_dwordx4 v120, s[12:15], s51 offen  lds
    s_add_u32 m0, s50, 66560
    s_nop 0
    buffer_load_dwordx4 v121, s[12:15], s51 offen  lds
    s_add_u32 m0, s50, 67584
    s_nop 0
    buffer_load_dwordx4 v122, s[12:15], s51 offen  lds
    s_add_u32 m0, s50, 68608
    s_nop 0
    buffer_load_dwordx4 v123, s[12:15], s51 offen  lds
    s_add_u32 m0, s50, 69632
    s_nop 0
    buffer_load_dwordx4 v124, s[12:15], s51 offen  lds
    s_add_u32 m0, s50, 70656
    s_nop 0
    buffer_load_dwordx4 v125, s[12:15], s51 offen  lds
    s_add_u32 m0, s50, 71680
    s_nop 0
    buffer_load_dwordx4 v126, s[12:15], s51 offen  lds
    s_add_u32 m0, s50, 72704
    s_nop 0
    buffer_load_dwordx4 v127, s[12:15], s51 offen  lds
    s_mul_i32 s50, s30, 8192
    s_mov_b32 s51, 1379840
    s_add_u32 m0, s50, 98304
    s_nop 0
    buffer_load_dwordx4 v120, s[12:15], s51 offen  lds
    s_add_u32 m0, s50, 99328
    s_nop 0
    buffer_load_dwordx4 v121, s[12:15], s51 offen  lds
    s_add_u32 m0, s50, 100352
    s_nop 0
    buffer_load_dwordx4 v122, s[12:15], s51 offen  lds
    s_add_u32 m0, s50, 101376
    s_nop 0
    buffer_load_dwordx4 v123, s[12:15], s51 offen  lds
    s_add_u32 m0, s50, 102400
    s_nop 0
    buffer_load_dwordx4 v124, s[12:15], s51 offen  lds
    s_add_u32 m0, s50, 103424
    s_nop 0
    buffer_load_dwordx4 v125, s[12:15], s51 offen  lds
    s_add_u32 m0, s50, 104448
    s_nop 0
    buffer_load_dwordx4 v126, s[12:15], s51 offen  lds
    s_add_u32 m0, s50, 105472
    s_nop 0
    buffer_load_dwordx4 v127, s[12:15], s51 offen  lds
L_nopre_27:
    v_lshlrev_b32 v32, 16, v164
    v_and_b32 v33, 0xffff0000, v164
    v_lshlrev_b32 v34, 16, v165
    v_and_b32 v35, 0xffff0000, v165
    v_lshlrev_b32 v36, 16, v166
    v_and_b32 v37, 0xffff0000, v166
    v_lshlrev_b32 v38, 16, v167
    v_and_b32 v39, 0xffff0000, v167
    v_lshlrev_b32 v40, 16, v168
    v_and_b32 v41, 0xffff0000, v168
    v_lshlrev_b32 v42, 16, v169
    v_and_b32 v43, 0xffff0000, v169
    v_lshlrev_b32 v44, 16, v170
    v_and_b32 v45, 0xffff0000, v170
    v_lshlrev_b32 v46, 16, v171
    v_and_b32 v47, 0xffff0000, v171
    v_lshlrev_b32 v48, 16, v172
    v_and_b32 v49, 0xffff0000, v172
    v_lshlrev_b32 v50, 16, v173
    v_and_b32 v51, 0xffff0000, v173
    v_lshlrev_b32 v52, 16, v174
    v_and_b32 v53, 0xffff0000, v174
    v_lshlrev_b32 v54, 16, v175
    v_and_b32 v55, 0xffff0000, v175
    v_lshlrev_b32 v56, 16, v176
    v_and_b32 v57, 0xffff0000, v176
    v_lshlrev_b32 v58, 16, v177
    v_and_b32 v59, 0xffff0000, v177
    v_lshlrev_b32 v60, 16, v178
    v_and_b32 v61, 0xffff0000, v178
    v_lshlrev_b32 v62, 16, v179
    v_and_b32 v63, 0xffff0000, v179
    v_pk_add_f32 v[112:113], v[32:33], v[34:35]
    v_pk_mul_f32 v[114:115], v[32:33], v[32:33]
    v_pk_fma_f32 v[114:115], v[34:35], v[34:35], v[114:115]
    v_add_f32 v96, v112, v113
    v_add_f32 v104, v114, v115
    v_pk_add_f32 v[112:113], v[36:37], v[38:39]
    v_pk_mul_f32 v[114:115], v[36:37], v[36:37]
    v_pk_fma_f32 v[114:115], v[38:39], v[38:39], v[114:115]
    v_add_f32 v97, v112, v113
    v_add_f32 v105, v114, v115
    v_pk_add_f32 v[112:113], v[40:41], v[42:43]
    v_pk_mul_f32 v[114:115], v[40:41], v[40:41]
    v_pk_fma_f32 v[114:115], v[42:43], v[42:43], v[114:115]
    v_add_f32 v98, v112, v113
    v_add_f32 v106, v114, v115
    v_pk_add_f32 v[112:113], v[44:45], v[46:47]
    v_pk_mul_f32 v[114:115], v[44:45], v[44:45]
    v_pk_fma_f32 v[114:115], v[46:47], v[46:47], v[114:115]
    v_add_f32 v99, v112, v113
    v_add_f32 v107, v114, v115
    v_pk_add_f32 v[112:113], v[48:49], v[50:51]
    v_pk_mul_f32 v[114:115], v[48:49], v[48:49]
    v_pk_fma_f32 v[114:115], v[50:51], v[50:51], v[114:115]
    v_add_f32 v100, v112, v113
    v_add_f32 v108, v114, v115
    v_pk_add_f32 v[112:113], v[52:53], v[54:55]
    v_pk_mul_f32 v[114:115], v[52:53], v[52:53]
    v_pk_fma_f32 v[114:115], v[54:55], v[54:55], v[114:115]
    v_add_f32 v101, v112, v113
    v_add_f32 v109, v114, v115
    v_pk_add_f32 v[112:113], v[56:57], v[58:59]
    v_pk_mul_f32 v[114:115], v[56:57], v[56:57]
    v_pk_fma_f32 v[114:115], v[58:59], v[58:59], v[114:115]
    v_add_f32 v102, v112, v113
    v_add_f32 v110, v114, v115
    v_pk_add_f32 v[112:113], v[60:61], v[62:63]
    v_pk_mul_f32 v[114:115], v[60:61], v[60:61]
    v_pk_fma_f32 v[114:115], v[62:63], v[62:63], v[114:115]
    v_add_f32 v103, v112, v113
    v_add_f32 v111, v114, v115
    v_permlane32_swap_b32 v96, v97
    v_permlane32_swap_b32 v98, v99
    v_permlane32_swap_b32 v100, v101
    v_permlane32_swap_b32 v102, v103
    v_permlane32_swap_b32 v104, v105
    v_permlane32_swap_b32 v106, v107
    v_permlane32_swap_b32 v108, v109
    v_permlane32_swap_b32 v110, v111
    v_add_f32 v96, v96, v97
    v_add_f32 v98, v98, v99
    v_add_f32 v100, v100, v101
    v_add_f32 v102, v102, v103
    v_add_f32 v104, v104, v105
    v_add_f32 v106, v106, v107
    v_add_f32 v108, v108, v109
    v_add_f32 v110, v110, v111
    v_permlane16_swap_b32 v96, v98
    v_permlane16_swap_b32 v100, v102
    v_permlane16_swap_b32 v104, v106
    v_permlane16_swap_b32 v108, v110
    v_add_f32 v96, v96, v98
    v_add_f32 v100, v100, v102
    v_add_f32 v104, v104, v106
    v_add_f32 v108, v108, v110
    v_add_f32_dpp v96, v96, v96 row_ror:8 row_mask:0xf bank_mask:0xf
    v_add_f32_dpp v100, v100, v100 row_ror:8 row_mask:0xf bank_mask:0xf
    v_add_f32_dpp v104, v104, v104 row_ror:8 row_mask:0xf bank_mask:0xf
    v_add_f32_dpp v108, v108, v108 row_ror:8 row_mask:0xf bank_mask:0xf
    v_add_f32_dpp v96, v96, v96 row_ror:4 row_mask:0xf bank_mask:0xf
    v_add_f32_dpp v100, v100, v100 row_ror:4 row_mask:0xf bank_mask:0xf
    v_add_f32_dpp v104, v104, v104 row_ror:4 row_mask:0xf bank_mask:0xf
    v_add_f32_dpp v108, v108, v108 row_ror:4 row_mask:0xf bank_mask:0xf
    v_add_f32_dpp v96, v96, v96 row_ror:2 row_mask:0xf bank_mask:0xf
    v_add_f32_dpp v100, v100, v100 row_ror:2 row_mask:0xf bank_mask:0xf
    v_add_f32_dpp v104, v104, v104 row_ror:2 row_mask:0xf bank_mask:0xf
    v_add_f32_dpp v108, v108, v108 row_ror:2 row_mask:0xf bank_mask:0xf
    v_add_f32_dpp v96, v96, v96 row_ror:1 row_mask:0xf bank_mask:0xf
    v_add_f32_dpp v100, v100, v100 row_ror:1 row_mask:0xf bank_mask:0xf
    v_add_f32_dpp v104, v104, v104 row_ror:1 row_mask:0xf bank_mask:0xf
    v_add_f32_dpp v108, v108, v108 row_ror:1 row_mask:0xf bank_mask:0xf
    ds_write_b32 v202, v96 offset:0
    ds_write_b32 v202, v100 offset:128
    ds_write_b32 v202, v104 offset:16
    ds_write_b32 v202, v108 offset:144
    s_waitcnt lgkmcnt(0)
    s_barrier
    ds_read_b128 v[96:99], v203 offset:0
    ds_read_b128 v[100:103], v203 offset:16
    s_waitcnt lgkmcnt(0)
    v_add_f32 v96, v96, v97
    v_add_f32 v98, v98, v99
    v_add_f32 v100, v100, v101
    v_add_f32 v102, v102, v103
    v_add_f32 v96, v96, v98
    v_add_f32 v100, v100, v102
    v_mul_f32 v96, 0xba800000, v96
    v_mul_f32 v100, 0x3a800000, v100
    v_fma_f32 v100, -v96, v96, v100
    v_max_f32 v100, 0, v100
    v_add_f32 v100, 0x3727c5ac, v100
    v_rsq_f32 v100, v100
    v_readlane_b32 s64, v96, 0
    v_readlane_b32 s65, v100, 0
    v_readlane_b32 s66, v96, 1
    v_readlane_b32 s67, v100, 1
    v_readlane_b32 s68, v96, 2
    v_readlane_b32 s69, v100, 2
    v_readlane_b32 s70, v96, 3
    v_readlane_b32 s71, v100, 3
    v_readlane_b32 s72, v96, 4
    v_readlane_b32 s73, v100, 4
    v_readlane_b32 s74, v96, 5
    v_readlane_b32 s75, v100, 5
    v_readlane_b32 s76, v96, 6
    v_readlane_b32 s77, v100, 6
    v_readlane_b32 s78, v96, 7
    v_readlane_b32 s79, v100, 7
    v_pk_add_f32 v[64:65], v[32:33], s[64:65] op_sel_hi:[1,0]
    v_pk_add_f32 v[66:67], v[34:35], s[64:65] op_sel_hi:[1,0]
    v_pk_mul_f32 v[64:65], v[64:65], s[64:65] op_sel:[0,1] op_sel_hi:[1,1]
    v_pk_mul_f32 v[66:67], v[66:67], s[64:65] op_sel:[0,1] op_sel_hi:[1,1]
    v_pk_add_f32 v[68:69], v[36:37], s[66:67] op_sel_hi:[1,0]
    v_pk_add_f32 v[70:71], v[38:39], s[66:67] op_sel_hi:[1,0]
    v_pk_mul_f32 v[68:69], v[68:69], s[66:67] op_sel:[0,1] op_sel_hi:[1,1]
    v_pk_mul_f32 v[70:71], v[70:71], s[66:67] op_sel:[0,1] op_sel_hi:[1,1]
    v_pk_add_f32 v[72:73], v[40:41], s[68:69] op_sel_hi:[1,0]
    v_pk_add_f32 v[74:75], v[42:43], s[68:69] op_sel_hi:[1,0]
    v_pk_mul_f32 v[72:73], v[72:73], s[68:69] op_sel:[0,1] op_sel_hi:[1,1]
    v_pk_mul_f32 v[74:75], v[74:75], s[68:69] op_sel:[0,1] op_sel_hi:[1,1]
    v_pk_add_f32 v[76:77], v[44:45], s[70:71] op_sel_hi:[1,0]
    v_pk_add_f32 v[78:79], v[46:47], s[70:71] op_sel_hi:[1,0]
    v_pk_mul_f32 v[76:77], v[76:77], s[70:71] op_sel:[0,1] op_sel_hi:[1,1]
    v_pk_mul_f32 v[78:79], v[78:79], s[70:71] op_sel:[0,1] op_sel_hi:[1,1]
    v_pk_add_f32 v[80:81], v[48:49], s[72:73] op_sel_hi:[1,0]
    v_pk_add_f32 v[82:83], v[50:51], s[72:73] op_sel_hi:[1,0]
    v_pk_mul_f32 v[80:81], v[80:81], s[72:73] op_sel:[0,1] op_sel_hi:[1,1]
    v_pk_mul_f32 v[82:83], v[82:83], s[72:73] op_sel:[0,1] op_sel_hi:[1,1]
    v_pk_add_f32 v[84:85], v[52:53], s[74:75] op_sel_hi:[1,0]
    v_pk_add_f32 v[86:87], v[54:55], s[74:75] op_sel_hi:[1,0]
    v_pk_mul_f32 v[84:85], v[84:85], s[74:75] op_sel:[0,1] op_sel_hi:[1,1]
    v_pk_mul_f32 v[86:87], v[86:87], s[74:75] op_sel:[0,1] op_sel_hi:[1,1]
    v_pk_add_f32 v[88:89], v[56:57], s[76:77] op_sel_hi:[1,0]
    v_pk_add_f32 v[90:91], v[58:59], s[76:77] op_sel_hi:[1,0]
    v_pk_mul_f32 v[88:89], v[88:89], s[76:77] op_sel:[0,1] op_sel_hi:[1,1]
    v_pk_mul_f32 v[90:91], v[90:91], s[76:77] op_sel:[0,1] op_sel_hi:[1,1]
    v_pk_add_f32 v[92:93], v[60:61], s[78:79] op_sel_hi:[1,0]
    v_pk_add_f32 v[94:95], v[62:63], s[78:79] op_sel_hi:[1,0]
    v_pk_mul_f32 v[92:93], v[92:93], s[78:79] op_sel:[0,1] op_sel_hi:[1,1]
    v_pk_mul_f32 v[94:95], v[94:95], s[78:79] op_sel:[0,1] op_sel_hi:[1,1]
    s_cmp_lg_u32 s3, 7
    s_cbranch_scc1 L_skip_28
    s_mov_b32 s60, 360448
    v_min_u32 v250, 63, v2
    v_lshlrev_b32 v250, 7, v250
    s_mov_b32 s61, 0
L_poll_29:
    buffer_load_dword v251, v250, s[8:11], s60 offen sc1
    s_add_u32 s62, s60, 8192
    buffer_load_dword v252, v250, s[8:11], s62 offen sc1
    s_add_u32 s62, s60, 16384
    buffer_load_dword v253, v250, s[8:11], s62 offen sc1
    s_add_u32 s62, s60, 24576
    buffer_load_dword v254, v250, s[8:11], s62 offen sc1
    s_add_u32 s61, s61, 1
    s_cmp_gt_u32 s61, 30000
    s_cbranch_scc1 L_go_30
    s_waitcnt vmcnt(0)
    v_xor_b32 v251, s6, v251
    v_xor_b32 v252, s6, v252
    v_xor_b32 v253, s6, v253
    v_xor_b32 v254, s6, v254
    v_or3_b32 v251, v251, v252, v253
    v_or_b32 v251, v251, v254
    v_cmp_ne_u32 vcc, 0, v251
    s_cbranch_vccnz L_poll_29
L_go_30:
    s_waitcnt vmcnt(0)
    s_cmp_lg_u32 s2, 0
    s_cbranch_scc1 L_skip_28
    v_mov_b32 v250, s6
    v_mov_b32 v251, 49152
    s_mov_b64 exec, 1
    buffer_store_dword v250, v251, s[8:11], 0 offen sc1
    s_mov_b64 exec, -1
L_skip_28:
    s_lshl_b32 s33, s30, 12
    s_add_u32 s48, s33, 16384
    s_lshl_b32 s33, s30, 13
    s_lshr_b32 s38, s7, 1
    s_lshl_b32 s38, s38, 15
    s_add_u32 s33, s33, s38
    s_and_b32 s38, s7, 1
    s_lshl_b32 s38, s38, 4
    s_add_u32 s33, s33, s38
    s_add_u32 s33, s33, 9437184
    s_barrier
    s_add_u32 m0, s48, 0
    s_add_u32 s38, s33, 0
    buffer_load_dwordx4 v201, s[8:11], s38 offen sc1 lds
    s_add_u32 m0, s48, 1024
    s_add_u32 s38, s33, 2048
    buffer_load_dwordx4 v201, s[8:11], s38 offen sc1 lds
    s_add_u32 m0, s48, 2048
    s_add_u32 s38, s33, 4096
    buffer_load_dwordx4 v201, s[8:11], s38 offen sc1 lds
    s_add_u32 m0, s48, 3072
    s_add_u32 s38, s33, 6144
    buffer_load_dwordx4 v201, s[8:11], s38 offen sc1 lds
    s_mov_b32 s38, 0
    buffer_load_dwordx4 v[180:183], v200, s[8:11], s38 offen sc1
    s_mov_b32 s38, 24576
    buffer_load_dwordx4 v[208:211], v200, s[8:11], s38 offen sc1
    s_mov_b32 s38, 4096
    buffer_load_dwordx4 v[184:187], v200, s[8:11], s38 offen sc1
    s_mov_b32 s38, 28672
    buffer_load_dwordx4 v[212:215], v200, s[8:11], s38 offen sc1
    s_mov_b32 s38, 8192
    buffer_load_dwordx4 v[188:191], v200, s[8:11], s38 offen sc1
    s_mov_b32 s38, 32768
    buffer_load_dwordx4 v[216:219], v200, s[8:11], s38 offen sc1
    s_mov_b32 s38, 12288
    buffer_load_dwordx4 v[192:195], v200, s[8:11], s38 offen sc1
    s_mov_b32 s38, 36864
    buffer_load_dwordx4 v[220:223], v200, s[8:11], s38 offen sc1
    s_mov_b32 s38, 16384
    buffer_load_dwordx4 v[196:199], v200, s[8:11], s38 offen sc1
    s_mov_b32 s38, 40960
    buffer_load_dwordx4 v[224:227], v200, s[8:11], s38 offen sc1
    s_waitcnt vmcnt(10)
    s_barrier
    ds_read_b128 v[8:11], v116
    ds_read_b128 v[12:15], v117
    ds_read_b128 v[16:19], v118
    ds_read_b128 v[20:23], v119
    s_waitcnt vmcnt(4)
    v_pk_add_f32 v[180:181], v[180:181], v[208:209]
    v_pk_add_f32 v[182:183], v[182:183], v[210:211]
    v_pk_add_f32 v[184:185], v[184:185], v[212:213]
    v_pk_add_f32 v[186:187], v[186:187], v[214:215]
    v_pk_add_f32 v[188:189], v[188:189], v[216:217]
    v_pk_add_f32 v[190:191], v[190:191], v[218:219]
    v_pk_fma_f32 v[184:185], v[184:185], v[188:189], v[188:189]
    v_pk_fma_f32 v[186:187], v[186:187], v[190:191], v[190:191]
    v_pk_mul_f32 v[180:181], v[180:181], v[188:189]
    v_pk_mul_f32 v[182:183], v[182:183], v[190:191]
    v_pk_fma_f32 v[64:65], v[64:65], v[184:185], v[180:181]
    v_pk_fma_f32 v[66:67], v[66:67], v[186:187], v[182:183]
    v_pk_fma_f32 v[68:69], v[68:69], v[184:185], v[180:181]
    v_pk_fma_f32 v[70:71], v[70:71], v[186:187], v[182:183]
    v_pk_fma_f32 v[72:73], v[72:73], v[184:185], v[180:181]
    v_pk_fma_f32 v[74:75], v[74:75], v[186:187], v[182:183]
    v_pk_fma_f32 v[76:77], v[76:77], v[184:185], v[180:181]
    v_pk_fma_f32 v[78:79], v[78:79], v[186:187], v[182:183]
    v_pk_fma_f32 v[80:81], v[80:81], v[184:185], v[180:181]
    v_pk_fma_f32 v[82:83], v[82:83], v[186:187], v[182:183]
    v_pk_fma_f32 v[84:85], v[84:85], v[184:185], v[180:181]
    v_pk_fma_f32 v[86:87], v[86:87], v[186:187], v[182:183]
    v_pk_fma_f32 v[88:89], v[88:89], v[184:185], v[180:181]
    v_pk_fma_f32 v[90:91], v[90:91], v[186:187], v[182:183]
    v_pk_fma_f32 v[92:93], v[92:93], v[184:185], v[180:181]
    v_pk_fma_f32 v[94:95], v[94:95], v[186:187], v[182:183]
    s_waitcnt lgkmcnt(0)
    v_lshlrev_b32 v96, 16, v8
    v_and_b32 v100, 0xffff0000, v8
    v_lshlrev_b32 v97, 16, v12
    v_and_b32 v101, 0xffff0000, v12
    v_lshlrev_b32 v98, 16, v16
    v_and_b32 v102, 0xffff0000, v16
    v_lshlrev_b32 v99, 16, v20
    v_and_b32 v103, 0xffff0000, v20
    v_pk_fma_f32 v[32:33], v[64:65], v[96:97], v[32:33]
    v_pk_fma_f32 v[34:35], v[66:67], v[98:99], v[34:35]
    v_pk_fma_f32 v[36:37], v[68:69], v[100:101], v[36:37]
    v_pk_fma_f32 v[38:39], v[70:71], v[102:103], v[38:39]
    v_lshlrev_b32 v96, 16, v9
    v_and_b32 v100, 0xffff0000, v9
    v_lshlrev_b32 v97, 16, v13
    v_and_b32 v101, 0xffff0000, v13
    v_lshlrev_b32 v98, 16, v17
    v_and_b32 v102, 0xffff0000, v17
    v_lshlrev_b32 v99, 16, v21
    v_and_b32 v103, 0xffff0000, v21
    v_pk_fma_f32 v[40:41], v[72:73], v[96:97], v[40:41]
    v_pk_fma_f32 v[42:43], v[74:75], v[98:99], v[42:43]
    v_pk_fma_f32 v[44:45], v[76:77], v[100:101], v[44:45]
    v_pk_fma_f32 v[46:47], v[78:79], v[102:103], v[46:47]
    v_lshlrev_b32 v96, 16, v10
    v_and_b32 v100, 0xffff0000, v10
    v_lshlrev_b32 v97, 16, v14
    v_and_b32 v101, 0xffff0000, v14
    v_lshlrev_b32 v98, 16, v18
    v_and_b32 v102, 0xffff0000, v18
    v_lshlrev_b32 v99, 16, v22
L_pad_11:
    s_cmp_eq_u32 s99, 1
    s_cbranch_scc1 L_padret_11
    v_and_b32 v103, 0xffff0000, v22
    v_pk_fma_f32 v[48:49], v[80:81], v[96:97], v[48:49]
    v_pk_fma_f32 v[50:51], v[82:83], v[98:99], v[50:51]
    v_pk_fma_f32 v[52:53], v[84:85], v[100:101], v[52:53]
    v_pk_fma_f32 v[54:55], v[86:87], v[102:103], v[54:55]
    v_lshlrev_b32 v96, 16, v11
    v_and_b32 v100, 0xffff0000, v11
    v_lshlrev_b32 v97, 16, v15
    v_and_b32 v101, 0xffff0000, v15
    v_lshlrev_b32 v98, 16, v19
    v_and_b32 v102, 0xffff0000, v19
    v_lshlrev_b32 v99, 16, v23
    v_and_b32 v103, 0xffff0000, v23
    v_pk_fma_f32 v[56:57], v[88:89], v[96:97], v[56:57]
    v_pk_fma_f32 v[58:59], v[90:91], v[98:99], v[58:59]
    v_pk_fma_f32 v[60:61], v[92:93], v[100:101], v[60:61]
    v_pk_fma_f32 v[62:63], v[94:95], v[102:103], v[62:63]
    v_cvt_pk_bf16_f32 v164, v32, v33
    v_cvt_pk_bf16_f32 v165, v34, v35
    v_cvt_pk_bf16_f32 v166, v36, v37
    v_cvt_pk_bf16_f32 v167, v38, v39
    v_cvt_pk_bf16_f32 v168, v40, v41
    v_cvt_pk_bf16_f32 v169, v42, v43
    v_cvt_pk_bf16_f32 v170, v44, v45
    v_cvt_pk_bf16_f32 v171, v46, v47
    v_cvt_pk_bf16_f32 v172, v48, v49
    v_cvt_pk_bf16_f32 v173, v50, v51
    v_cvt_pk_bf16_f32 v174, v52, v53
    v_cvt_pk_bf16_f32 v175, v54, v55
    v_cvt_pk_bf16_f32 v176, v56, v57
    v_cvt_pk_bf16_f32 v177, v58, v59
    v_cvt_pk_bf16_f32 v178, v60, v61
    v_cvt_pk_bf16_f32 v179, v62, v63
    s_add_u32 s31, s32, 13631488
    buffer_store_dwordx2 v[164:165], v1, s[8:11], s31 offen offset:0 sc1
    buffer_store_dwordx2 v[166:167], v1, s[8:11], s31 offen offset:2048 sc1
    s_add_u32 s31, s32, 13635584
    buffer_store_dwordx2 v[168:169], v1, s[8:11], s31 offen offset:0 sc1
    buffer_store_dwordx2 v[170:171], v1, s[8:11], s31 offen offset:2048 sc1
    s_add_u32 s31, s32, 13639680
    buffer_store_dwordx2 v[172:173], v1, s[8:11], s31 offen offset:0 sc1
    buffer_store_dwordx2 v[174:175], v1, s[8:11], s31 offen offset:2048 sc1
    s_add_u32 s31, s32, 13643776
    buffer_store_dwordx2 v[176:177], v1, s[8:11], s31 offen offset:0 sc1
    buffer_store_dwordx2 v[178:179], v1, s[8:11], s31 offen offset:2048 sc1
    v_pk_add_f32 v[112:113], v[32:33], v[34:35]
    v_pk_mul_f32 v[114:115], v[32:33], v[32:33]
    v_pk_fma_f32 v[114:115], v[34:35], v[34:35], v[114:115]
    v_add_f32 v96, v112, v113
    v_add_f32 v104, v114, v115
    v_pk_add_f32 v[112:113], v[36:37], v[38:39]
    v_pk_mul_f32 v[114:115], v[36:37], v[36:37]
    v_pk_fma_f32 v[114:115], v[38:39], v[38:39], v[114:115]
    v_add_f32 v97, v112, v113
    v_add_f32 v105, v114, v115
    v_pk_add_f32 v[112:113], v[40:41], v[42:43]
    v_pk_mul_f32 v[114:115], v[40:41], v[40:41]
    v_pk_fma_f32 v[114:115], v[42:43], v[42:43], v[114:115]
    v_add_f32 v98, v112, v113
    v_add_f32 v106, v114, v115
    v_pk_add_f32 v[112:113], v[44:45], v[46:47]
    v_pk_mul_f32 v[114:115], v[44:45], v[44:45]
    v_pk_fma_f32 v[114:115], v[46:47], v[46:47], v[114:115]
    v_add_f32 v99, v112, v113
    v_add_f32 v107, v114, v115
    v_pk_add_f32 v[112:113], v[48:49], v[50:51]
    v_pk_mul_f32 v[114:115], v[48:49], v[48:49]
    v_pk_fma_f32 v[114:115], v[50:51], v[50:51], v[114:115]
    v_add_f32 v100, v112, v113
    v_add_f32 v108, v114, v115
    v_pk_add_f32 v[112:113], v[52:53], v[54:55]
    v_pk_mul_f32 v[114:115], v[52:53], v[52:53]
    v_pk_fma_f32 v[114:115], v[54:55], v[54:55], v[114:115]
    v_add_f32 v101, v112, v113
    v_add_f32 v109, v114, v115
    v_pk_add_f32 v[112:113], v[56:57], v[58:59]
    v_pk_mul_f32 v[114:115], v[56:57], v[56:57]
    v_pk_fma_f32 v[114:115], v[58:59], v[58:59], v[114:115]
    v_add_f32 v102, v112, v113
    v_add_f32 v110, v114, v115
    v_pk_add_f32 v[112:113], v[60:61], v[62:63]
    v_pk_mul_f32 v[114:115], v[60:61], v[60:61]
    v_pk_fma_f32 v[114:115], v[62:63], v[62:63], v[114:115]
    v_add_f32 v103, v112, v113
    v_add_f32 v111, v114, v115
    v_permlane32_swap_b32 v96, v97
    v_permlane32_swap_b32 v98, v99
    v_permlane32_swap_b32 v100, v101
    v_permlane32_swap_b32 v102, v103
    v_permlane32_swap_b32 v104, v105
    v_permlane32_swap_b32 v106, v107
    v_permlane32_swap_b32 v108, v109
    v_permlane32_swap_b32 v110, v111
    v_add_f32 v96, v96, v97
    v_add_f32 v98, v98, v99
    v_add_f32 v100, v100, v101
    v_add_f32 v102, v102, v103
    v_add_f32 v104, v104, v105
    v_add_f32 v106, v106, v107
    v_add_f32 v108, v108, v109
    v_add_f32 v110, v110, v111
    v_permlane16_swap_b32 v96, v98
    v_permlane16_swap_b32 v100, v102
    v_permlane16_swap_b32 v104, v106
    v_permlane16_swap_b32 v108, v110
    v_add_f32 v96, v96, v98
    v_add_f32 v100, v100, v102
    v_add_f32 v104, v104, v106
    v_add_f32 v108, v108, v110
    v_add_f32_dpp v96, v96, v96 row_ror:8 row_mask:0xf bank_mask:0xf
    v_add_f32_dpp v100, v100, v100 row_ror:8 row_mask:0xf bank_mask:0xf
    v_add_f32_dpp v104, v104, v104 row_ror:8 row_mask:0xf bank_mask:0xf
    v_add_f32_dpp v108, v108, v108 row_ror:8 row_mask:0xf bank_mask:0xf
    v_add_f32_dpp v96, v96, v96 row_ror:4 row_mask:0xf bank_mask:0xf
    v_add_f32_dpp v100, v100, v100 row_ror:4 row_mask:0xf bank_mask:0xf
    v_add_f32_dpp v104, v104, v104 row_ror:4 row_mask:0xf bank_mask:0xf
    v_add_f32_dpp v108, v108, v108 row_ror:4 row_mask:0xf bank_mask:0xf
    v_add_f32_dpp v96, v96, v96 row_ror:2 row_mask:0xf bank_mask:0xf
    v_add_f32_dpp v100, v100, v100 row_ror:2 row_mask:0xf bank_mask:0xf
    v_add_f32_dpp v104, v104, v104 row_ror:2 row_mask:0xf bank_mask:0xf
    v_add_f32_dpp v108, v108, v108 row_ror:2 row_mask:0xf bank_mask:0xf
    v_add_f32_dpp v96, v96, v96 row_ror:1 row_mask:0xf bank_mask:0xf
    v_add_f32_dpp v100, v100, v100 row_ror:1 row_mask:0xf bank_mask:0xf
    v_add_f32_dpp v104, v104, v104 row_ror:1 row_mask:0xf bank_mask:0xf
    v_add_f32_dpp v108, v108, v108 row_ror:1 row_mask:0xf bank_mask:0xf
    ds_write_b32 v202, v96 offset:256
    ds_write_b32 v202, v100 offset:384
    ds_write_b32 v202, v104 offset:272
    ds_write_b32 v202, v108 offset:400
    s_waitcnt lgkmcnt(0)
    s_waitcnt vmcnt(8)
    v_pk_add_f32 v[192:193], v[192:193], v[220:221]
    v_pk_add_f32 v[194:195], v[194:195], v[222:223]
    v_pk_add_f32 v[196:197], v[196:197], v[224:225]
    v_pk_add_f32 v[198:199], v[198:199], v[226:227]
    v_pk_add_f32 v[196:197], v[196:197], 1.0 op_sel_hi:[1,0]
    v_pk_add_f32 v[198:199], v[198:199], 1.0 op_sel_hi:[1,0]
    s_lshl_b32 s33, s7, 15
    v_lshrrev_b32 v6, 7, v1
    v_add_u32 v7, 4, v6
    v_mul_u32_u24 v7, 37, v7
    v_lshrrev_b32 v7, 8, v7
    v_add_u32 v6, v6, v7
    v_and_b32 v205, 127, v1
    v_lshl_add_u32 v205, v6, 7, v205
    s_barrier
    ds_read_b128 v[96:99], v203 offset:256
    ds_read_b128 v[100:103], v203 offset:272
    s_waitcnt lgkmcnt(0)
    v_add_f32 v96, v96, v97
    v_add_f32 v98, v98, v99
    v_add_f32 v100, v100, v101
    v_add_f32 v102, v102, v103
    v_add_f32 v96, v96, v98
    v_add_f32 v100, v100, v102
    v_mul_f32 v96, 0xba800000, v96
    v_mul_f32 v100, 0x3a800000, v100
    v_fma_f32 v100, -v96, v96, v100
    v_max_f32 v100, 0, v100
    v_add_f32 v100, 0x3727c5ac, v100
    v_rsq_f32 v100, v100
    s_nop 0
    v_mul_f32 v96, v96, v100
    s_nop 0
    v_readlane_b32 s64, v96, 0
    v_readlane_b32 s65, v100, 0
    v_readlane_b32 s66, v96, 1
    v_readlane_b32 s67, v100, 1
    v_readlane_b32 s68, v96, 2
    v_readlane_b32 s69, v100, 2
    v_readlane_b32 s70, v96, 3
    v_readlane_b32 s71, v100, 3
    v_readlane_b32 s72, v96, 4
    v_readlane_b32 s73, v100, 4
    v_readlane_b32 s74, v96, 5
    v_readlane_b32 s75, v100, 5
    v_readlane_b32 s76, v96, 6
    v_readlane_b32 s77, v100, 6
    v_readlane_b32 s78, v96, 7
    v_readlane_b32 s79, v100, 7
    v_mov_b32 v104, s64
    v_pk_fma_f32 v[64:65], v[32:33], s[64:65], v[104:105] op_sel:[0,1,0] op_sel_hi:[1,1,0]
    v_pk_fma_f32 v[66:67], v[34:35], s[64:65], v[104:105] op_sel:[0,1,0] op_sel_hi:[1,1,0]
    v_pk_fma_f32 v[64:65], v[64:65], v[196:197], v[192:193]
    v_pk_fma_f32 v[66:67], v[66:67], v[198:199], v[194:195]
    v_cvt_pk_bf16_f32 v8, v64, v65
    v_cvt_pk_bf16_f32 v9, v66, v67
    s_add_u32 s38, s33, 17825792
    buffer_store_dwordx2 v[8:9], v205, s[8:11], s38 offen sc1
    v_mov_b32 v106, s66
    v_pk_fma_f32 v[68:69], v[36:37], s[66:67], v[106:107] op_sel:[0,1,0] op_sel_hi:[1,1,0]
    v_pk_fma_f32 v[70:71], v[38:39], s[66:67], v[106:107] op_sel:[0,1,0] op_sel_hi:[1,1,0]
    v_pk_fma_f32 v[68:69], v[68:69], v[196:197], v[192:193]
    v_pk_fma_f32 v[70:71], v[70:71], v[198:199], v[194:195]
    v_cvt_pk_bf16_f32 v10, v68, v69
    v_cvt_pk_bf16_f32 v11, v70, v71
    s_add_u32 s38, s33, 17829888
    buffer_store_dwordx2 v[10:11], v205, s[8:11], s38 offen sc1
    v_mov_b32 v104, s68
    v_pk_fma_f32 v[72:73], v[40:41], s[68:69], v[104:105] op_sel:[0,1,0] op_sel_hi:[1,1,0]
    v_pk_fma_f32 v[74:75], v[42:43], s[68:69], v[104:105] op_sel:[0,1,0] op_sel_hi:[1,1,0]
    v_pk_fma_f32 v[72:73], v[72:73], v[196:197], v[192:193]
    v_pk_fma_f32 v[74:75], v[74:75], v[198:199], v[194:195]
    v_cvt_pk_bf16_f32 v12, v72, v73
    v_cvt_pk_bf16_f32 v13, v74, v75
    s_add_u32 s38, s33, 17833984
    buffer_store_dwordx2 v[12:13], v205, s[8:11], s38 offen sc1
    v_mov_b32 v106, s70
    v_pk_fma_f32 v[76:77], v[44:45], s[70:71], v[106:107] op_sel:[0,1,0] op_sel_hi:[1,1,0]
    v_pk_fma_f32 v[78:79], v[46:47], s[70:71], v[106:107] op_sel:[0,1,0] op_sel_hi:[1,1,0]
    v_pk_fma_f32 v[76:77], v[76:77], v[196:197], v[192:193]
    v_pk_fma_f32 v[78:79], v[78:79], v[198:199], v[194:195]
    v_cvt_pk_bf16_f32 v14, v76, v77
    v_cvt_pk_bf16_f32 v15, v78, v79
    s_add_u32 s38, s33, 17838080
    buffer_store_dwordx2 v[14:15], v205, s[8:11], s38 offen sc1
    v_mov_b32 v104, s72
    v_pk_fma_f32 v[80:81], v[48:49], s[72:73], v[104:105] op_sel:[0,1,0] op_sel_hi:[1,1,0]
    v_pk_fma_f32 v[82:83], v[50:51], s[72:73], v[104:105] op_sel:[0,1,0] op_sel_hi:[1,1,0]
    v_pk_fma_f32 v[80:81], v[80:81], v[196:197], v[192:193]
    v_pk_fma_f32 v[82:83], v[82:83], v[198:199], v[194:195]
    v_cvt_pk_bf16_f32 v16, v80, v81
    v_cvt_pk_bf16_f32 v17, v82, v83
    s_add_u32 s38, s33, 17842176
    buffer_store_dwordx2 v[16:17], v205, s[8:11], s38 offen sc1
    v_mov_b32 v106, s74
    v_pk_fma_f32 v[84:85], v[52:53], s[74:75], v[106:107] op_sel:[0,1,0] op_sel_hi:[1,1,0]
    v_pk_fma_f32 v[86:87], v[54:55], s[74:75], v[106:107] op_sel:[0,1,0] op_sel_hi:[1,1,0]
    v_pk_fma_f32 v[84:85], v[84:85], v[196:197], v[192:193]
    v_pk_fma_f32 v[86:87], v[86:87], v[198:199], v[194:195]
    v_cvt_pk_bf16_f32 v18, v84, v85
    v_cvt_pk_bf16_f32 v19, v86, v87
    s_add_u32 s38, s33, 17846272
    buffer_store_dwordx2 v[18:19], v205, s[8:11], s38 offen sc1
    v_mov_b32 v104, s76
    v_pk_fma_f32 v[88:89], v[56:57], s[76:77], v[104:105] op_sel:[0,1,0] op_sel_hi:[1,1,0]
    v_pk_fma_f32 v[90:91], v[58:59], s[76:77], v[104:105] op_sel:[0,1,0] op_sel_hi:[1,1,0]
    v_pk_fma_f32 v[88:89], v[88:89], v[196:197], v[192:193]
    v_pk_fma_f32 v[90:91], v[90:91], v[198:199], v[194:195]
    v_cvt_pk_bf16_f32 v20, v88, v89
    v_cvt_pk_bf16_f32 v21, v90, v91
    s_add_u32 s38, s33, 17850368
    buffer_store_dwordx2 v[20:21], v205, s[8:11], s38 offen sc1
    v_mov_b32 v106, s78
    v_pk_fma_f32 v[92:93], v[60:61], s[78:79], v[106:107] op_sel:[0,1,0] op_sel_hi:[1,1,0]
    v_pk_fma_f32 v[94:95], v[62:63], s[78:79], v[106:107] op_sel:[0,1,0] op_sel_hi:[1,1,0]
    v_pk_fma_f32 v[92:93], v[92:93], v[196:197], v[192:193]
    v_pk_fma_f32 v[94:95], v[94:95], v[198:199], v[194:195]
    v_cvt_pk_bf16_f32 v22, v92, v93
    v_cvt_pk_bf16_f32 v23, v94, v95
    s_add_u32 s38, s33, 17854464
    buffer_store_dwordx2 v[22:23], v205, s[8:11], s38 offen sc1
    s_waitcnt vmcnt(0)
    s_barrier
    s_cmp_lg_u32 s3, 7
    s_cbranch_scc1 L_skip_31
    s_lshl_b32 s60, s7, 7
    s_add_u32 s60, s60, 393216
    v_mov_b32 v250, s6
    v_mov_b32 v251, 0
    s_mov_b64 exec, 1
    buffer_store_dword v250, v251, s[8:11], s60 offen sc1
    s_mov_b64 exec, -1
L_skip_31:
    s_cmp_ge_u32 s5, 28
    s_cbranch_scc1 L_Bspare
    s_cmp_ge_u32 s3, 6
    s_cbranch_scc1 L_X
    s_and_b32 s35, s57, 3
    s_cmp_lg_u32 s35, 1
    s_cbranch_scc1 L_nofix_32
    s_add_u32 s20, s94, 42991360
    s_addc_u32 s21, s95, 0
    s_and_b32 s21, s21, 0xffff
L_nofix_32:
    s_add_u32 s64, s94, 55574400
    s_addc_u32 s65, s95, 0
    s_and_b32 s65, s65, 0xffff
    s_mov_b32 s66, 8388608
    s_mov_b32 s67, 0x00020000
    s_barrier
    s_mul_i32 s50, s30, 8192
    s_mov_b32 s51, 0
    s_add_u32 m0, s50, 16384
    s_nop 0
    buffer_load_dwordx4 v128, s[8:11], s51 offen sc1 lds
    s_add_u32 m0, s50, 17408
    s_nop 0
    buffer_load_dwordx4 v129, s[8:11], s51 offen sc1 lds
    s_add_u32 m0, s50, 18432
    s_nop 0
    buffer_load_dwordx4 v130, s[8:11], s51 offen sc1 lds
    s_add_u32 m0, s50, 19456
    s_nop 0
    buffer_load_dwordx4 v131, s[8:11], s51 offen sc1 lds
    s_add_u32 m0, s50, 20480
    s_nop 0
    buffer_load_dwordx4 v132, s[8:11], s51 offen sc1 lds
    s_add_u32 m0, s50, 21504
    s_nop 0
    buffer_load_dwordx4 v133, s[8:11], s51 offen sc1 lds
    s_add_u32 m0, s50, 22528
    s_nop 0
    buffer_load_dwordx4 v134, s[8:11], s51 offen sc1 lds
    s_add_u32 m0, s50, 23552
    s_nop 0
    buffer_load_dwordx4 v135, s[8:11], s51 offen sc1 lds
    s_mul_i32 s50, s30, 8192
    s_mov_b32 s51, 128
    s_add_u32 m0, s50, 49152
    s_nop 0
    buffer_load_dwordx4 v128, s[8:11], s51 offen sc1 lds
    s_add_u32 m0, s50, 50176
    s_nop 0
    buffer_load_dwordx4 v129, s[8:11], s51 offen sc1 lds
    s_add_u32 m0, s50, 51200
    s_nop 0
    buffer_load_dwordx4 v130, s[8:11], s51 offen sc1 lds
    s_add_u32 m0, s50, 52224
    s_nop 0
    buffer_load_dwordx4 v131, s[8:11], s51 offen sc1 lds
    s_add_u32 m0, s50, 53248
    s_nop 0
    buffer_load_dwordx4 v132, s[8:11], s51 offen sc1 lds
    s_add_u32 m0, s50, 54272
    s_nop 0
    buffer_load_dwordx4 v133, s[8:11], s51 offen sc1 lds
    s_add_u32 m0, s50, 55296
    s_nop 0
    buffer_load_dwordx4 v134, s[8:11], s51 offen sc1 lds
    s_add_u32 m0, s50, 56320
    s_nop 0
    buffer_load_dwordx4 v135, s[8:11], s51 offen sc1 lds
    s_mul_i32 s50, s30, 8192
    s_mov_b32 s51, 256
    s_add_u32 m0, s50, 81920
    s_nop 0
    buffer_load_dwordx4 v128, s[8:11], s51 offen sc1 lds
    s_add_u32 m0, s50, 82944
    s_nop 0
    buffer_load_dwordx4 v129, s[8:11], s51 offen sc1 lds
    s_add_u32 m0, s50, 83968
    s_nop 0
    buffer_load_dwordx4 v130, s[8:11], s51 offen sc1 lds
    s_add_u32 m0, s50, 84992
    s_nop 0
    buffer_load_dwordx4 v131, s[8:11], s51 offen sc1 lds
    s_add_u32 m0, s50, 86016
    s_nop 0
    buffer_load_dwordx4 v132, s[8:11], s51 offen sc1 lds
    s_add_u32 m0, s50, 87040
    s_nop 0
    buffer_load_dwordx4 v133, s[8:11], s51 offen sc1 lds
    s_add_u32 m0, s50, 88064
    s_nop 0
    buffer_load_dwordx4 v134, s[8:11], s51 offen sc1 lds
    s_add_u32 m0, s50, 89088
    s_nop 0
    buffer_load_dwordx4 v135, s[8:11], s51 offen sc1 lds
    s_waitcnt vmcnt(16)
    s_barrier
    s_mul_i32 s50, s30, 8192
    s_mov_b32 s51, 512
    s_add_u32 m0, s50, 114688
    s_nop 0
    buffer_load_dwordx4 v128, s[8:11], s51 offen sc1 lds
    s_add_u32 m0, s50, 115712
    s_nop 0
    buffer_load_dwordx4 v129, s[8:11], s51 offen sc1 lds
    s_add_u32 m0, s50, 116736
    s_nop 0
    buffer_load_dwordx4 v130, s[8:11], s51 offen sc1 lds
    s_add_u32 m0, s50, 117760
    s_nop 0
    buffer_load_dwordx4 v131, s[8:11], s51 offen sc1 lds
    s_add_u32 m0, s50, 118784
    s_nop 0
    buffer_load_dwordx4 v132, s[8:11], s51 offen sc1 lds
    s_add_u32 m0, s50, 119808
    s_nop 0
    buffer_load_dwordx4 v133, s[8:11], s51 offen sc1 lds
    s_add_u32 m0, s50, 120832
    s_nop 0
    buffer_load_dwordx4 v134, s[8:11], s51 offen sc1 lds
    s_add_u32 m0, s50, 121856
    s_nop 0
    buffer_load_dwordx4 v135, s[8:11], s51 offen sc1 lds
    s_waitcnt vmcnt(16)
    s_barrier
    s_mul_i32 s50, s30, 8192
    s_mov_b32 s51, 640
    s_add_u32 m0, s50, 16384
    s_nop 0
    buffer_load_dwordx4 v128, s[8:11], s51 offen sc1 lds
    s_add_u32 m0, s50, 17408
    s_nop 0
    buffer_load_dwordx4 v129, s[8:11], s51 offen sc1 lds
    s_add_u32 m0, s50, 18432
    s_nop 0
    buffer_load_dwordx4 v130, s[8:11], s51 offen sc1 lds
    s_add_u32 m0, s50, 19456
    s_nop 0
    buffer_load_dwordx4 v131, s[8:11], s51 offen sc1 lds
    s_add_u32 m0, s50, 20480
    s_nop 0
    buffer_load_dwordx4 v132, s[8:11], s51 offen sc1 lds
    s_add_u32 m0, s50, 21504
    s_nop 0
    buffer_load_dwordx4 v133, s[8:11], s51 offen sc1 lds
    s_add_u32 m0, s50, 22528
    s_nop 0
    buffer_load_dwordx4 v134, s[8:11], s51 offen sc1 lds
    s_add_u32 m0, s50, 23552
    s_nop 0
    buffer_load_dwordx4 v135, s[8:11], s51 offen sc1 lds
    s_mul_i32 s50, s30, 8192
    s_mov_b32 s51, 1838592
    s_add_u32 m0, s50, 0
    s_nop 0
    buffer_load_dwordx4 v120, s[12:15], s51 offen  lds
    s_add_u32 m0, s50, 1024
    s_nop 0
    buffer_load_dwordx4 v121, s[12:15], s51 offen  lds
    s_add_u32 m0, s50, 2048
    s_nop 0
    buffer_load_dwordx4 v122, s[12:15], s51 offen  lds
    s_add_u32 m0, s50, 3072
    s_nop 0
    buffer_load_dwordx4 v123, s[12:15], s51 offen  lds
    s_add_u32 m0, s50, 4096
    s_nop 0
    buffer_load_dwordx4 v124, s[12:15], s51 offen  lds
    s_add_u32 m0, s50, 5120
    s_nop 0
    buffer_load_dwordx4 v125, s[12:15], s51 offen  lds
    s_add_u32 m0, s50, 6144
    s_nop 0
    buffer_load_dwordx4 v126, s[12:15], s51 offen  lds
    s_add_u32 m0, s50, 7168
    s_nop 0
    buffer_load_dwordx4 v127, s[12:15], s51 offen  lds
    s_waitcnt vmcnt(24)
    s_mov_b32 s53, 768
    s_mov_b32 s55, 49152
    s_mov_b32 s47, 5
    s_mov_b32 s52, 2297344
    s_mov_b32 s54, 32768
    s_mov_b32 s44, 11
L_lda_33:
    s_barrier
    s_mul_i32 s50, s30, 8192
    s_add_u32 s50, s50, s55
    s_add_u32 m0, s50, 0
    s_nop 0
    buffer_load_dwordx4 v128, s[8:11], s53 offen sc1 lds
    s_add_u32 m0, s50, 1024
    s_nop 0
    buffer_load_dwordx4 v129, s[8:11], s53 offen sc1 lds
    s_add_u32 m0, s50, 2048
    s_nop 0
    buffer_load_dwordx4 v130, s[8:11], s53 offen sc1 lds
    s_add_u32 m0, s50, 3072
    s_nop 0
    buffer_load_dwordx4 v131, s[8:11], s53 offen sc1 lds
    s_add_u32 m0, s50, 4096
    s_nop 0
    buffer_load_dwordx4 v132, s[8:11], s53 offen sc1 lds
    s_add_u32 m0, s50, 5120
    s_nop 0
    buffer_load_dwordx4 v133, s[8:11], s53 offen sc1 lds
    s_add_u32 m0, s50, 6144
    s_nop 0
    buffer_load_dwordx4 v134, s[8:11], s53 offen sc1 lds
    s_add_u32 m0, s50, 7168
    s_nop 0
    buffer_load_dwordx4 v135, s[8:11], s53 offen sc1 lds
    s_mul_i32 s50, s30, 8192
    s_add_u32 s50, s50, s54
    s_add_u32 m0, s50, 0
    s_nop 0
    buffer_load_dwordx4 v120, s[12:15], s52 offen  lds
    s_add_u32 m0, s50, 1024
    s_nop 0
    buffer_load_dwordx4 v121, s[12:15], s52 offen  lds
    s_add_u32 m0, s50, 2048
    s_nop 0
    buffer_load_dwordx4 v122, s[12:15], s52 offen  lds
    s_add_u32 m0, s50, 3072
    s_nop 0
    buffer_load_dwordx4 v123, s[12:15], s52 offen  lds
    s_add_u32 m0, s50, 4096
    s_nop 0
    buffer_load_dwordx4 v124, s[12:15], s52 offen  lds
    s_add_u32 m0, s50, 5120
    s_nop 0
    buffer_load_dwordx4 v125, s[12:15], s52 offen  lds
    s_add_u32 m0, s50, 6144
    s_nop 0
    buffer_load_dwordx4 v126, s[12:15], s52 offen  lds
    s_add_u32 m0, s50, 7168
    s_nop 0
    buffer_load_dwordx4 v127, s[12:15], s52 offen  lds
    s_add_u32 s47, s47, 1
    s_add_u32 s51, s47, 4
    s_mul_i32 s51, s51, 37
    s_lshr_b32 s51, s51, 8
    s_add_u32 s53, s47, s51
    s_lshl_b32 s53, s53, 7
    s_add_u32 s55, s55, 32768
    s_cmp_eq_u32 s55, 147456
    s_cselect_b32 s55, 16384, s55
    s_add_u32 s52, s52, 458752
    s_add_u32 s54, s54, 32768
    s_cmp_eq_u32 s54, 131072
    s_cselect_b32 s54, 0, s54
    s_sub_u32 s44, s44, 1
    s_cmp_lg_u32 s44, 0
    s_waitcnt vmcnt(32)
    s_cbranch_scc1 L_lda_33
    s_mov_b32 s53, 0
    s_mov_b32 s55, 16384
    s_mov_b32 s47, 0
    s_mov_b32 s52, 0
    s_mov_b32 s54, 0
    s_mov_b32 s44, 4
L_lda_34:
    s_barrier
    s_mul_i32 s50, s30, 8192
    s_add_u32 s50, s50, s55
    s_add_u32 m0, s50, 0
    s_nop 0
    buffer_load_dwordx4 v128, s[8:11], s53 offen sc1 lds
    s_add_u32 m0, s50, 1024
    s_nop 0
    buffer_load_dwordx4 v129, s[8:11], s53 offen sc1 lds
    s_add_u32 m0, s50, 2048
    s_nop 0
    buffer_load_dwordx4 v130, s[8:11], s53 offen sc1 lds
    s_add_u32 m0, s50, 3072
    s_nop 0
    buffer_load_dwordx4 v131, s[8:11], s53 offen sc1 lds
    s_add_u32 m0, s50, 4096
    s_nop 0
    buffer_load_dwordx4 v132, s[8:11], s53 offen sc1 lds
    s_add_u32 m0, s50, 5120
    s_nop 0
    buffer_load_dwordx4 v133, s[8:11], s53 offen sc1 lds
    s_add_u32 m0, s50, 6144
    s_nop 0
    buffer_load_dwordx4 v134, s[8:11], s53 offen sc1 lds
    s_add_u32 m0, s50, 7168
    s_nop 0
    buffer_load_dwordx4 v135, s[8:11], s53 offen sc1 lds
    s_mul_i32 s50, s30, 8192
    s_add_u32 s50, s50, s54
    s_add_u32 m0, s50, 0
    s_nop 0
    buffer_load_dwordx4 v120, s[24:27], s52 offen sc1 lds
    s_add_u32 m0, s50, 1024
    s_nop 0
    buffer_load_dwordx4 v121, s[24:27], s52 offen sc1 lds
    s_add_u32 m0, s50, 2048
    s_nop 0
    buffer_load_dwordx4 v122, s[24:27], s52 offen sc1 lds
    s_add_u32 m0, s50, 3072
    s_nop 0
    buffer_load_dwordx4 v123, s[24:27], s52 offen sc1 lds
    s_add_u32 m0, s50, 4096
    s_nop 0
    buffer_load_dwordx4 v124, s[24:27], s52 offen sc1 lds
    s_add_u32 m0, s50, 5120
    s_nop 0
    buffer_load_dwordx4 v125, s[24:27], s52 offen sc1 lds
    s_add_u32 m0, s50, 6144
    s_nop 0
    buffer_load_dwordx4 v126, s[24:27], s52 offen sc1 lds
    s_add_u32 m0, s50, 7168
    s_nop 0
    buffer_load_dwordx4 v127, s[24:27], s52 offen sc1 lds
    s_add_u32 s47, s47, 1
    s_add_u32 s51, s47, 4
    s_mul_i32 s51, s51, 37
    s_lshr_b32 s51, s51, 8
    s_add_u32 s53, s47, s51
    s_lshl_b32 s53, s53, 7
    s_add_u32 s55, s55, 32768
    s_cmp_eq_u32 s55, 147456
    s_cselect_b32 s55, 16384, s55
    s_add_u32 s52, s52, 458752
    s_add_u32 s54, s54, 32768
    s_cmp_eq_u32 s54, 131072
    s_cselect_b32 s54, 0, s54
    s_sub_u32 s44, s44, 1
    s_cmp_lg_u32 s44, 0
    s_waitcnt vmcnt(32)
    s_cbranch_scc1 L_lda_34
    s_barrier
    s_mul_i32 s50, s30, 8192
    s_mov_b32 s51, 640
    s_add_u32 m0, s50, 16384
    s_nop 0
    buffer_load_dwordx4 v128, s[8:11], s51 offen sc1 lds
    s_add_u32 m0, s50, 17408
    s_nop 0
    buffer_load_dwordx4 v129, s[8:11], s51 offen sc1 lds
    s_add_u32 m0, s50, 18432
    s_nop 0
    buffer_load_dwordx4 v130, s[8:11], s51 offen sc1 lds
    s_add_u32 m0, s50, 19456
    s_nop 0
    buffer_load_dwordx4 v131, s[8:11], s51 offen sc1 lds
    s_add_u32 m0, s50, 20480
    s_nop 0
    buffer_load_dwordx4 v132, s[8:11], s51 offen sc1 lds
    s_add_u32 m0, s50, 21504
    s_nop 0
    buffer_load_dwordx4 v133, s[8:11], s51 offen sc1 lds
    s_add_u32 m0, s50, 22528
    s_nop 0
    buffer_load_dwordx4 v134, s[8:11], s51 offen sc1 lds
    s_add_u32 m0, s50, 23552
    s_nop 0
    buffer_load_dwordx4 v135, s[8:11], s51 offen sc1 lds
    s_mul_i32 s50, s30, 8192
    s_mov_b32 s51, 1835008
    s_add_u32 m0, s50, 0
    s_nop 0
    buffer_load_dwordx4 v120, s[24:27], s51 offen sc1 lds
    s_add_u32 m0, s50, 1024
    s_nop 0
L_pad_12:
    s_cmp_eq_u32 s99, 1
    s_cbranch_scc1 L_padret_12
    buffer_load_dwordx4 v121, s[24:27], s51 offen sc1 lds
    s_add_u32 m0, s50, 2048
    s_nop 0
    buffer_load_dwordx4 v122, s[24:27], s51 offen sc1 lds
    s_add_u32 m0, s50, 3072
    s_nop 0
    buffer_load_dwordx4 v123, s[24:27], s51 offen sc1 lds
    s_add_u32 m0, s50, 4096
    s_nop 0
    buffer_load_dwordx4 v124, s[24:27], s51 offen sc1 lds
    s_add_u32 m0, s50, 5120
    s_nop 0
    buffer_load_dwordx4 v125, s[24:27], s51 offen sc1 lds
    s_add_u32 m0, s50, 6144
    s_nop 0
    buffer_load_dwordx4 v126, s[24:27], s51 offen sc1 lds
    s_add_u32 m0, s50, 7168
    s_nop 0
    buffer_load_dwordx4 v127, s[24:27], s51 offen sc1 lds
    s_waitcnt vmcnt(32)
    s_mov_b32 s53, 768
    s_mov_b32 s55, 49152
    s_mov_b32 s47, 5
    s_mov_b32 s52, 2293760
    s_mov_b32 s54, 32768
    s_mov_b32 s44, 11
L_lda_35:
    s_barrier
    s_mul_i32 s50, s30, 8192
    s_add_u32 s50, s50, s55
    s_add_u32 m0, s50, 0
    s_nop 0
    buffer_load_dwordx4 v128, s[8:11], s53 offen sc1 lds
    s_add_u32 m0, s50, 1024
    s_nop 0
    buffer_load_dwordx4 v129, s[8:11], s53 offen sc1 lds
    s_add_u32 m0, s50, 2048
    s_nop 0
    buffer_load_dwordx4 v130, s[8:11], s53 offen sc1 lds
    s_add_u32 m0, s50, 3072
    s_nop 0
    buffer_load_dwordx4 v131, s[8:11], s53 offen sc1 lds
    s_add_u32 m0, s50, 4096
    s_nop 0
    buffer_load_dwordx4 v132, s[8:11], s53 offen sc1 lds
    s_add_u32 m0, s50, 5120
    s_nop 0
    buffer_load_dwordx4 v133, s[8:11], s53 offen sc1 lds
    s_add_u32 m0, s50, 6144
    s_nop 0
    buffer_load_dwordx4 v134, s[8:11], s53 offen sc1 lds
    s_add_u32 m0, s50, 7168
    s_nop 0
    buffer_load_dwordx4 v135, s[8:11], s53 offen sc1 lds
    s_mul_i32 s50, s30, 8192
    s_add_u32 s50, s50, s54
    s_add_u32 m0, s50, 0
    s_nop 0
    buffer_load_dwordx4 v120, s[24:27], s52 offen sc1 lds
    s_add_u32 m0, s50, 1024
    s_nop 0
    buffer_load_dwordx4 v121, s[24:27], s52 offen sc1 lds
    s_add_u32 m0, s50, 2048
    s_nop 0
    buffer_load_dwordx4 v122, s[24:27], s52 offen sc1 lds
    s_add_u32 m0, s50, 3072
    s_nop 0
    buffer_load_dwordx4 v123, s[24:27], s52 offen sc1 lds
    s_add_u32 m0, s50, 4096
    s_nop 0
    buffer_load_dwordx4 v124, s[24:27], s52 offen sc1 lds
    s_add_u32 m0, s50, 5120
    s_nop 0
    buffer_load_dwordx4 v125, s[24:27], s52 offen sc1 lds
    s_add_u32 m0, s50, 6144
    s_nop 0
    buffer_load_dwordx4 v126, s[24:27], s52 offen sc1 lds
    s_add_u32 m0, s50, 7168
    s_nop 0
    buffer_load_dwordx4 v127, s[24:27], s52 offen sc1 lds
    s_add_u32 s47, s47, 1
    s_add_u32 s51, s47, 4
    s_mul_i32 s51, s51, 37
    s_lshr_b32 s51, s51, 8
    s_add_u32 s53, s47, s51
    s_lshl_b32 s53, s53, 7
    s_add_u32 s55, s55, 32768
    s_cmp_eq_u32 s55, 147456
    s_cselect_b32 s55, 16384, s55
    s_add_u32 s52, s52, 458752
    s_add_u32 s54, s54, 32768
    s_cmp_eq_u32 s54, 131072
    s_cselect_b32 s54, 0, s54
    s_sub_u32 s44, s44, 1
    s_cmp_lg_u32 s44, 0
    s_waitcnt vmcnt(32)
    s_cbranch_scc1 L_lda_35
    s_barrier
    s_mul_i32 s50, s30, 8192
    s_mov_b32 s51, 0
    s_add_u32 m0, s50, 16384
    s_nop 0
    buffer_load_dwordx4 v144, s[16:19], s51 offen  lds
    s_add_u32 m0, s50, 17408
    s_nop 0
    buffer_load_dwordx4 v145, s[16:19], s51 offen  lds
    s_add_u32 m0, s50, 18432
    s_nop 0
    buffer_load_dwordx4 v146, s[16:19], s51 offen  lds
    s_add_u32 m0, s50, 19456
    s_nop 0
    buffer_load_dwordx4 v147, s[16:19], s51 offen  lds
    s_add_u32 m0, s50, 20480
    s_nop 0
    buffer_load_dwordx4 v148, s[16:19], s51 offen  lds
    s_add_u32 m0, s50, 21504
    s_nop 0
    buffer_load_dwordx4 v149, s[16:19], s51 offen  lds
    s_add_u32 m0, s50, 22528
    s_nop 0
    buffer_load_dwordx4 v150, s[16:19], s51 offen  lds
    s_add_u32 m0, s50, 23552
    s_nop 0
    buffer_load_dwordx4 v151, s[16:19], s51 offen  lds
    s_waitcnt vmcnt(24)
    s_barrier
    s_mul_i32 s50, s30, 8192
    s_mov_b32 s51, 128
    s_add_u32 m0, s50, 49152
    s_nop 0
    buffer_load_dwordx4 v144, s[16:19], s51 offen  lds
    s_add_u32 m0, s50, 50176
    s_nop 0
    buffer_load_dwordx4 v145, s[16:19], s51 offen  lds
    s_add_u32 m0, s50, 51200
    s_nop 0
    buffer_load_dwordx4 v146, s[16:19], s51 offen  lds
    s_add_u32 m0, s50, 52224
    s_nop 0
    buffer_load_dwordx4 v147, s[16:19], s51 offen  lds
    s_add_u32 m0, s50, 53248
    s_nop 0
    buffer_load_dwordx4 v148, s[16:19], s51 offen  lds
    s_add_u32 m0, s50, 54272
    s_nop 0
    buffer_load_dwordx4 v149, s[16:19], s51 offen  lds
    s_add_u32 m0, s50, 55296
    s_nop 0
    buffer_load_dwordx4 v150, s[16:19], s51 offen  lds
    s_add_u32 m0, s50, 56320
    s_nop 0
    buffer_load_dwordx4 v151, s[16:19], s51 offen  lds
    s_waitcnt vmcnt(16)
    s_barrier
    s_mul_i32 s50, s30, 8192
    s_mov_b32 s51, 256
    s_add_u32 m0, s50, 81920
    s_nop 0
    buffer_load_dwordx4 v144, s[16:19], s51 offen  lds
    s_add_u32 m0, s50, 82944
    s_nop 0
    buffer_load_dwordx4 v145, s[16:19], s51 offen  lds
    s_add_u32 m0, s50, 83968
    s_nop 0
    buffer_load_dwordx4 v146, s[16:19], s51 offen  lds
    s_add_u32 m0, s50, 84992
    s_nop 0
    buffer_load_dwordx4 v147, s[16:19], s51 offen  lds
    s_add_u32 m0, s50, 86016
    s_nop 0
    buffer_load_dwordx4 v148, s[16:19], s51 offen  lds
    s_add_u32 m0, s50, 87040
    s_nop 0
    buffer_load_dwordx4 v149, s[16:19], s51 offen  lds
    s_add_u32 m0, s50, 88064
    s_nop 0
    buffer_load_dwordx4 v150, s[16:19], s51 offen  lds
    s_add_u32 m0, s50, 89088
    s_nop 0
    buffer_load_dwordx4 v151, s[16:19], s51 offen  lds
    s_barrier
    s_mul_i32 s50, s30, 8192
    s_mov_b32 s51, 0
    s_add_u32 m0, s50, 0
    s_nop 0
    buffer_load_dwordx4 v136, s[8:11], s51 offen sc1 lds
    s_add_u32 m0, s50, 1024
    s_nop 0
    buffer_load_dwordx4 v137, s[8:11], s51 offen sc1 lds
    s_add_u32 m0, s50, 2048
    s_nop 0
    buffer_load_dwordx4 v138, s[8:11], s51 offen sc1 lds
    s_add_u32 m0, s50, 3072
    s_nop 0
    buffer_load_dwordx4 v139, s[8:11], s51 offen sc1 lds
    s_add_u32 m0, s50, 4096
    s_nop 0
    buffer_load_dwordx4 v140, s[8:11], s51 offen sc1 lds
    s_add_u32 m0, s50, 5120
    s_nop 0
    buffer_load_dwordx4 v141, s[8:11], s51 offen sc1 lds
    s_add_u32 m0, s50, 6144
    s_nop 0
    buffer_load_dwordx4 v142, s[8:11], s51 offen sc1 lds
    s_add_u32 m0, s50, 7168
    s_nop 0
    buffer_load_dwordx4 v143, s[8:11], s51 offen sc1 lds
    s_mul_i32 s50, s30, 8192
    s_mov_b32 s51, 262144
    s_add_u32 m0, s50, 32768
    s_nop 0
    buffer_load_dwordx4 v136, s[8:11], s51 offen sc1 lds
    s_add_u32 m0, s50, 33792
    s_nop 0
    buffer_load_dwordx4 v137, s[8:11], s51 offen sc1 lds
    s_add_u32 m0, s50, 34816
    s_nop 0
    buffer_load_dwordx4 v138, s[8:11], s51 offen sc1 lds
    s_add_u32 m0, s50, 35840
    s_nop 0
    buffer_load_dwordx4 v139, s[8:11], s51 offen sc1 lds
    s_add_u32 m0, s50, 36864
    s_nop 0
    buffer_load_dwordx4 v140, s[8:11], s51 offen sc1 lds
    s_add_u32 m0, s50, 37888
    s_nop 0
    buffer_load_dwordx4 v141, s[8:11], s51 offen sc1 lds
    s_add_u32 m0, s50, 38912
    s_nop 0
    buffer_load_dwordx4 v142, s[8:11], s51 offen sc1 lds
    s_add_u32 m0, s50, 39936
    s_nop 0
    buffer_load_dwordx4 v143, s[8:11], s51 offen sc1 lds
    s_mul_i32 s50, s30, 8192
    s_mov_b32 s51, 524288
    s_add_u32 m0, s50, 65536
    s_nop 0
    buffer_load_dwordx4 v136, s[8:11], s51 offen sc1 lds
    s_add_u32 m0, s50, 66560
    s_nop 0
    buffer_load_dwordx4 v137, s[8:11], s51 offen sc1 lds
    s_add_u32 m0, s50, 67584
    s_nop 0
    buffer_load_dwordx4 v138, s[8:11], s51 offen sc1 lds
    s_add_u32 m0, s50, 68608
    s_nop 0
    buffer_load_dwordx4 v139, s[8:11], s51 offen sc1 lds
    s_add_u32 m0, s50, 69632
    s_nop 0
    buffer_load_dwordx4 v140, s[8:11], s51 offen sc1 lds
    s_add_u32 m0, s50, 70656
    s_nop 0
    buffer_load_dwordx4 v141, s[8:11], s51 offen sc1 lds
    s_add_u32 m0, s50, 71680
    s_nop 0
    buffer_load_dwordx4 v142, s[8:11], s51 offen sc1 lds
    s_add_u32 m0, s50, 72704
    s_nop 0
    buffer_load_dwordx4 v143, s[8:11], s51 offen sc1 lds
    s_waitcnt vmcnt(16)
    s_barrier
    s_mul_i32 s50, s30, 8192
    s_mov_b32 s51, 786432
    s_add_u32 m0, s50, 98304
    s_nop 0
    buffer_load_dwordx4 v136, s[8:11], s51 offen sc1 lds
    s_add_u32 m0, s50, 99328
    s_nop 0
    buffer_load_dwordx4 v137, s[8:11], s51 offen sc1 lds
    s_add_u32 m0, s50, 100352
    s_nop 0
    buffer_load_dwordx4 v138, s[8:11], s51 offen sc1 lds
    s_add_u32 m0, s50, 101376
    s_nop 0
    buffer_load_dwordx4 v139, s[8:11], s51 offen sc1 lds
    s_add_u32 m0, s50, 102400
    s_nop 0
    buffer_load_dwordx4 v140, s[8:11], s51 offen sc1 lds
    s_add_u32 m0, s50, 103424
    s_nop 0
    buffer_load_dwordx4 v141, s[8:11], s51 offen sc1 lds
    s_add_u32 m0, s50, 104448
    s_nop 0
    buffer_load_dwordx4 v142, s[8:11], s51 offen sc1 lds
    s_add_u32 m0, s50, 105472
    s_nop 0
    buffer_load_dwordx4 v143, s[8:11], s51 offen sc1 lds
    s_mul_i32 s50, s30, 8192
    s_mov_b32 s51, 384
    s_add_u32 m0, s50, 114688
    s_nop 0
    buffer_load_dwordx4 v144, s[16:19], s51 offen  lds
    s_add_u32 m0, s50, 115712
    s_nop 0
    buffer_load_dwordx4 v145, s[16:19], s51 offen  lds
    s_add_u32 m0, s50, 116736
    s_nop 0
    buffer_load_dwordx4 v146, s[16:19], s51 offen  lds
    s_add_u32 m0, s50, 117760
    s_nop 0
    buffer_load_dwordx4 v147, s[16:19], s51 offen  lds
    s_add_u32 m0, s50, 118784
    s_nop 0
    buffer_load_dwordx4 v148, s[16:19], s51 offen  lds
    s_add_u32 m0, s50, 119808
    s_nop 0
    buffer_load_dwordx4 v149, s[16:19], s51 offen  lds
    s_add_u32 m0, s50, 120832
    s_nop 0
    buffer_load_dwordx4 v150, s[16:19], s51 offen  lds
    s_add_u32 m0, s50, 121856
    s_nop 0
    buffer_load_dwordx4 v151, s[16:19], s51 offen  lds
    s_waitcnt vmcnt(24)
    s_mov_b32 s52, 1048576
    s_mov_b32 s54, 0
    s_mov_b32 s53, 512
    s_mov_b32 s55, 16384
    s_mov_b32 s44, 28
L_lda_36:
    s_barrier
    s_mul_i32 s50, s30, 8192
    s_add_u32 s50, s50, s54
    s_add_u32 m0, s50, 0
    s_nop 0
    buffer_load_dwordx4 v136, s[8:11], s52 offen sc1 lds
    s_add_u32 m0, s50, 1024
    s_nop 0
    buffer_load_dwordx4 v137, s[8:11], s52 offen sc1 lds
    s_add_u32 m0, s50, 2048
    s_nop 0
    buffer_load_dwordx4 v138, s[8:11], s52 offen sc1 lds
    s_add_u32 m0, s50, 3072
    s_nop 0
    buffer_load_dwordx4 v139, s[8:11], s52 offen sc1 lds
    s_add_u32 m0, s50, 4096
    s_nop 0
    buffer_load_dwordx4 v140, s[8:11], s52 offen sc1 lds
    s_add_u32 m0, s50, 5120
    s_nop 0
    buffer_load_dwordx4 v141, s[8:11], s52 offen sc1 lds
    s_add_u32 m0, s50, 6144
    s_nop 0
    buffer_load_dwordx4 v142, s[8:11], s52 offen sc1 lds
    s_add_u32 m0, s50, 7168
    s_nop 0
    buffer_load_dwordx4 v143, s[8:11], s52 offen sc1 lds
    s_mul_i32 s50, s30, 8192
    s_add_u32 s50, s50, s55
    s_add_u32 m0, s50, 0
    s_nop 0
    buffer_load_dwordx4 v144, s[16:19], s53 offen  lds
    s_add_u32 m0, s50, 1024
    s_nop 0
    buffer_load_dwordx4 v145, s[16:19], s53 offen  lds
    s_add_u32 m0, s50, 2048
    s_nop 0
    buffer_load_dwordx4 v146, s[16:19], s53 offen  lds
    s_add_u32 m0, s50, 3072
    s_nop 0
    buffer_load_dwordx4 v147, s[16:19], s53 offen  lds
    s_add_u32 m0, s50, 4096
    s_nop 0
    buffer_load_dwordx4 v148, s[16:19], s53 offen  lds
    s_add_u32 m0, s50, 5120
    s_nop 0
    buffer_load_dwordx4 v149, s[16:19], s53 offen  lds
    s_add_u32 m0, s50, 6144
    s_nop 0
    buffer_load_dwordx4 v150, s[16:19], s53 offen  lds
    s_add_u32 m0, s50, 7168
    s_nop 0
    buffer_load_dwordx4 v151, s[16:19], s53 offen  lds
    s_add_u32 s52, s52, 262144
    s_add_u32 s54, s54, 32768
    s_cmp_eq_u32 s54, 131072
    s_cselect_b32 s54, 0, s54
    s_add_u32 s53, s53, 128
    s_add_u32 s55, s55, 32768
    s_cmp_eq_u32 s55, 147456
    s_cselect_b32 s55, 16384, s55
    s_sub_u32 s44, s44, 1
    s_cmp_lg_u32 s44, 0
    s_waitcnt vmcnt(32)
    s_cbranch_scc1 L_lda_36
    s_barrier
    s_waitcnt vmcnt(16)
    s_barrier
    s_waitcnt vmcnt(0)
    s_barrier
    s_mul_i32 s50, s30, 8192
    s_mov_b32 s51, 0
    s_add_u32 m0, s50, 0
    s_nop 0
    buffer_load_dwordx4 v152, s[20:23], s51 offen sc1 lds
    s_add_u32 m0, s50, 1024
    s_nop 0
    buffer_load_dwordx4 v153, s[20:23], s51 offen sc1 lds
    s_add_u32 m0, s50, 2048
    s_nop 0
    buffer_load_dwordx4 v154, s[20:23], s51 offen sc1 lds
    s_add_u32 m0, s50, 3072
    s_nop 0
    buffer_load_dwordx4 v155, s[20:23], s51 offen sc1 lds
    s_add_u32 m0, s50, 4096
    s_nop 0
    buffer_load_dwordx4 v156, s[20:23], s51 offen sc1 lds
    s_add_u32 m0, s50, 5120
    s_nop 0
    buffer_load_dwordx4 v157, s[20:23], s51 offen sc1 lds
    s_add_u32 m0, s50, 6144
    s_nop 0
    buffer_load_dwordx4 v158, s[20:23], s51 offen sc1 lds
    s_add_u32 m0, s50, 7168
    s_nop 0
    buffer_load_dwordx4 v159, s[20:23], s51 offen sc1 lds
    s_mul_i32 s50, s30, 8192
    s_mov_b32 s51, 131072
    s_add_u32 m0, s50, 16384
    s_nop 0
    buffer_load_dwordx4 v152, s[20:23], s51 offen sc1 lds
    s_add_u32 m0, s50, 17408
    s_nop 0
    buffer_load_dwordx4 v153, s[20:23], s51 offen sc1 lds
    s_add_u32 m0, s50, 18432
    s_nop 0
    buffer_load_dwordx4 v154, s[20:23], s51 offen sc1 lds
    s_add_u32 m0, s50, 19456
    s_nop 0
    buffer_load_dwordx4 v155, s[20:23], s51 offen sc1 lds
    s_add_u32 m0, s50, 20480
    s_nop 0
    buffer_load_dwordx4 v156, s[20:23], s51 offen sc1 lds
    s_add_u32 m0, s50, 21504
    s_nop 0
    buffer_load_dwordx4 v157, s[20:23], s51 offen sc1 lds
    s_add_u32 m0, s50, 22528
    s_nop 0
    buffer_load_dwordx4 v158, s[20:23], s51 offen sc1 lds
    s_add_u32 m0, s50, 23552
    s_nop 0
    buffer_load_dwordx4 v159, s[20:23], s51 offen sc1 lds
    s_barrier
    s_mul_i32 s50, s30, 8192
    s_mov_b32 s51, 262144
    s_add_u32 m0, s50, 32768
    s_nop 0
    buffer_load_dwordx4 v152, s[20:23], s51 offen sc1 lds
    s_add_u32 m0, s50, 33792
    s_nop 0
    buffer_load_dwordx4 v153, s[20:23], s51 offen sc1 lds
    s_add_u32 m0, s50, 34816
    s_nop 0
    buffer_load_dwordx4 v154, s[20:23], s51 offen sc1 lds
    s_add_u32 m0, s50, 35840
    s_nop 0
    buffer_load_dwordx4 v155, s[20:23], s51 offen sc1 lds
    s_add_u32 m0, s50, 36864
    s_nop 0
    buffer_load_dwordx4 v156, s[20:23], s51 offen sc1 lds
    s_add_u32 m0, s50, 37888
    s_nop 0
    buffer_load_dwordx4 v157, s[20:23], s51 offen sc1 lds
    s_add_u32 m0, s50, 38912
    s_nop 0
    buffer_load_dwordx4 v158, s[20:23], s51 offen sc1 lds
    s_add_u32 m0, s50, 39936
    s_nop 0
    buffer_load_dwordx4 v159, s[20:23], s51 offen sc1 lds
    s_mul_i32 s50, s30, 8192
    s_mov_b32 s51, 393216
    s_add_u32 m0, s50, 49152
    s_nop 0
    buffer_load_dwordx4 v152, s[20:23], s51 offen sc1 lds
    s_add_u32 m0, s50, 50176
    s_nop 0
    buffer_load_dwordx4 v153, s[20:23], s51 offen sc1 lds
    s_add_u32 m0, s50, 51200
    s_nop 0
    buffer_load_dwordx4 v154, s[20:23], s51 offen sc1 lds
    s_add_u32 m0, s50, 52224
    s_nop 0
    buffer_load_dwordx4 v155, s[20:23], s51 offen sc1 lds
    s_add_u32 m0, s50, 53248
    s_nop 0
    buffer_load_dwordx4 v156, s[20:23], s51 offen sc1 lds
    s_add_u32 m0, s50, 54272
    s_nop 0
    buffer_load_dwordx4 v157, s[20:23], s51 offen sc1 lds
    s_add_u32 m0, s50, 55296
    s_nop 0
    buffer_load_dwordx4 v158, s[20:23], s51 offen sc1 lds
    s_add_u32 m0, s50, 56320
    s_nop 0
    buffer_load_dwordx4 v159, s[20:23], s51 offen sc1 lds
    s_mul_i32 s50, s30, 8192
    s_mov_b32 s51, 524288
    s_add_u32 m0, s50, 65536
    s_nop 0
    buffer_load_dwordx4 v152, s[20:23], s51 offen sc1 lds
    s_add_u32 m0, s50, 66560
    s_nop 0
    buffer_load_dwordx4 v153, s[20:23], s51 offen sc1 lds
    s_add_u32 m0, s50, 67584
    s_nop 0
    buffer_load_dwordx4 v154, s[20:23], s51 offen sc1 lds
    s_add_u32 m0, s50, 68608
    s_nop 0
    buffer_load_dwordx4 v155, s[20:23], s51 offen sc1 lds
    s_add_u32 m0, s50, 69632
    s_nop 0
    buffer_load_dwordx4 v156, s[20:23], s51 offen sc1 lds
    s_add_u32 m0, s50, 70656
    s_nop 0
    buffer_load_dwordx4 v157, s[20:23], s51 offen sc1 lds
    s_add_u32 m0, s50, 71680
    s_nop 0
    buffer_load_dwordx4 v158, s[20:23], s51 offen sc1 lds
    s_add_u32 m0, s50, 72704
    s_nop 0
    buffer_load_dwordx4 v159, s[20:23], s51 offen sc1 lds
    s_mul_i32 s50, s30, 8192
    s_mov_b32 s51, 655360
    s_add_u32 m0, s50, 81920
    s_nop 0
    buffer_load_dwordx4 v152, s[20:23], s51 offen sc1 lds
    s_add_u32 m0, s50, 82944
    s_nop 0
    buffer_load_dwordx4 v153, s[20:23], s51 offen sc1 lds
    s_add_u32 m0, s50, 83968
    s_nop 0
    buffer_load_dwordx4 v154, s[20:23], s51 offen sc1 lds
    s_add_u32 m0, s50, 84992
    s_nop 0
    buffer_load_dwordx4 v155, s[20:23], s51 offen sc1 lds
    s_add_u32 m0, s50, 86016
    s_nop 0
    buffer_load_dwordx4 v156, s[20:23], s51 offen sc1 lds
    s_add_u32 m0, s50, 87040
    s_nop 0
    buffer_load_dwordx4 v157, s[20:23], s51 offen sc1 lds
    s_add_u32 m0, s50, 88064
    s_nop 0
    buffer_load_dwordx4 v158, s[20:23], s51 offen sc1 lds
    s_add_u32 m0, s50, 89088
    s_nop 0
    buffer_load_dwordx4 v159, s[20:23], s51 offen sc1 lds
    s_waitcnt vmcnt(32)
    s_mul_i32 s50, s30, 8192
    s_mov_b32 s51, 786432
    s_add_u32 m0, s50, 98304
    s_nop 0
    buffer_load_dwordx4 v152, s[20:23], s51 offen sc1 lds
    s_add_u32 m0, s50, 99328
    s_nop 0
    buffer_load_dwordx4 v153, s[20:23], s51 offen sc1 lds
    s_add_u32 m0, s50, 100352
    s_nop 0
    buffer_load_dwordx4 v154, s[20:23], s51 offen sc1 lds
    s_add_u32 m0, s50, 101376
    s_nop 0
    buffer_load_dwordx4 v155, s[20:23], s51 offen sc1 lds
    s_add_u32 m0, s50, 102400
    s_nop 0
    buffer_load_dwordx4 v156, s[20:23], s51 offen sc1 lds
    s_add_u32 m0, s50, 103424
    s_nop 0
    buffer_load_dwordx4 v157, s[20:23], s51 offen sc1 lds
    s_add_u32 m0, s50, 104448
    s_nop 0
    buffer_load_dwordx4 v158, s[20:23], s51 offen sc1 lds
    s_add_u32 m0, s50, 105472
    s_nop 0
    buffer_load_dwordx4 v159, s[20:23], s51 offen sc1 lds
    s_mul_i32 s50, s30, 8192
    s_mov_b32 s51, 917504
    s_add_u32 m0, s50, 114688
    s_nop 0
    buffer_load_dwordx4 v152, s[20:23], s51 offen sc1 lds
    s_add_u32 m0, s50, 115712
    s_nop 0
    buffer_load_dwordx4 v153, s[20:23], s51 offen sc1 lds
    s_add_u32 m0, s50, 116736
    s_nop 0
    buffer_load_dwordx4 v154, s[20:23], s51 offen sc1 lds
    s_add_u32 m0, s50, 117760
    s_nop 0
    buffer_load_dwordx4 v155, s[20:23], s51 offen sc1 lds
    s_add_u32 m0, s50, 118784
    s_nop 0
    buffer_load_dwordx4 v156, s[20:23], s51 offen sc1 lds
    s_add_u32 m0, s50, 119808
    s_nop 0
    buffer_load_dwordx4 v157, s[20:23], s51 offen sc1 lds
    s_add_u32 m0, s50, 120832
    s_nop 0
    buffer_load_dwordx4 v158, s[20:23], s51 offen sc1 lds
    s_add_u32 m0, s50, 121856
    s_nop 0
    buffer_load_dwordx4 v159, s[20:23], s51 offen sc1 lds
L_L3:
    s_waitcnt vmcnt(40)
    s_barrier
    s_mul_i32 s50, s30, 4096
    s_mov_b32 s51, 0
    s_add_u32 m0, s50, 131072
    s_nop 0
    buffer_load_dwordx4 v160, s[8:11], s51 offen sc1 lds
    s_add_u32 m0, s50, 132096
    s_nop 0
    buffer_load_dwordx4 v161, s[8:11], s51 offen sc1 lds
    s_add_u32 m0, s50, 133120
    s_nop 0
    buffer_load_dwordx4 v162, s[8:11], s51 offen sc1 lds
    s_add_u32 m0, s50, 134144
    s_nop 0
    buffer_load_dwordx4 v163, s[8:11], s51 offen sc1 lds
    s_mul_i32 s50, s30, 4096
    s_mov_b32 s51, 128
    s_add_u32 m0, s50, 139264
    s_nop 0
    buffer_load_dwordx4 v160, s[8:11], s51 offen sc1 lds
    s_add_u32 m0, s50, 140288
    s_nop 0
    buffer_load_dwordx4 v161, s[8:11], s51 offen sc1 lds
    s_add_u32 m0, s50, 141312
    s_nop 0
L_pad_13:
    s_cmp_eq_u32 s99, 1
    s_cbranch_scc1 L_padret_13
    buffer_load_dwordx4 v162, s[8:11], s51 offen sc1 lds
    s_add_u32 m0, s50, 142336
    s_nop 0
    buffer_load_dwordx4 v163, s[8:11], s51 offen sc1 lds
    s_mul_i32 s50, s30, 4096
    s_mov_b32 s51, 256
    s_add_u32 m0, s50, 147456
    s_nop 0
    buffer_load_dwordx4 v160, s[8:11], s51 offen sc1 lds
    s_add_u32 m0, s50, 148480
    s_nop 0
    buffer_load_dwordx4 v161, s[8:11], s51 offen sc1 lds
    s_add_u32 m0, s50, 149504
    s_nop 0
    buffer_load_dwordx4 v162, s[8:11], s51 offen sc1 lds
    s_add_u32 m0, s50, 150528
    s_nop 0
    buffer_load_dwordx4 v163, s[8:11], s51 offen sc1 lds
    s_waitcnt vmcnt(8)
    s_barrier
    s_mul_i32 s50, s30, 4096
    s_mov_b32 s51, 512
    s_add_u32 m0, s50, 155648
    s_nop 0
    buffer_load_dwordx4 v160, s[8:11], s51 offen sc1 lds
    s_add_u32 m0, s50, 156672
    s_nop 0
    buffer_load_dwordx4 v161, s[8:11], s51 offen sc1 lds
    s_add_u32 m0, s50, 157696
    s_nop 0
    buffer_load_dwordx4 v162, s[8:11], s51 offen sc1 lds
    s_add_u32 m0, s50, 158720
    s_nop 0
    buffer_load_dwordx4 v163, s[8:11], s51 offen sc1 lds
    s_waitcnt vmcnt(8)
    s_barrier
    s_mul_i32 s50, s30, 4096
    s_mov_b32 s51, 640
    s_add_u32 m0, s50, 131072
    s_nop 0
    buffer_load_dwordx4 v160, s[8:11], s51 offen sc1 lds
    s_add_u32 m0, s50, 132096
    s_nop 0
    buffer_load_dwordx4 v161, s[8:11], s51 offen sc1 lds
    s_add_u32 m0, s50, 133120
    s_nop 0
    buffer_load_dwordx4 v162, s[8:11], s51 offen sc1 lds
    s_add_u32 m0, s50, 134144
    s_nop 0
    buffer_load_dwordx4 v163, s[8:11], s51 offen sc1 lds
    s_mul_i32 s50, s30, 8192
    s_mov_b32 s51, 1048576
    s_add_u32 m0, s50, 0
    s_nop 0
    buffer_load_dwordx4 v152, s[20:23], s51 offen sc1 lds
    s_add_u32 m0, s50, 1024
    s_nop 0
    buffer_load_dwordx4 v153, s[20:23], s51 offen sc1 lds
    s_add_u32 m0, s50, 2048
    s_nop 0
    buffer_load_dwordx4 v154, s[20:23], s51 offen sc1 lds
    s_add_u32 m0, s50, 3072
    s_nop 0
    buffer_load_dwordx4 v155, s[20:23], s51 offen sc1 lds
    s_add_u32 m0, s50, 4096
    s_nop 0
    buffer_load_dwordx4 v156, s[20:23], s51 offen sc1 lds
    s_add_u32 m0, s50, 5120
    s_nop 0
    buffer_load_dwordx4 v157, s[20:23], s51 offen sc1 lds
    s_add_u32 m0, s50, 6144
    s_nop 0
    buffer_load_dwordx4 v158, s[20:23], s51 offen sc1 lds
    s_add_u32 m0, s50, 7168
    s_nop 0
    buffer_load_dwordx4 v159, s[20:23], s51 offen sc1 lds
    s_waitcnt vmcnt(16)
    s_barrier
    s_mul_i32 s50, s30, 4096
    s_mov_b32 s51, 768
    s_add_u32 m0, s50, 139264
    s_nop 0
    buffer_load_dwordx4 v160, s[8:11], s51 offen sc1 lds
    s_add_u32 m0, s50, 140288
    s_nop 0
    buffer_load_dwordx4 v161, s[8:11], s51 offen sc1 lds
    s_add_u32 m0, s50, 141312
    s_nop 0
    buffer_load_dwordx4 v162, s[8:11], s51 offen sc1 lds
    s_add_u32 m0, s50, 142336
    s_nop 0
    buffer_load_dwordx4 v163, s[8:11], s51 offen sc1 lds
    s_mul_i32 s50, s30, 8192
    s_mov_b32 s51, 1179648
    s_add_u32 m0, s50, 16384
    s_nop 0
    buffer_load_dwordx4 v152, s[20:23], s51 offen sc1 lds
    s_add_u32 m0, s50, 17408
    s_nop 0
    buffer_load_dwordx4 v153, s[20:23], s51 offen sc1 lds
    s_add_u32 m0, s50, 18432
    s_nop 0
    buffer_load_dwordx4 v154, s[20:23], s51 offen sc1 lds
    s_add_u32 m0, s50, 19456
    s_nop 0
    buffer_load_dwordx4 v155, s[20:23], s51 offen sc1 lds
    s_add_u32 m0, s50, 20480
    s_nop 0
    buffer_load_dwordx4 v156, s[20:23], s51 offen sc1 lds
    s_add_u32 m0, s50, 21504
    s_nop 0
    buffer_load_dwordx4 v157, s[20:23], s51 offen sc1 lds
    s_add_u32 m0, s50, 22528
    s_nop 0
    buffer_load_dwordx4 v158, s[20:23], s51 offen sc1 lds
    s_add_u32 m0, s50, 23552
    s_nop 0
    buffer_load_dwordx4 v159, s[20:23], s51 offen sc1 lds
    s_waitcnt vmcnt(24)
    s_mov_b32 s53, 896
    s_mov_b32 s55, 147456
    s_mov_b32 s47, 6
    s_mov_b32 s52, 1310720
    s_mov_b32 s54, 32768
    s_mov_b32 s44, 18
L_ldc_37:
    s_barrier
    s_mul_i32 s50, s30, 4096
    s_add_u32 s50, s50, s55
    s_add_u32 m0, s50, 0
    s_nop 0
    buffer_load_dwordx4 v160, s[8:11], s53 offen sc1 lds
    s_add_u32 m0, s50, 1024
    s_nop 0
    buffer_load_dwordx4 v161, s[8:11], s53 offen sc1 lds
    s_add_u32 m0, s50, 2048
    s_nop 0
    buffer_load_dwordx4 v162, s[8:11], s53 offen sc1 lds
    s_add_u32 m0, s50, 3072
    s_nop 0
    buffer_load_dwordx4 v163, s[8:11], s53 offen sc1 lds
    s_mul_i32 s50, s30, 8192
    s_add_u32 s50, s50, s54
    s_add_u32 m0, s50, 0
    s_nop 0
    buffer_load_dwordx4 v152, s[20:23], s52 offen sc1 lds
    s_add_u32 m0, s50, 1024
    s_nop 0
    buffer_load_dwordx4 v153, s[20:23], s52 offen sc1 lds
    s_add_u32 m0, s50, 2048
    s_nop 0
    buffer_load_dwordx4 v154, s[20:23], s52 offen sc1 lds
    s_add_u32 m0, s50, 3072
    s_nop 0
    buffer_load_dwordx4 v155, s[20:23], s52 offen sc1 lds
    s_add_u32 m0, s50, 4096
    s_nop 0
    buffer_load_dwordx4 v156, s[20:23], s52 offen sc1 lds
    s_add_u32 m0, s50, 5120
    s_nop 0
    buffer_load_dwordx4 v157, s[20:23], s52 offen sc1 lds
    s_add_u32 m0, s50, 6144
    s_nop 0
    buffer_load_dwordx4 v158, s[20:23], s52 offen sc1 lds
    s_add_u32 m0, s50, 7168
    s_nop 0
    buffer_load_dwordx4 v159, s[20:23], s52 offen sc1 lds
    s_add_u32 s47, s47, 1
    s_add_u32 s51, s47, 4
    s_mul_i32 s51, s51, 37
    s_lshr_b32 s51, s51, 8
    s_add_u32 s53, s47, s51
    s_lshl_b32 s53, s53, 7
    s_add_u32 s55, s55, 8192
    s_cmp_eq_u32 s55, 163840
    s_cselect_b32 s55, 131072, s55
    s_add_u32 s52, s52, 131072
    s_add_u32 s54, s54, 16384
    s_cmp_eq_u32 s54, 131072
    s_cselect_b32 s54, 0, s54
    s_sub_u32 s44, s44, 1
    s_cmp_lg_u32 s44, 0
    s_waitcnt vmcnt(32)
    s_cbranch_scc1 L_ldc_37
    s_barrier
    s_mul_i32 s50, s30, 4096
    s_mov_b32 s51, 3584
    s_add_u32 m0, s50, 131072
    s_nop 0
    buffer_load_dwordx4 v160, s[8:11], s51 offen sc1 lds
    s_add_u32 m0, s50, 132096
    s_nop 0
    buffer_load_dwordx4 v161, s[8:11], s51 offen sc1 lds
    s_add_u32 m0, s50, 133120
    s_nop 0
    buffer_load_dwordx4 v162, s[8:11], s51 offen sc1 lds
    s_add_u32 m0, s50, 134144
    s_nop 0
    buffer_load_dwordx4 v163, s[8:11], s51 offen sc1 lds
    s_waitcnt vmcnt(24)
    s_barrier
    s_mul_i32 s50, s30, 4096
    s_mov_b32 s51, 3712
    s_add_u32 m0, s50, 139264
    s_nop 0
    buffer_load_dwordx4 v160, s[8:11], s51 offen sc1 lds
    s_add_u32 m0, s50, 140288
    s_nop 0
    buffer_load_dwordx4 v161, s[8:11], s51 offen sc1 lds
    s_add_u32 m0, s50, 141312
    s_nop 0
    buffer_load_dwordx4 v162, s[8:11], s51 offen sc1 lds
    s_add_u32 m0, s50, 142336
    s_nop 0
    buffer_load_dwordx4 v163, s[8:11], s51 offen sc1 lds
    s_waitcnt vmcnt(16)
    s_barrier
    s_mul_i32 s50, s30, 4096
    s_mov_b32 s51, 3840
    s_add_u32 m0, s50, 147456
    s_nop 0
    buffer_load_dwordx4 v160, s[8:11], s51 offen sc1 lds
    s_add_u32 m0, s50, 148480
    s_nop 0
    buffer_load_dwordx4 v161, s[8:11], s51 offen sc1 lds
    s_add_u32 m0, s50, 149504
    s_nop 0
    buffer_load_dwordx4 v162, s[8:11], s51 offen sc1 lds
    s_add_u32 m0, s50, 150528
    s_nop 0
    buffer_load_dwordx4 v163, s[8:11], s51 offen sc1 lds
    s_waitcnt vmcnt(8)
    s_barrier
    s_mul_i32 s50, s30, 4096
    s_mov_b32 s51, 3968
    s_add_u32 m0, s50, 155648
    s_nop 0
    buffer_load_dwordx4 v160, s[8:11], s51 offen sc1 lds
    s_add_u32 m0, s50, 156672
    s_nop 0
    buffer_load_dwordx4 v161, s[8:11], s51 offen sc1 lds
    s_add_u32 m0, s50, 157696
    s_nop 0
    buffer_load_dwordx4 v162, s[8:11], s51 offen sc1 lds
    s_add_u32 m0, s50, 158720
    s_nop 0
    buffer_load_dwordx4 v163, s[8:11], s51 offen sc1 lds
    s_waitcnt vmcnt(8)
    s_barrier
    s_waitcnt vmcnt(4)
    s_barrier
    s_waitcnt vmcnt(0)
    s_barrier
    s_branch L_end
L_X:
    s_sub_u32 s35, s3, 6
    s_lshl_b32 s35, s35, 6
    v_add_u32 v5, s35, v2
    v_lshlrev_b32 v6, 4, v5
    v_add_u32 v6, 156672, v6
    v_lshlrev_b32 v5, 3, v5
    v_add_u32 v7, 158720, v5
    s_mul_i32 s36, s58, 14336
    s_add_u32 s36, s36, 65536
    s_lshl_b32 s38, s59, 10
    s_add_u32 s38, s38, s36
    s_mov_b32 s55, 0
    s_cmp_lg_u32 s3, 7
    s_cbranch_scc1 L_skip_38
    s_lshl_b32 s37, s58, 4
    s_lshl_b32 s60, s37, 7
    s_add_u32 s60, s60, 393216
    v_min_u32 v250, 15, v2
    v_lshlrev_b32 v250, 7, v250
    s_mov_b32 s61, 0
L_poll_39:
    buffer_load_dword v251, v250, s[8:11], s60 offen sc1
    s_add_u32 s61, s61, 1
    s_cmp_gt_u32 s61, 30000
    s_cbranch_scc1 L_go_40
    s_waitcnt vmcnt(0)
    v_xor_b32 v251, s6, v251
    v_cmp_ne_u32 vcc, 0, v251
    s_cbranch_vccnz L_poll_39
L_go_40:
    s_waitcnt vmcnt(0)
L_skip_38:
    s_waitcnt vmcnt(0)
    s_barrier
    s_cmp_lg_u32 s3, 6
    s_cbranch_scc1 L_skip_41
    s_mov_b32 s99, 1
    s_branch L_pad_2
L_padret_2:
    s_mov_b32 s99, 0
L_skip_41:
    s_barrier
    s_barrier
    s_barrier
    s_barrier
    s_barrier
    s_barrier
    s_barrier
    s_barrier
    s_barrier
    s_barrier
    s_barrier
    s_barrier
    s_cmp_lg_u32 s3, 7
    s_cbranch_scc1 L_skip_42
    s_cmp_lg_u32 s5, 0
    s_cbranch_scc1 L_skip_42
    s_lshl_b32 s60, s7, 7
    s_add_u32 s60, s60, 524288
    v_mov_b32 v250, s6
    v_mov_b32 v251, 0
    s_mov_b64 exec, 1
    buffer_store_dword v250, v251, s[8:11], s60 offen sc1
    s_mov_b64 exec, -1
L_skip_42:
    s_barrier
    s_barrier
    s_barrier
    s_cmp_lg_u32 s3, 6
    s_cbranch_scc1 L_skip_43
    s_mov_b32 s99, 1
    s_branch L_pad_3
L_padret_3:
    s_mov_b32 s99, 0
L_skip_43:
    s_barrier
    s_barrier
    s_barrier
    s_barrier
    s_barrier
    s_cmp_lg_u32 s3, 6
    s_cbranch_scc1 L_skip_44
    s_mov_b32 s99, 1
    s_branch L_pad_4
L_padret_4:
    s_mov_b32 s99, 0
L_skip_44:
    s_barrier
    ds_read_b128 v[8:11], v6
    s_waitcnt lgkmcnt(0)
    v_add_f32 v8, v8, v10
    v_add_f32 v9, v9, v11
    v_cmp_o_f32 vcc, v9, v9
    v_mov_b32 v10, 0x7fc00000
    s_nop 0
    v_cndmask_b32 v9, v10, v9, vcc
    buffer_store_dwordx2 v[8:9], v5, s[8:11], s38 offen sc1
    s_barrier
    s_barrier
    s_barrier
    s_add_u32 s37, s36, 0
    buffer_load_dwordx2 v[12:13], v5, s[8:11], s37 offen offset:0 sc1
    buffer_load_dwordx2 v[14:15], v5, s[8:11], s37 offen offset:1024 sc1
    buffer_load_dwordx2 v[16:17], v5, s[8:11], s37 offen offset:2048 sc1
    buffer_load_dwordx2 v[18:19], v5, s[8:11], s37 offen offset:3072 sc1
    s_add_u32 s37, s36, 4096
    buffer_load_dwordx2 v[20:21], v5, s[8:11], s37 offen offset:0 sc1
    buffer_load_dwordx2 v[22:23], v5, s[8:11], s37 offen offset:1024 sc1
    buffer_load_dwordx2 v[24:25], v5, s[8:11], s37 offen offset:2048 sc1
    buffer_load_dwordx2 v[26:27], v5, s[8:11], s37 offen offset:3072 sc1
    s_add_u32 s37, s36, 8192
    buffer_load_dwordx2 v[28:29], v5, s[8:11], s37 offen offset:0 sc1
    buffer_load_dwordx2 v[30:31], v5, s[8:11], s37 offen offset:1024 sc1
    buffer_load_dwordx2 v[32:33], v5, s[8:11], s37 offen offset:2048 sc1
    buffer_load_dwordx2 v[34:35], v5, s[8:11], s37 offen offset:3072 sc1
    s_add_u32 s37, s36, 12288
    buffer_load_dwordx2 v[36:37], v5, s[8:11], s37 offen offset:0 sc1
    buffer_load_dwordx2 v[38:39], v5, s[8:11], s37 offen offset:1024 sc1
    s_barrier
    s_cmp_lg_u32 s3, 6
    s_cbranch_scc1 L_skip_45
    s_mov_b32 s99, 1
    s_branch L_pad_5
L_padret_5:
    s_mov_b32 s99, 0
L_skip_45:
    s_cmp_lg_u32 s55, 0
    s_cbranch_scc1 L_lno_48
    s_mov_b32 s39, 0
L_lnc_46:
    s_waitcnt vmcnt(0)
    v_max_u32 v8, v13, v15
    v_max3_u32 v8, v8, v17, v19
    v_max3_u32 v8, v8, v21, v23
    v_max3_u32 v8, v8, v25, v27
    v_max3_u32 v8, v8, v29, v31
    v_max3_u32 v8, v8, v33, v35
    v_max3_u32 v8, v8, v37, v39
    v_cmp_eq_u32 vcc, -1, v8
    s_add_u32 s39, s39, 1
    s_cmp_gt_u32 s39, 20000
    s_cbranch_scc1 L_lnf_47
    s_cbranch_vccz L_lnf_47
    s_add_u32 s37, s36, 0
    buffer_load_dwordx2 v[12:13], v5, s[8:11], s37 offen offset:0 sc1
    buffer_load_dwordx2 v[14:15], v5, s[8:11], s37 offen offset:1024 sc1
    buffer_load_dwordx2 v[16:17], v5, s[8:11], s37 offen offset:2048 sc1
    buffer_load_dwordx2 v[18:19], v5, s[8:11], s37 offen offset:3072 sc1
    s_add_u32 s37, s36, 4096
    buffer_load_dwordx2 v[20:21], v5, s[8:11], s37 offen offset:0 sc1
    buffer_load_dwordx2 v[22:23], v5, s[8:11], s37 offen offset:1024 sc1
    buffer_load_dwordx2 v[24:25], v5, s[8:11], s37 offen offset:2048 sc1
    buffer_load_dwordx2 v[26:27], v5, s[8:11], s37 offen offset:3072 sc1
    s_add_u32 s37, s36, 8192
    buffer_load_dwordx2 v[28:29], v5, s[8:11], s37 offen offset:0 sc1
    buffer_load_dwordx2 v[30:31], v5, s[8:11], s37 offen offset:1024 sc1
    buffer_load_dwordx2 v[32:33], v5, s[8:11], s37 offen offset:2048 sc1
    buffer_load_dwordx2 v[34:35], v5, s[8:11], s37 offen offset:3072 sc1
    s_add_u32 s37, s36, 12288
    buffer_load_dwordx2 v[36:37], v5, s[8:11], s37 offen offset:0 sc1
    buffer_load_dwordx2 v[38:39], v5, s[8:11], s37 offen offset:1024 sc1
    s_branch L_lnc_46
L_lnf_47:
    v_add_f32 v12, v12, v14
    v_add_f32 v13, v13, v15
    v_add_f32 v12, v12, v16
    v_add_f32 v13, v13, v17
    v_add_f32 v12, v12, v18
    v_add_f32 v13, v13, v19
    v_add_f32 v12, v12, v20
    v_add_f32 v13, v13, v21
    v_add_f32 v12, v12, v22
    v_add_f32 v13, v13, v23
    v_add_f32 v12, v12, v24
    v_add_f32 v13, v13, v25
    v_add_f32 v12, v12, v26
    v_add_f32 v13, v13, v27
    v_add_f32 v12, v12, v28
    v_add_f32 v13, v13, v29
    v_add_f32 v12, v12, v30
    v_add_f32 v13, v13, v31
    v_add_f32 v12, v12, v32
    v_add_f32 v13, v13, v33
    v_add_f32 v12, v12, v34
    v_add_f32 v13, v13, v35
    v_add_f32 v12, v12, v36
    v_add_f32 v13, v13, v37
    v_add_f32 v12, v12, v38
    v_add_f32 v13, v13, v39
    v_mul_f32 v12, 0x3a124925, v12
    v_mul_f32 v13, 0x3a124925, v13
    v_fma_f32 v13, -v12, v12, v13
    v_max_f32 v13, 0, v13
    v_add_f32 v13, 0x3727c5ac, v13
    v_rsq_f32 v8, v13
    s_nop 0
    v_mul_f32 v9, -v12, v8
    ds_write_b64 v7, v[8:9]
    s_mov_b32 s55, 1
    s_waitcnt lgkmcnt(0)
L_lno_48:
    s_barrier
    s_barrier
    s_barrier
    s_barrier
    s_barrier
    s_cmp_lg_u32 s3, 7
    s_cbranch_scc1 L_skip_49
    s_lshl_b32 s37, s59, 4
    s_add_u32 s37, s37, s58
    s_lshl_b32 s60, s37, 7
    s_add_u32 s60, s60, 425984
    v_mov_b32 v250, s6
    v_mov_b32 v251, 0
    s_mov_b64 exec, 1
    buffer_store_dword v250, v251, s[8:11], s60 offen sc1
    s_mov_b64 exec, -1
L_skip_49:
    s_barrier
    s_barrier
    s_cmp_lg_u32 s3, 7
    s_cbranch_scc1 L_skip_50
    s_lshl_b32 s37, s59, 4
    s_lshl_b32 s60, s37, 7
    s_add_u32 s60, s60, 425984
    v_min_u32 v250, 15, v2
    v_lshlrev_b32 v250, 7, v250
    s_mov_b32 s61, 0
L_poll_51:
    buffer_load_dword v251, v250, s[8:11], s60 offen sc1
    s_add_u32 s61, s61, 1
    s_cmp_gt_u32 s61, 30000
    s_cbranch_scc1 L_go_52
    s_waitcnt vmcnt(0)
    v_xor_b32 v251, s6, v251
    v_cmp_ne_u32 vcc, 0, v251
    s_cbranch_vccnz L_poll_51
L_go_52:
    s_waitcnt vmcnt(0)
L_skip_50:
    s_barrier
    s_cmp_lg_u32 s3, 6
    s_cbranch_scc1 L_skip_53
    s_mov_b32 s99, 1
    s_branch L_pad_6
L_padret_6:
    s_mov_b32 s99, 0
L_skip_53:
    s_barrier
    s_barrier
    s_barrier
    s_barrier
    s_barrier
    s_barrier
    s_barrier
    s_cmp_lg_u32 s3, 6
    s_cbranch_scc1 L_skip_54
    s_mov_b32 s99, 1
    s_branch L_pad_7
L_padret_7:
    s_mov_b32 s99, 0
L_skip_54:
    s_barrier
    s_barrier
    s_barrier
    s_barrier
    s_barrier
    s_barrier
    s_cmp_lg_u32 s3, 6
    s_cbranch_scc1 L_skip_55
    s_mov_b32 s99, 1
    s_branch L_pad_8
L_padret_8:
    s_mov_b32 s99, 0
L_skip_55:
    s_barrier
    s_barrier
    s_barrier
    s_barrier
    s_barrier
    s_barrier
    s_barrier
    s_barrier
    s_barrier
    s_barrier
    s_barrier
    s_barrier
    s_cmp_lg_u32 s3, 7
    s_cbranch_scc1 L_skip_56
    v_min_u32 v248, 31, v2
    v_lshlrev_b32 v248, 7, v248
    s_mov_b32 s60, 622592
    buffer_load_dword v249, v248, s[8:11], s60 offen sc1
L_skip_56:
    s_barrier
    s_barrier
    s_barrier
    s_cmp_lg_u32 s3, 7
    s_cbranch_scc1 L_skip_57
    s_waitcnt vmcnt(0)
    v_cmp_ne_u32 vcc, s6, v249
    s_cbranch_vccz L_seen_58
    s_mov_b32 s60, 622592
    v_min_u32 v250, 31, v2
    v_lshlrev_b32 v250, 7, v250
    s_mov_b32 s61, 0
L_poll_59:
    buffer_load_dword v251, v250, s[8:11], s60 offen sc1
    s_add_u32 s61, s61, 1
    s_cmp_gt_u32 s61, 30000
    s_cbranch_scc1 L_go_60
    s_waitcnt vmcnt(0)
    v_xor_b32 v251, s6, v251
    v_cmp_ne_u32 vcc, 0, v251
    s_cbranch_vccnz L_poll_59
L_go_60:
    s_waitcnt vmcnt(0)
L_seen_58:
L_skip_57:
    s_barrier
    s_barrier
    s_barrier
    s_barrier
    s_barrier
    s_cmp_lg_u32 s3, 7
    s_cbranch_scc1 L_skip_61
    s_lshl_b32 s37, s58, 4
    s_add_u32 s37, s37, s59
    s_lshl_b32 s60, s37, 7
    s_add_u32 s60, s60, 458752
    v_mov_b32 v250, s6
    v_mov_b32 v251, 0
    s_mov_b64 exec, 1
    buffer_store_dword v250, v251, s[8:11], s60 offen sc1
    s_mov_b64 exec, -1
L_skip_61:
L_X3:
    s_cmp_lg_u32 s3, 7
    s_cbranch_scc1 L_skip_62
    s_lshr_b32 s37, s56, 1
    s_lshl_b32 s37, s37, 4
    s_lshl_b32 s60, s37, 7
    s_add_u32 s60, s60, 458752
    v_min_u32 v250, 1, v2
    v_lshlrev_b32 v250, 7, v250
    s_mov_b32 s61, 0
L_poll_63:
    buffer_load_dword v251, v250, s[8:11], s60 offen sc1
    s_add_u32 s61, s61, 1
    s_cmp_gt_u32 s61, 30000
    s_cbranch_scc1 L_go_64
    s_waitcnt vmcnt(0)
    v_xor_b32 v251, s6, v251
    v_cmp_ne_u32 vcc, 0, v251
    s_cbranch_vccnz L_poll_63
L_go_64:
    s_waitcnt vmcnt(0)
L_skip_62:
    s_waitcnt vmcnt(0)
    s_barrier
    s_cmp_lg_u32 s3, 7
    s_cbranch_scc1 L_skip_65
    s_lshl_b32 s60, s37, 7
    s_add_u32 s60, s60, 458752
    v_min_u32 v250, 13, v2
    v_lshlrev_b32 v250, 7, v250
    s_mov_b32 s61, 0
L_poll_66:
    buffer_load_dword v251, v250, s[8:11], s60 offen sc1
    s_add_u32 s61, s61, 1
    s_cmp_gt_u32 s61, 30000
    s_cbranch_scc1 L_go_67
    s_waitcnt vmcnt(0)
    v_xor_b32 v251, s6, v251
    v_cmp_ne_u32 vcc, 0, v251
    s_cbranch_vccnz L_poll_66
L_go_67:
    s_waitcnt vmcnt(0)
L_skip_65:
    s_barrier
    s_barrier
    s_barrier
    s_barrier
    s_barrier
    s_barrier
    s_barrier
    s_barrier
    s_barrier
    s_barrier
    s_barrier
    s_barrier
    s_barrier
    s_barrier
    s_barrier
    s_barrier
    s_barrier
    s_barrier
    s_barrier
    s_barrier
    s_barrier
    s_barrier
    s_barrier
    s_barrier
    s_cmp_lg_u32 s3, 6
    s_cbranch_scc1 L_skip_68
    s_mov_b32 s99, 1
    s_branch L_pad_9
L_padret_9:
    s_mov_b32 s99, 0
L_skip_68:
    s_barrier
    s_barrier
    s_barrier
    s_barrier
    s_branch L_end
L_Bspare:
    s_sub_u32 s32, s5, 28
    s_lshl_b32 s32, s32, 3
    s_add_u32 s32, s32, s4
    v_and_b32 v5, 255, v0
    v_lshlrev_b32 v5, 7, v5
    s_mov_b32 s62, 0
    s_mov_b32 s63, -1
    s_lshl_b32 s33, s32, 2
    s_add_u32 s33, s33, s30
    s_mul_i32 s34, s33, 57344
    s_add_u32 s34, s34, 0
    v_and_b32 v6, 31, v2
    v_min_u32 v6, 27, v6
    v_lshlrev_b32 v6, 7, v6
    v_lshrrev_b32 v7, 5, v2
    v_mul_u32_u24 v7, 7168, v7
    v_add_u32 v6, v6, v7
    buffer_load_dword v204, v6, s[12:15], s34 offen
    s_add_u32 s34, s34, 14336
    buffer_load_dword v204, v6, s[12:15], s34 offen
    s_add_u32 s34, s34, 14336
    buffer_load_dword v204, v6, s[12:15], s34 offen
    s_add_u32 s34, s34, 14336
    buffer_load_dword v204, v6, s[12:15], s34 offen
    s_add_u32 s34, s34, 14336
    s_cmp_lg_u32 s3, 7
    s_cbranch_scc1 L_skip_69
    s_lshl_b32 s37, s4, 5
    s_lshl_b32 s60, s37, 7
    s_add_u32 s60, s60, 524288
    v_min_u32 v250, 0, v2
    v_lshlrev_b32 v250, 7, v250
    s_mov_b32 s61, 0
L_poll_70:
    s_sleep 8
    buffer_load_dword v251, v250, s[8:11], s60 offen sc1
    s_add_u32 s61, s61, 1
    s_cmp_gt_u32 s61, 30000
    s_cbranch_scc1 L_go_71
    s_waitcnt vmcnt(0)
    v_xor_b32 v251, s6, v251
    v_cmp_ne_u32 vcc, 0, v251
    s_cbranch_vccnz L_poll_70
L_go_71:
    s_waitcnt vmcnt(0)
L_skip_69:
    s_barrier
    v_and_b32 v6, 63, v0
    v_lshlrev_b32 v6, 12, v6
    s_lshl_b32 s35, s32, 18
    s_cmp_eq_u32 s30, 0
    s_cselect_b32 s34, 0, s34
    s_cmp_eq_u32 s30, 1
    s_cselect_b32 s34, 128, s34
    s_cmp_eq_u32 s30, 2
    s_cselect_b32 s34, 256, s34
    s_cmp_eq_u32 s30, 3
    s_cselect_b32 s34, 384, s34
    s_add_u32 s34, s34, s35
    buffer_load_dword v100, v6, s[16:19], s34 offen
    s_cmp_eq_u32 s30, 0
    s_cselect_b32 s34, 512, s34
    s_cmp_eq_u32 s30, 1
    s_cselect_b32 s34, 640, s34
    s_cmp_eq_u32 s30, 2
    s_cselect_b32 s34, 768, s34
    s_cmp_eq_u32 s30, 3
    s_cselect_b32 s34, 896, s34
    s_add_u32 s34, s34, s35
    buffer_load_dword v100, v6, s[16:19], s34 offen
    s_cmp_eq_u32 s30, 0
    s_cselect_b32 s34, 1024, s34
    s_cmp_eq_u32 s30, 1
    s_cselect_b32 s34, 1152, s34
    s_cmp_eq_u32 s30, 2
    s_cselect_b32 s34, 1280, s34
    s_cmp_eq_u32 s30, 3
    s_cselect_b32 s34, 1408, s34
    s_add_u32 s34, s34, s35
    buffer_load_dword v100, v6, s[16:19], s34 offen
    s_cmp_eq_u32 s30, 0
    s_cselect_b32 s34, 1536, s34
    s_cmp_eq_u32 s30, 1
    s_cselect_b32 s34, 1664, s34
    s_cmp_eq_u32 s30, 2
    s_cselect_b32 s34, 1792, s34
    s_cmp_eq_u32 s30, 3
    s_cselect_b32 s34, 1920, s34
    s_add_u32 s34, s34, s35
    buffer_load_dword v100, v6, s[16:19], s34 offen
    s_cmp_eq_u32 s30, 0
    s_cselect_b32 s34, 2048, s34
    s_cmp_eq_u32 s30, 1
    s_cselect_b32 s34, 2176, s34
    s_cmp_eq_u32 s30, 2
    s_cselect_b32 s34, 2304, s34
    s_cmp_eq_u32 s30, 3
    s_cselect_b32 s34, 2432, s34
    s_add_u32 s34, s34, s35
    buffer_load_dword v100, v6, s[16:19], s34 offen
    s_cmp_eq_u32 s30, 0
    s_cselect_b32 s34, 2560, s34
    s_cmp_eq_u32 s30, 1
    s_cselect_b32 s34, 2688, s34
    s_cmp_eq_u32 s30, 2
    s_cselect_b32 s34, 2816, s34
    s_cmp_eq_u32 s30, 3
    s_cselect_b32 s34, 2944, s34
    s_add_u32 s34, s34, s35
    buffer_load_dword v100, v6, s[16:19], s34 offen
    s_cmp_eq_u32 s30, 0
    s_cselect_b32 s34, 3072, s34
    s_cmp_eq_u32 s30, 1
    s_cselect_b32 s34, 3200, s34
    s_cmp_eq_u32 s30, 2
    s_cselect_b32 s34, 3328, s34
    s_cmp_eq_u32 s30, 3
    s_cselect_b32 s34, 3456, s34
    s_add_u32 s34, s34, s35
    buffer_load_dword v100, v6, s[16:19], s34 offen
L_pad_14:
    s_cmp_eq_u32 s99, 1
    s_cbranch_scc1 L_padret_14
    s_cmp_eq_u32 s30, 0
    s_cselect_b32 s34, 3584, s34
    s_cmp_eq_u32 s30, 1
    s_cselect_b32 s34, 3712, s34
    s_cmp_eq_u32 s30, 2
    s_cselect_b32 s34, 3840, s34
    s_cmp_eq_u32 s30, 3
    s_cselect_b32 s34, 3968, s34
    s_add_u32 s34, s34, s35
    buffer_load_dword v100, v6, s[16:19], s34 offen
    s_add_u32 s33, s32, 160
    s_sub_u32 s40, s3, 4
    s_lshr_b32 s35, s33, 1
    s_and_b32 s47, s33, 1
    s_lshl_b32 s34, s47, 2
    s_add_u32 s34, s34, s40
    s_mov_b32 s16, s88
    s_and_b32 s17, s89, 0xffff
    s_mov_b32 s18, 12582912
    s_mov_b32 s19, 0x00020000
    s_mov_b32 s20, s86
    s_and_b32 s21, s87, 0xffff
    s_mov_b32 s22, 2048
    s_mov_b32 s23, 0x00020000
    s_lshl_b32 s36, s34, 8
    v_lshl_add_u32 v29, v2, 2, s36
    buffer_load_dword v28, v29, s[20:23], 0 offen
    s_mul_i32 s36, s34, 1572864
    s_lshl_b32 s37, s35, 7
    s_add_u32 s46, s36, s37
    v_lshrrev_b32 v20, 3, v2
    v_mul_u32_u24 v20, 12288, v20
    v_and_b32 v21, 7, v2
    v_and_b32 v22, 1, v4
    v_lshlrev_b32 v22, 1, v22
    v_xor_b32 v21, v21, v22
    v_lshl_add_u32 v20, v21, 4, v20
    v_xor_b32 v21, 64, v20
    s_lshl_b32 s41, s40, 8
    s_add_u32 s41, s41, 154624
    s_lshl_b32 s40, s40, 14
    s_add_u32 s40, s40, 70656
    s_mov_b32 s45, s35
    s_add_u32 m0, s40, 0
    s_nop 0
    buffer_load_dwordx4 v20, s[16:19], s46 offen nt lds
    s_add_u32 s46, s46, 98304
    s_add_u32 m0, s40, 1024
    s_nop 0
    buffer_load_dwordx4 v21, s[16:19], s46 offen nt lds
    s_add_u32 s46, s46, 98304
    s_add_u32 m0, s40, 2048
    s_nop 0
    buffer_load_dwordx4 v20, s[16:19], s46 offen nt lds
    s_add_u32 s46, s46, 98304
    s_add_u32 m0, s40, 3072
    s_nop 0
    buffer_load_dwordx4 v21, s[16:19], s46 offen nt lds
    s_add_u32 s46, s46, 98304
    s_add_u32 m0, s40, 4096
    s_nop 0
    buffer_load_dwordx4 v20, s[16:19], s46 offen nt lds
    s_add_u32 s46, s46, 98304
    s_add_u32 m0, s40, 5120
    s_nop 0
    buffer_load_dwordx4 v21, s[16:19], s46 offen nt lds
    s_add_u32 s46, s46, 98304
    s_add_u32 m0, s40, 6144
    s_nop 0
    buffer_load_dwordx4 v20, s[16:19], s46 offen nt lds
    s_add_u32 s46, s46, 98304
    s_add_u32 m0, s40, 7168
    s_nop 0
    buffer_load_dwordx4 v21, s[16:19], s46 offen nt lds
    s_add_u32 s46, s46, 98304
    s_add_u32 m0, s40, 8192
    s_nop 0
    buffer_load_dwordx4 v20, s[16:19], s46 offen nt lds
    s_add_u32 s46, s46, 98304
    s_add_u32 m0, s40, 9216
    s_nop 0
    buffer_load_dwordx4 v21, s[16:19], s46 offen nt lds
    s_add_u32 s46, s46, 98304
    s_add_u32 m0, s40, 10240
    s_nop 0
    buffer_load_dwordx4 v20, s[16:19], s46 offen nt lds
    s_add_u32 s46, s46, 98304
    s_add_u32 m0, s40, 11264
    s_nop 0
    buffer_load_dwordx4 v21, s[16:19], s46 offen nt lds
    s_add_u32 s46, s46, 98304
    s_add_u32 m0, s40, 12288
    s_nop 0
    buffer_load_dwordx4 v20, s[16:19], s46 offen nt lds
    s_add_u32 s46, s46, 98304
    s_add_u32 m0, s40, 13312
    s_nop 0
    buffer_load_dwordx4 v21, s[16:19], s46 offen nt lds
    s_add_u32 s46, s46, 98304
    s_add_u32 m0, s40, 14336
    s_nop 0
    buffer_load_dwordx4 v20, s[16:19], s46 offen nt lds
    s_add_u32 s46, s46, 98304
    s_add_u32 m0, s40, 15360
    s_nop 0
    buffer_load_dwordx4 v21, s[16:19], s46 offen nt lds
    s_add_u32 s46, s46, 98304
    s_waitcnt vmcnt(16)
    v_lshlrev_b32 v22, 16, v28
    v_and_b32 v23, 0xffff0000, v28
    v_mul_f32 v24, 0xbfb8aa3b, v22
    v_mul_f32 v25, 0xbfb8aa3b, v23
    v_exp_f32 v24, v24
    v_exp_f32 v25, v25
    v_add_f32 v24, 1.0, v24
    v_add_f32 v25, 1.0, v25
    v_rcp_f32 v24, v24
    v_rcp_f32 v25, v25
    v_mul_f32 v22, v22, v24
    v_mul_f32 v23, v23, v25
    v_cvt_pk_bf16_f32 v22, v22, v23
    v_lshl_add_u32 v23, v2, 2, s41
    ds_write_b32 v23, v22
    v_lshl_add_u32 v23, v4, 4, s41
    s_waitcnt lgkmcnt(0)
    ds_read_b128 v[208:211], v23 offset:0
    ds_read_b128 v[212:215], v23 offset:64
    ds_read_b128 v[216:219], v23 offset:128
    ds_read_b128 v[220:223], v23 offset:192
    v_bfe_u32 v24, v2, 2, 2
    v_and_b32 v25, 3, v2
    v_lshl_add_u32 v26, v4, 3, v24
    v_lshlrev_b32 v26, 7, v26
    v_lshl_add_u32 v26, v25, 3, v26
    v_add_u32 v26, s40, v26
    v_lshrrev_b32 v24, 1, v24
    v_and_b32 v25, 1, v4
    v_lshl_or_b32 v24, v25, 1, v24
    v_xor_b32 v25, 0, v24
    v_lshl_add_u32 v224, v25, 5, v26
    v_xor_b32 v25, 1, v24
    v_lshl_add_u32 v225, v25, 5, v26
    v_xor_b32 v25, 2, v24
    v_lshl_add_u32 v226, v25, 5, v26
    v_xor_b32 v25, 3, v24
    v_lshl_add_u32 v227, v25, 5, v26
    s_waitcnt lgkmcnt(0)
    s_waitcnt vmcnt(0)
    ds_read_b64_tr_b16 v[64:65], v224 offset:0
    ds_read_b64_tr_b16 v[66:67], v224 offset:512
    ds_read_b64_tr_b16 v[68:69], v225 offset:0
    ds_read_b64_tr_b16 v[70:71], v225 offset:512
    ds_read_b64_tr_b16 v[72:73], v226 offset:0
    ds_read_b64_tr_b16 v[74:75], v226 offset:512
    ds_read_b64_tr_b16 v[76:77], v227 offset:0
    ds_read_b64_tr_b16 v[78:79], v227 offset:512
    s_waitcnt lgkmcnt(4)
    ds_read_b64_tr_b16 v[80:81], v224 offset:4096
    ds_read_b64_tr_b16 v[82:83], v224 offset:4608
    ds_read_b64_tr_b16 v[84:85], v225 offset:4096
    ds_read_b64_tr_b16 v[86:87], v225 offset:4608
    ds_read_b64_tr_b16 v[88:89], v226 offset:4096
    ds_read_b64_tr_b16 v[90:91], v226 offset:4608
    ds_read_b64_tr_b16 v[92:93], v227 offset:4096
    ds_read_b64_tr_b16 v[94:95], v227 offset:4608
    s_waitcnt lgkmcnt(0)
    v_mfma_f32_16x16x32_bf16 v[228:231], v[208:211], v[64:67], 0
    v_mfma_f32_16x16x32_bf16 v[232:235], v[208:211], v[68:71], 0
    v_mfma_f32_16x16x32_bf16 v[236:239], v[208:211], v[72:75], 0
    v_mfma_f32_16x16x32_bf16 v[240:243], v[208:211], v[76:79], 0
    v_mfma_f32_16x16x32_bf16 v[228:231], v[212:215], v[80:83], v[228:231]
    v_mfma_f32_16x16x32_bf16 v[232:235], v[212:215], v[84:87], v[232:235]
    v_mfma_f32_16x16x32_bf16 v[236:239], v[212:215], v[88:91], v[236:239]
    v_mfma_f32_16x16x32_bf16 v[240:243], v[212:215], v[92:95], v[240:243]
    ds_read_b64_tr_b16 v[64:65], v224 offset:8192
    ds_read_b64_tr_b16 v[66:67], v224 offset:8704
    ds_read_b64_tr_b16 v[68:69], v225 offset:8192
    ds_read_b64_tr_b16 v[70:71], v225 offset:8704
    ds_read_b64_tr_b16 v[72:73], v226 offset:8192
    ds_read_b64_tr_b16 v[74:75], v226 offset:8704
    ds_read_b64_tr_b16 v[76:77], v227 offset:8192
    ds_read_b64_tr_b16 v[78:79], v227 offset:8704
    s_waitcnt lgkmcnt(4)
    ds_read_b64_tr_b16 v[80:81], v224 offset:12288
    ds_read_b64_tr_b16 v[82:83], v224 offset:12800
    ds_read_b64_tr_b16 v[84:85], v225 offset:12288
    ds_read_b64_tr_b16 v[86:87], v225 offset:12800
    ds_read_b64_tr_b16 v[88:89], v226 offset:12288
    ds_read_b64_tr_b16 v[90:91], v226 offset:12800
    ds_read_b64_tr_b16 v[92:93], v227 offset:12288
    ds_read_b64_tr_b16 v[94:95], v227 offset:12800
    s_waitcnt lgkmcnt(0)
    v_mfma_f32_16x16x32_bf16 v[228:231], v[216:219], v[64:67], v[228:231]
    v_mfma_f32_16x16x32_bf16 v[232:235], v[216:219], v[68:71], v[232:235]
    v_mfma_f32_16x16x32_bf16 v[236:239], v[216:219], v[72:75], v[236:239]
    v_mfma_f32_16x16x32_bf16 v[240:243], v[216:219], v[76:79], v[240:243]
    v_mfma_f32_16x16x32_bf16 v[228:231], v[220:223], v[80:83], v[228:231]
    v_mfma_f32_16x16x32_bf16 v[232:235], v[220:223], v[84:87], v[232:235]
    v_mfma_f32_16x16x32_bf16 v[236:239], v[220:223], v[88:91], v[236:239]
    v_mfma_f32_16x16x32_bf16 v[240:243], v[220:223], v[92:95], v[240:243]
    v_cmp_eq_u32 vcc, 1, v4
    s_nop 4
    v_cndmask_b32 v228, v228, v232, vcc
    v_cmp_eq_u32 vcc, 2, v4
    s_nop 1
    v_cndmask_b32 v228, v228, v236, vcc
    v_cmp_eq_u32 vcc, 3, v4
    s_nop 1
    v_cndmask_b32 v228, v228, v240, vcc
    v_lshl_add_u32 v23, v2, 2, s41
    ds_write_b32 v23, v228
    s_waitcnt lgkmcnt(0)
    v_mov_b32 v7, 156420
    v_mov_b32 v6, 1
    s_mov_b64 exec, 1
    ds_add_u32 v7, v6
    s_mov_b64 exec, -1
    s_mov_b32 s39, 0
L_spin_73:
    ds_read_b32 v6, v7
    s_add_u32 s39, s39, 1
    s_cmp_gt_u32 s39, 200000
    s_cbranch_scc1 L_spun_74
    s_waitcnt lgkmcnt(0)
    v_cmp_ne_u32 vcc, 4, v6
    s_cbranch_vccnz L_spin_73
L_spun_74:
    s_cmp_lg_u32 s3, 4
    s_cbranch_scc1 L_gb_72
    v_lshl_add_u32 v23, v2, 2, s41
    ds_read_b32 v24, v23 offset:0
    ds_read_b32 v25, v23 offset:256
    ds_read_b32 v26, v23 offset:512
    ds_read_b32 v27, v23 offset:768
    s_mul_i32 s37, s47, 24576
    s_lshl_b32 s38, s45, 8
    s_add_u32 s37, s37, s38
    v_lshlrev_b32 v23, 2, v2
    s_waitcnt lgkmcnt(0)
    v_add_f32 v24, v24, v25
    v_add_f32 v26, v26, v27
    v_add_f32 v24, v24, v26
    buffer_store_dword v24, v23, s[8:11], s37 offen sc1
L_gb_72:
    s_mov_b32 s16, s80
    s_and_b32 s17, s81, 0xffff
    s_mov_b32 s18, 8388608
    s_mov_b32 s19, 0x00020000
    s_mov_b32 s20, s84
    s_and_b32 s21, s85, 0xffff
    s_mov_b32 s22, 3670016
    s_mov_b32 s23, 0x00020000
    s_lshl_b32 s33, s32, 2
    s_add_u32 s33, s33, s30
    v_and_b32 v8, 1, v4
    v_lshlrev_b32 v8, 10, v8
    v_lshl_add_u32 v8, v3, 4, v8
    v_lshrrev_b32 v7, 5, v2
    v_lshl_add_u32 v8, v7, 11, v8
    v_add_u32 v8, 256, v8
    s_mul_i32 s34, s33, 28672
    buffer_load_dwordx4 v[32:35], v8, s[20:23], s34 offen
    s_add_u32 s34, s34, 4096
    buffer_load_dwordx4 v[36:39], v8, s[20:23], s34 offen
    s_add_u32 s34, s34, 4096
    buffer_load_dwordx4 v[40:43], v8, s[20:23], s34 offen
    s_add_u32 s34, s34, 4096
    buffer_load_dwordx4 v[44:47], v8, s[20:23], s34 offen
    s_add_u32 s34, s34, 4096
    buffer_load_dwordx4 v[48:51], v8, s[20:23], s34 offen
    s_add_u32 s34, s34, 4096
    buffer_load_dwordx4 v[52:55], v8, s[20:23], s34 offen
    s_add_u32 s34, s34, 4096
    buffer_load_dwordx4 v[56:59], v8, s[20:23], s34 offen
    s_add_u32 s34, s34, 4096
    s_mul_i32 s34, s33, 28672
    s_add_u32 s34, s34, 42991360
    s_waitcnt vmcnt(6)
    buffer_store_dwordx4 v[32:35], v8, s[8:11], s34 offen sc1
    s_add_u32 s34, s34, 4096
    s_waitcnt vmcnt(6)
    buffer_store_dwordx4 v[36:39], v8, s[8:11], s34 offen sc1
    s_add_u32 s34, s34, 4096
    s_waitcnt vmcnt(6)
    buffer_store_dwordx4 v[40:43], v8, s[8:11], s34 offen sc1
    s_add_u32 s34, s34, 4096
    s_waitcnt vmcnt(6)
    buffer_store_dwordx4 v[44:47], v8, s[8:11], s34 offen sc1
    s_add_u32 s34, s34, 4096
    s_waitcnt vmcnt(6)
    buffer_store_dwordx4 v[48:51], v8, s[8:11], s34 offen sc1
    s_add_u32 s34, s34, 4096
    s_waitcnt vmcnt(6)
    buffer_store_dwordx4 v[52:55], v8, s[8:11], s34 offen sc1
    s_add_u32 s34, s34, 4096
    s_waitcnt vmcnt(6)
    buffer_store_dwordx4 v[56:59], v8, s[8:11], s34 offen sc1
    s_add_u32 s34, s34, 4096
    s_waitcnt vmcnt(0)
    s_barrier
    s_cmp_lg_u32 s3, 7
    s_cbranch_scc1 L_skip_75
    s_lshl_b32 s60, s32, 7
    s_add_u32 s60, s60, 622592
    v_mov_b32 v250, s6
    v_mov_b32 v251, 0
    s_mov_b64 exec, 1
    buffer_store_dword v250, v251, s[8:11], s60 offen sc1
    s_mov_b64 exec, -1
L_skip_75:
    s_mul_i32 s34, s32, 114688
    buffer_load_dword v100, v5, s[20:23], s34 offen
    s_add_u32 s34, s34, 32768
    buffer_load_dword v100, v5, s[20:23], s34 offen
    s_add_u32 s34, s34, 32768
    buffer_load_dword v100, v5, s[20:23], s34 offen
    s_add_u32 s34, s34, 32768
    buffer_load_dword v100, v5, s[20:23], s34 offen
    s_add_u32 s34, s34, 32768
    s_add_u32 s64, s94, 55574400
    s_addc_u32 s65, s95, 0
    s_and_b32 s65, s65, 0xffff
    s_mov_b32 s66, 8388608
    s_mov_b32 s67, 0x00020000
    s_cmp_lg_u32 s3, 7
    s_cbranch_scc1 L_skip_76
    s_mov_b32 s60, 622592
    v_min_u32 v250, 31, v2
    v_lshlrev_b32 v250, 7, v250
    s_mov_b32 s61, 0
L_poll_77:
    s_sleep 8
    buffer_load_dword v251, v250, s[8:11], s60 offen sc1
    s_add_u32 s61, s61, 1
    s_cmp_gt_u32 s61, 30000
    s_cbranch_scc1 L_go_78
    s_waitcnt vmcnt(0)
    v_xor_b32 v251, s6, v251
    v_cmp_ne_u32 vcc, 0, v251
    s_cbranch_vccnz L_poll_77
L_go_78:
    s_waitcnt vmcnt(0)
L_skip_76:
    s_barrier
    s_and_b32 s35, s57, 3
    s_cmp_lg_u32 s35, 1
    s_cbranch_scc1 L_nofix_79
    s_add_u32 s20, s94, 42991360
    s_addc_u32 s21, s95, 0
    s_and_b32 s21, s21, 0xffff
L_nofix_79:
    s_cmp_ge_u32 s3, 6
    s_cbranch_scc1 L_X3
    s_waitcnt vmcnt(0)
    s_mul_i32 s50, s30, 8192
    s_mov_b32 s51, 0
    s_add_u32 m0, s50, 0
    s_nop 0
    buffer_load_dwordx4 v152, s[20:23], s51 offen sc1 lds
    s_add_u32 m0, s50, 1024
    s_nop 0
    buffer_load_dwordx4 v153, s[20:23], s51 offen sc1 lds
    s_add_u32 m0, s50, 2048
    s_nop 0
    buffer_load_dwordx4 v154, s[20:23], s51 offen sc1 lds
    s_add_u32 m0, s50, 3072
    s_nop 0
    buffer_load_dwordx4 v155, s[20:23], s51 offen sc1 lds
    s_add_u32 m0, s50, 4096
    s_nop 0
    buffer_load_dwordx4 v156, s[20:23], s51 offen sc1 lds
    s_add_u32 m0, s50, 5120
    s_nop 0
    buffer_load_dwordx4 v157, s[20:23], s51 offen sc1 lds
    s_add_u32 m0, s50, 6144
    s_nop 0
    buffer_load_dwordx4 v158, s[20:23], s51 offen sc1 lds
    s_add_u32 m0, s50, 7168
    s_nop 0
    buffer_load_dwordx4 v159, s[20:23], s51 offen sc1 lds
    s_mul_i32 s50, s30, 8192
    s_mov_b32 s51, 131072
    s_add_u32 m0, s50, 16384
    s_nop 0
    buffer_load_dwordx4 v152, s[20:23], s51 offen sc1 lds
    s_add_u32 m0, s50, 17408
    s_nop 0
    buffer_load_dwordx4 v153, s[20:23], s51 offen sc1 lds
    s_add_u32 m0, s50, 18432
    s_nop 0
    buffer_load_dwordx4 v154, s[20:23], s51 offen sc1 lds
    s_add_u32 m0, s50, 19456
    s_nop 0
    buffer_load_dwordx4 v155, s[20:23], s51 offen sc1 lds
    s_add_u32 m0, s50, 20480
    s_nop 0
    buffer_load_dwordx4 v156, s[20:23], s51 offen sc1 lds
    s_add_u32 m0, s50, 21504
    s_nop 0
    buffer_load_dwordx4 v157, s[20:23], s51 offen sc1 lds
    s_add_u32 m0, s50, 22528
    s_nop 0
    buffer_load_dwordx4 v158, s[20:23], s51 offen sc1 lds
    s_add_u32 m0, s50, 23552
    s_nop 0
    buffer_load_dwordx4 v159, s[20:23], s51 offen sc1 lds
    s_mul_i32 s50, s30, 8192
    s_mov_b32 s51, 262144
    s_add_u32 m0, s50, 32768
    s_nop 0
    buffer_load_dwordx4 v152, s[20:23], s51 offen sc1 lds
    s_add_u32 m0, s50, 33792
    s_nop 0
    buffer_load_dwordx4 v153, s[20:23], s51 offen sc1 lds
    s_add_u32 m0, s50, 34816
    s_nop 0
    buffer_load_dwordx4 v154, s[20:23], s51 offen sc1 lds
    s_add_u32 m0, s50, 35840
    s_nop 0
    buffer_load_dwordx4 v155, s[20:23], s51 offen sc1 lds
    s_add_u32 m0, s50, 36864
    s_nop 0
    buffer_load_dwordx4 v156, s[20:23], s51 offen sc1 lds
    s_add_u32 m0, s50, 37888
    s_nop 0
    buffer_load_dwordx4 v157, s[20:23], s51 offen sc1 lds
    s_add_u32 m0, s50, 38912
    s_nop 0
    buffer_load_dwordx4 v158, s[20:23], s51 offen sc1 lds
    s_add_u32 m0, s50, 39936
    s_nop 0
    buffer_load_dwordx4 v159, s[20:23], s51 offen sc1 lds
    s_mul_i32 s50, s30, 8192
    s_mov_b32 s51, 393216
    s_add_u32 m0, s50, 49152
    s_nop 0
    buffer_load_dwordx4 v152, s[20:23], s51 offen sc1 lds
    s_add_u32 m0, s50, 50176
    s_nop 0
    buffer_load_dwordx4 v153, s[20:23], s51 offen sc1 lds
    s_add_u32 m0, s50, 51200
    s_nop 0
    buffer_load_dwordx4 v154, s[20:23], s51 offen sc1 lds
    s_add_u32 m0, s50, 52224
    s_nop 0
    buffer_load_dwordx4 v155, s[20:23], s51 offen sc1 lds
    s_add_u32 m0, s50, 53248
    s_nop 0
    buffer_load_dwordx4 v156, s[20:23], s51 offen sc1 lds
    s_add_u32 m0, s50, 54272
    s_nop 0
    buffer_load_dwordx4 v157, s[20:23], s51 offen sc1 lds
    s_add_u32 m0, s50, 55296
    s_nop 0
    buffer_load_dwordx4 v158, s[20:23], s51 offen sc1 lds
    s_add_u32 m0, s50, 56320
    s_nop 0
    buffer_load_dwordx4 v159, s[20:23], s51 offen sc1 lds
    s_mul_i32 s50, s30, 8192
    s_mov_b32 s51, 524288
    s_add_u32 m0, s50, 65536
    s_nop 0
    buffer_load_dwordx4 v152, s[20:23], s51 offen sc1 lds
    s_add_u32 m0, s50, 66560
    s_nop 0
    buffer_load_dwordx4 v153, s[20:23], s51 offen sc1 lds
    s_add_u32 m0, s50, 67584
    s_nop 0
    buffer_load_dwordx4 v154, s[20:23], s51 offen sc1 lds
    s_add_u32 m0, s50, 68608
    s_nop 0
    buffer_load_dwordx4 v155, s[20:23], s51 offen sc1 lds
    s_add_u32 m0, s50, 69632
    s_nop 0
    buffer_load_dwordx4 v156, s[20:23], s51 offen sc1 lds
    s_add_u32 m0, s50, 70656
    s_nop 0
    buffer_load_dwordx4 v157, s[20:23], s51 offen sc1 lds
    s_add_u32 m0, s50, 71680
    s_nop 0
    buffer_load_dwordx4 v158, s[20:23], s51 offen sc1 lds
    s_add_u32 m0, s50, 72704
    s_nop 0
    buffer_load_dwordx4 v159, s[20:23], s51 offen sc1 lds
    s_mul_i32 s50, s30, 8192
    s_mov_b32 s51, 655360
    s_add_u32 m0, s50, 81920
    s_nop 0
    buffer_load_dwordx4 v152, s[20:23], s51 offen sc1 lds
    s_add_u32 m0, s50, 82944
    s_nop 0
    buffer_load_dwordx4 v153, s[20:23], s51 offen sc1 lds
    s_add_u32 m0, s50, 83968
    s_nop 0
    buffer_load_dwordx4 v154, s[20:23], s51 offen sc1 lds
    s_add_u32 m0, s50, 84992
    s_nop 0
    buffer_load_dwordx4 v155, s[20:23], s51 offen sc1 lds
    s_add_u32 m0, s50, 86016
    s_nop 0
    buffer_load_dwordx4 v156, s[20:23], s51 offen sc1 lds
    s_add_u32 m0, s50, 87040
    s_nop 0
    buffer_load_dwordx4 v157, s[20:23], s51 offen sc1 lds
    s_add_u32 m0, s50, 88064
    s_nop 0
    buffer_load_dwordx4 v158, s[20:23], s51 offen sc1 lds
    s_add_u32 m0, s50, 89088
    s_nop 0
    buffer_load_dwordx4 v159, s[20:23], s51 offen sc1 lds
    s_waitcnt vmcnt(32)
    s_mul_i32 s50, s30, 8192
    s_mov_b32 s51, 786432
    s_add_u32 m0, s50, 98304
    s_nop 0
    buffer_load_dwordx4 v152, s[20:23], s51 offen sc1 lds
    s_add_u32 m0, s50, 99328
    s_nop 0
    buffer_load_dwordx4 v153, s[20:23], s51 offen sc1 lds
    s_add_u32 m0, s50, 100352
    s_nop 0
    buffer_load_dwordx4 v154, s[20:23], s51 offen sc1 lds
    s_add_u32 m0, s50, 101376
    s_nop 0
    buffer_load_dwordx4 v155, s[20:23], s51 offen sc1 lds
    s_add_u32 m0, s50, 102400
    s_nop 0
    buffer_load_dwordx4 v156, s[20:23], s51 offen sc1 lds
    s_add_u32 m0, s50, 103424
    s_nop 0
    buffer_load_dwordx4 v157, s[20:23], s51 offen sc1 lds
    s_add_u32 m0, s50, 104448
    s_nop 0
    buffer_load_dwordx4 v158, s[20:23], s51 offen sc1 lds
    s_add_u32 m0, s50, 105472
    s_nop 0
    buffer_load_dwordx4 v159, s[20:23], s51 offen sc1 lds
    s_mul_i32 s50, s30, 8192
    s_mov_b32 s51, 917504
    s_add_u32 m0, s50, 114688
    s_nop 0
    buffer_load_dwordx4 v152, s[20:23], s51 offen sc1 lds
    s_add_u32 m0, s50, 115712
    s_nop 0
    buffer_load_dwordx4 v153, s[20:23], s51 offen sc1 lds
    s_add_u32 m0, s50, 116736
    s_nop 0
    buffer_load_dwordx4 v154, s[20:23], s51 offen sc1 lds
    s_add_u32 m0, s50, 117760
    s_nop 0
    buffer_load_dwordx4 v155, s[20:23], s51 offen sc1 lds
    s_add_u32 m0, s50, 118784
    s_nop 0
    buffer_load_dwordx4 v156, s[20:23], s51 offen sc1 lds
    s_add_u32 m0, s50, 119808
    s_nop 0
    buffer_load_dwordx4 v157, s[20:23], s51 offen sc1 lds
    s_add_u32 m0, s50, 120832
    s_nop 0
    buffer_load_dwordx4 v158, s[20:23], s51 offen sc1 lds
    s_add_u32 m0, s50, 121856
    s_nop 0
    buffer_load_dwordx4 v159, s[20:23], s51 offen sc1 lds
    s_branch L_L3
L_end:
L_done:
    s_endpgm
L_pad_15:
    s_branch L_padret_15
.section .rodata,"a"
.p2align 6
.amdhsa_kernel adaLN_cond__ssm_conv_h3__mixer_gmlp__prompt_kernel
  .amdhsa_next_free_vgpr 256
  .amdhsa_next_free_sgpr 102
  .amdhsa_accum_offset 256
  .amdhsa_group_segment_fixed_size 0
  .amdhsa_kernarg_size 128
  .amdhsa_user_sgpr_count 2
  .amdhsa_user_sgpr_kernarg_segment_ptr 1
  .amdhsa_system_sgpr_workgroup_id_x 1
  .amdhsa_float_denorm_mode_32 3
.end_amdhsa_kernel
```
